```python
import torch

def _softmax(x, axis=-1):
    return torch.softmax(x, dim=axis)
def _gelu(x):
    return torch.nn.functional.gelu(x, approximate="tanh")
def _silu(x):
    return torch.nn.functional.silu(x)
def _sigmoid(x):
    return torch.sigmoid(x)
def _layernorm(x, axis=-1, eps=1e-5):
    m = x.mean(dim=axis, keepdim=True)
    v = x.var(dim=axis, keepdim=True, unbiased=False)
    return (x - m) / torch.sqrt(v + eps)
def _scatter_add(tgt, idx, src, axis=0):
    return tgt.clone().index_add_(axis, idx, src)
def _segment_sum(src, seg, n):
    out = torch.zeros((n,) + src.shape[1:], dtype=src.dtype)
    return out.index_add_(0, seg, src)
def _pad(x, pw):
    flat = tuple(v for pair in reversed(pw) for v in pair)
    return torch.nn.functional.pad(x, flat)

kernel_name = 'recurrent_scan__linear_attn_block__glu_gated_bilinear__prompt'

def setup_inputs():

    _w = (lambda a: (lambda t: t.to(torch.bfloat16) if t.is_floating_point() else t)(torch.as_tensor(a)))
    def _A_setup():
        B, S, D = 1, 2048, 576
        return {
            "x": _w((lambda *s: torch.randn(*s, dtype=torch.bfloat16) * 0.05)(B, S, D)),
            "wqkv": _w((lambda *s: torch.randn(*s, dtype=torch.bfloat16) * 0.8)(D, 3 * D)),
            "wo": _w((lambda *s: torch.randn(*s, dtype=torch.bfloat16) * 0.8)(D, D)),
        }
    _A_in = _A_setup()

    def _B_setup():
        B, S, D, F = 1, 2048, 576, 4608
        return {
            "x": _w((lambda *s: torch.randn(*s, dtype=torch.bfloat16) * 0.05)(B, S, D)),
            "w_gate": _w((lambda *s: torch.randn(*s, dtype=torch.bfloat16) * 0.2)(D, F) * (D ** -0.5)),
            "w_up": _w((lambda *s: torch.randn(*s, dtype=torch.bfloat16) * 0.2)(D, F) * (D ** -0.5)),
            "w_down": _w((lambda *s: torch.randn(*s, dtype=torch.bfloat16) * 0.2)(F, D) * (F ** -0.5)),
        }
    _B_in = _B_setup()

    return {
        "A_x": _A_in["x"],
        "A_wqkv": _A_in["wqkv"],
        "A_wo": _A_in["wo"],
        "B_x": _B_in["x"],
        "B_w_gate": _B_in["w_gate"],
        "B_w_up": _B_in["w_up"],
        "B_w_down": _B_in["w_down"],
    }

def reference(A_x, A_wqkv, A_wo, B_x, B_w_gate, B_w_up, B_w_down):
    def _A_ref(x, wqkv, wo):
        B, S, D = x.shape
        H = 32; Dh = D // H
        qkv = (lambda x, *d: x.permute(*d))((x @ wqkv).reshape(B, S, 3, H, Dh), 2, 0, 3, 1, 4)
        q, k, v = qkv[0], qkv[1], qkv[2]
        phi = lambda t: torch.where(t > 0, t + 1, torch.exp(t)) + 1e-6
        pq, pk = phi(q), phi(k)
        kv = torch.einsum("bhsd,bhse->bhde", pk, v)
        z = torch.einsum("bhsd->bhd", pk)
        num = torch.einsum("bhqd,bhde->bhqe", pq, kv)
        den = torch.einsum("bhqd,bhd->bhq", pq, z)[..., None] + 1e-6
        o = num / den
        return (lambda x, *d: x.permute(*d))(o, 0, 2, 1, 3).reshape(B, S, D) @ wo

    def _B_ref(x, w_gate, w_up, w_down):
        g = torch.einsum("bsd,df->bsf", x, w_gate)
        u = torch.einsum("bsd,df->bsf", x, w_up)
        h = g * u
        return torch.einsum("bsf,fd->bsd", h, w_down)

    x = A_x
    xn = _layernorm(x, axis=-1)
    s = _A_ref(xn, A_wqkv, A_wo)
    g = _silu(_B_ref(xn, B_w_gate, B_w_up, B_w_down))
    return x + s * g
```

```asm
; @launch grid=(256,1,1) block=(256,1,1) lds=163840
.amdgcn_target "amdgcn-amd-amdhsa--gfx950"
.text
.globl recurrent_scan__linear_attn_block__glu_gated_bilinear__prompt_kernel
.p2align 8
.type recurrent_scan__linear_attn_block__glu_gated_bilinear__prompt_kernel,@function
recurrent_scan__linear_attn_block__glu_gated_bilinear__prompt_kernel:
    s_cmp_ge_u32 s2, 256
    s_cbranch_scc1 L_end
    s_load_dwordx2 s[4:5], s[0:1], 0
    s_load_dwordx2 s[32:33], s[0:1], 72
    s_load_dwordx2 s[16:17], s[0:1], 32
    s_load_dwordx2 s[20:21], s[0:1], 40
    s_load_dwordx2 s[8:9], s[0:1], 8
    s_load_dwordx2 s[12:13], s[0:1], 16
    s_load_dwordx2 s[24:25], s[0:1], 48
    s_load_dwordx2 s[28:29], s[0:1], 56
    v_lshrrev_b32 v1, 6, v0
    v_and_b32 v209, 63, v0
    v_readfirstlane_b32 s36, v1
    s_and_b32 s94, s2, 7
    s_lshr_b32 s95, s2, 3
    s_and_b32 s44, s94, 0
    s_lshl_b32 s44, s44, 4
    s_and_b32 s45, s95, 15
    s_add_u32 s37, s44, s45
    s_lshr_b32 s44, s94, 0
    s_lshl_b32 s44, s44, 1
    s_lshr_b32 s45, s95, 4
    s_add_u32 s38, s44, s45
    s_add_u32 s42, s37, s38
    s_mul_i32 s44, s42, 171
    s_lshr_b32 s44, s44, 9
    s_mul_i32 s44, s44, 3
    s_sub_u32 s66, s42, s44
    v_lshrrev_b32 v58, 3, v209
    v_mul_u32_u24 v58, 1152, v58
    v_lshrrev_b32 v59, 4, v209
    v_and_b32 v60, 7, v209
    v_xor_b32 v60, v60, v59
    v_lshl_add_u32 v52, v60, 4, v58
    v_xor_b32 v60, 4, v60
    v_lshl_add_u32 v53, v60, 4, v58
    v_add_u32 v54, 16384, v52
    v_add_u32 v55, 24576, v53
    v_add_u32 v53, 8192, v53
    s_lshl_b32 s42, s37, 2
    s_add_u32 s42, s42, s36
    s_mul_i32 s89, s42, 36864
    s_lshl_b32 s80, s36, 12
    s_mov_b32 s6, 2359296
    s_mov_b32 s7, 0x20000
    s_waitcnt lgkmcnt(0)
    s_mul_i32 s74, s66, 384
    s_add_u32 s74, s74, s89
    s_add_u32 m0, s80, 0
    s_nop 0
    buffer_load_dwordx4 v52, s[4:7], s74 offen offset:0  lds
    buffer_load_dwordx4 v53, s[4:7], s74 offen offset:1024  lds
    buffer_load_dwordx4 v54, s[4:7], s74 offen offset:2048  lds
    buffer_load_dwordx4 v55, s[4:7], s74 offen offset:3072  lds
    s_add_u32 s74, s74, 128
    s_add_u32 m0, s80, 16384
    s_nop 0
    buffer_load_dwordx4 v52, s[4:7], s74 offen offset:0  lds
    buffer_load_dwordx4 v53, s[4:7], s74 offen offset:1024  lds
    buffer_load_dwordx4 v54, s[4:7], s74 offen offset:2048  lds
    buffer_load_dwordx4 v55, s[4:7], s74 offen offset:3072  lds
    s_add_u32 s74, s74, 128
    s_add_u32 m0, s80, 32768
    s_nop 0
    buffer_load_dwordx4 v52, s[4:7], s74 offen offset:0  lds
    buffer_load_dwordx4 v53, s[4:7], s74 offen offset:1024  lds
    buffer_load_dwordx4 v54, s[4:7], s74 offen offset:2048  lds
    buffer_load_dwordx4 v55, s[4:7], s74 offen offset:3072  lds
    s_add_u32 s67, s66, 1
    s_cmp_eq_u32 s67, 3
    s_cselect_b32 s67, 0, s67
    s_add_u32 s68, s67, 1
    s_cmp_eq_u32 s68, 3
    s_cselect_b32 s68, 0, s68
    s_mov_b32 s34, 268435456
    s_mov_b32 s35, 0x20000
    s_mov_b32 s30, 2359296
    s_mov_b32 s31, 0x20000
    s_sub_u32 s16, s16, 3072
    s_subb_u32 s17, s17, 0
    s_mov_b32 s18, 5311488
    s_mov_b32 s19, 0x20000
    s_sub_u32 s20, s20, 3072
    s_subb_u32 s21, s21, 0
    s_mov_b32 s22, 5311488
    s_mov_b32 s23, 0x20000
    s_sub_u32 s8, s8, 3072
    s_subb_u32 s9, s9, 0
    s_mov_b32 s10, 1993728
    s_mov_b32 s11, 0x20000
    s_sub_u32 s12, s12, 3072
    s_subb_u32 s13, s13, 0
    s_mov_b32 s14, 666624
    s_mov_b32 s15, 0x20000
    s_sub_u32 s24, s24, 3072
    s_subb_u32 s25, s25, 0
    s_mov_b32 s26, 5311488
    s_mov_b32 s27, 0x20000
    s_lshl_b32 s91, s95, 2
    s_add_u32 s91, s91, s36
    s_lshl_b32 s91, s91, 7
    s_lshl_b32 s94, s94, 1
    s_lshr_b32 s44, s95, 4
    s_add_u32 s94, s94, s44
    s_and_b32 s95, s95, 15
    s_and_b32 s41, s38, 1
    s_mul_i32 s39, s36, 6144
    s_mul_i32 s72, s41, 640
    s_lshr_b32 s42, s38, 1
    s_add_u32 s71, s42, s37
    s_and_b32 s71, s71, 3
    s_mul_i32 s70, s42, 1152
    s_mul_i32 s48, s66, 1769472
    s_add_u32 s49, s48, 294912
    s_add_u32 s50, s49, 294912
    s_add_u32 s51, s50, 294912
    s_add_u32 s52, s51, 294912
    s_add_u32 s53, s52, 294912
    s_mul_i32 s54, s67, 1769472
    s_add_u32 s55, s54, 294912
    s_add_u32 s56, s55, 294912
    s_add_u32 s57, s56, 294912
    s_add_u32 s58, s57, 294912
    s_add_u32 s59, s58, 294912
    s_mul_i32 s60, s68, 1769472
    s_add_u32 s61, s60, 294912
    s_add_u32 s62, s61, 294912
    s_add_u32 s63, s62, 294912
    s_add_u32 s64, s63, 294912
    s_add_u32 s65, s64, 294912
    s_lshl_b32 s42, s37, 4
    s_add_u32 s42, s42, s38
    s_mul_i32 s47, s42, 256
    s_add_u32 s47, s47, 47185920
    s_mul_i32 s46, s42, 73728
    s_mul_i32 s43, s36, 18432
    s_add_u32 s46, s46, s43
    s_add_u32 s46, s46, 20971520
    s_lshl_b32 s42, s37, 1
    s_add_u32 s42, s42, s41
    s_lshl_b32 s42, s42, 3
    s_lshr_b32 s44, s38, 1
    s_add_u32 s42, s42, s44
    s_mul_i32 s79, s42, 73728
    s_add_u32 s79, s79, s43
    s_mul_i32 s42, s41, 147456
    s_sub_u32 s42, 73728, s42
    s_add_u32 s75, s46, s42
    s_lshl_b32 s76, s38, 4
    s_add_u32 s76, s76, s37
    s_lshl_b32 s76, s76, 2
    s_add_u32 s76, s76, s36
    s_lshl_b32 s76, s76, 10
    s_add_u32 s76, s76, 46137344
    s_lshl_b32 s81, s37, 2
    s_add_u32 s81, s81, s36
    s_lshl_b32 s81, s81, 16
    s_add_u32 s81, s81, 41943040
    s_lshr_b32 s82, s38, 3
    s_lshl_b32 s82, s82, 4
    s_and_b32 s42, s38, 7
    s_xor_b32 s42, s42, 0
    s_add_u32 s82, s82, s42
    s_lshl_b32 s82, s82, 7
    s_add_u32 s82, s82, s81
    s_add_u32 s82, s82, 32768
    s_lshr_b32 s42, s95, 3
    s_bfe_u32 s43, s95, 0x20001
    s_and_b32 s44, s95, 1
    s_lshl_b32 s44, s44, 1
    s_lshr_b32 s45, s36, 1
    s_add_u32 s44, s44, s45
    s_and_b32 s45, s36, 1
    s_and_b32 s78, s95, 14
    s_sub_u32 s88, s43, s94
    s_mul_i32 s90, s42, 640
    s_lshl_b32 s69, s43, 7
    s_add_u32 s90, s90, s69
    s_lshl_b32 s73, s42, 6
    s_lshl_b32 s69, s43, 4
    s_add_u32 s73, s73, s69
    s_add_u32 s73, s73, 512
    s_lshl_b32 s84, s94, 2
    s_add_u32 s84, s84, s44
    s_lshl_b32 s85, s84, 1
    s_add_u32 s85, s85, s45
    s_mul_i32 s85, s85, 18432
    s_add_u32 s86, s85, 9216
    s_lshl_b32 s84, s84, 16
    s_add_u32 s84, s84, 41943040
    s_lshl_b32 s69, s45, 10
    s_add_u32 s84, s84, s69
    s_lshl_b32 s83, s78, 11
    s_add_u32 s83, s83, s84
    s_lshl_b32 s87, s94, 1
    s_add_u32 s87, s87, s42
    s_mul_i32 s87, s87, 589824
    s_mul_i32 s44, s44, 18432
    s_add_u32 s87, s87, s44
    s_add_u32 s101, s87, s69
    s_add_u32 s101, s101, 16384
    s_and_b32 s44, s43, 1
    s_lshl_b32 s44, s44, 9
    s_add_u32 s101, s101, s44
    s_lshr_b32 s44, s43, 1
    s_lshl_b32 s44, s44, 3
    s_add_u32 s101, s101, s44
    s_lshl_b32 s43, s43, 12
    s_add_u32 s87, s87, s43
    s_lshl_b32 s69, s69, 1
    s_add_u32 s87, s87, s69
    s_mul_i32 s95, s94, 4096
    s_add_u32 s95, s95, 47185920
    s_mul_i32 s42, s42, 256
    s_add_u32 s94, s95, s42
    v_lshlrev_b32 v208, 4, v209
    v_lshrrev_b32 v36, 4, v209
    v_and_b32 v39, 15, v209
    v_lshrrev_b32 v37, 2, v39
    v_and_b32 v38, 3, v209
    v_and_b32 v41, 1, v36
    v_lshl_add_u32 v40, v41, 2, v37
    v_mov_b32 v50, 1073741824
    v_lshrrev_b32 v46, 3, v39
    v_lshlrev_b32 v46, 10, v46
    v_and_b32 v47, 7, v39
    v_lshl_add_u32 v46, v47, 7, v46
    v_add_u32 v46, s80, v46
    v_lshrrev_b32 v47, 1, v39
    v_lshrrev_b32 v48, 1, v36
    v_xor_b32 v47, v47, v48
    v_lshl_add_u32 v56, v47, 4, v46
    v_lshl_add_u32 v56, v41, 3, v56
    v_xor_b32 v57, 32, v56
    v_xor_b32 v58, 64, v56
    v_xor_b32 v59, 96, v56
    v_mov_b32 v0, 0x3f803f80
    v_mov_b32 v1, 0x3f803f80
    v_mov_b32 v2, 0x3f803f80
    v_mov_b32 v3, 0x3f803f80
    v_and_b32 v46, 1, v209
    v_lshlrev_b32 v46, 4, v46
    v_mov_b32 v47, 0x3f80
    v_lshlrev_b32 v46, v46, v47
    v_cmp_gt_u32 vcc, 2, v38
    s_nop 1
    v_cndmask_b32 v4, 0, v46, vcc
    v_cndmask_b32 v5, v46, 0, vcc
    v_accvgpr_write_b32 a199, v4
    v_accvgpr_write_b32 a200, v5
    v_lshrrev_b32 v44, 3, v209
    s_lshl_b32 s42, s36, 3
    v_add_u32 v46, s42, v44
    v_and_b32 v45, 7, v209
    v_lshlrev_b32 v48, 1, v36
    v_xor_b32 v47, v45, v48
    s_lshl_b32 s100, s41, 9
    s_add_u32 s100, s100, s70
    s_add_u32 s100, s100, 3072
    v_mul_u32_u24 v48, 9216, v46
    v_lshl_add_u32 v48, v47, 4, v48
    v_add_u32 v224, s100, v48
    v_subrev_u32 v225, 1024, v224
    v_subrev_u32 v226, 2048, v224
    v_subrev_u32 v227, 3072, v224
    v_mul_u32_u24 v48, 1152, v46
    v_lshl_add_u32 v49, v47, 4, v48
    v_add_u32 v49, 3072, v49
    v_accvgpr_write_b32 a249, v49
    v_lshrrev_b32 v46, 2, v209
    s_lshl_b32 s43, s36, 4
    v_add_u32 v49, s43, v46
    v_lshlrev_b32 v47, 1, v41
    v_xor_b32 v47, v47, v38
    s_lshl_b32 s43, s41, 6
    s_add_u32 s42, s70, s43
    s_add_u32 s42, s42, 4096
    v_mul_u32_u24 v48, 9216, v49
    v_lshl_add_u32 v48, v47, 4, v48
    v_add_u32 v48, s42, v48
    v_accvgpr_write_b32 a248, v48
    s_add_u32 s43, s43, 3584
    v_mul_u32_u24 v48, 1152, v49
    v_lshl_add_u32 v48, v47, 4, v48
    v_add_u32 v48, s43, v48
    v_accvgpr_write_b32 a250, v48
    s_add_u32 s42, s73, 3072
    v_mul_u32_u24 v48, 36, v46
    v_add3_u32 v48, v48, v38, 32
    v_mul_u32_u24 v48, 1152, v48
    v_add_u32 v48, s42, v48
    v_accvgpr_write_b32 a254, v48
    v_lshrrev_b32 v48, 5, v209
    v_lshl_add_u32 v48, v48, 2, v209
    v_mul_u32_u24 v48, 1152, v48
    v_add_u32 v48, s42, v48
    v_accvgpr_write_b32 a251, v48
    s_and_b32 s42, s36, 1
    s_lshl_b32 s42, s42, 2
    v_add_u32 v46, s42, v36
    v_lshlrev_b32 v46, 1, v46
    v_xor_b32 v46, v46, v39
    v_mul_u32_u24 v47, 52, v46
    v_lshrrev_b32 v47, 8, v47
    v_mul_u32_u24 v48, 1072, v47
    v_lshl_add_u32 v48, v46, 4, v48
    s_mul_i32 s77, s38, 72
    s_and_b32 s77, s77, 0xfffffff0
    s_add_u32 s77, s77, 3072
    s_xor_b32 s43, s38, 0
    s_mul_i32 s43, s43, 72
    s_and_b32 s43, s43, 0xfffffff0
    s_add_u32 s43, s43, 3072
    v_mov_b32 v42, s77
    v_mov_b32 v43, s43
    v_cmp_eq_u32 vcc, 0, v47
    s_nop 1
    v_cndmask_b32 v42, v42, v43, vcc
    s_lshl_b32 s42, s36, 2
    v_add_u32 v49, s42, v36
    v_mul_u32_u24 v49, 3456, v49
    v_add3_u32 v48, v48, v49, v42
    v_cmp_gt_u32 vcc, 3, v47
    s_nop 1
    v_cndmask_b32 v228, v50, v48, vcc
    v_subrev_u32 v229, 1024, v228
    v_subrev_u32 v230, 2048, v228
    v_subrev_u32 v231, 3072, v228
    v_lshrrev_b32 v42, 1, v36
    v_mul_u32_u24 v42, 6144, v42
    v_lshl_add_u32 v42, v40, 7, v42
    v_lshrrev_b32 v43, 1, v40
    v_lshl_add_u32 v42, v43, 5, v42
    v_lshl_add_u32 v212, v38, 3, v42
    v_xor_b32 v213, 32, v212
    v_xor_b32 v214, 64, v212
    v_xor_b32 v215, 96, v212
    v_lshlrev_b32 v47, 4, v39
    v_and_b32 v47, 0xc0, v47
    v_lshl_add_u32 v47, v36, 8, v47
    v_lshl_add_u32 v48, v41, 5, v47
    v_lshl_add_u32 v48, v38, 3, v48
    v_accvgpr_write_b32 a252, v48
    v_lshrrev_b32 v47, 2, v47
    v_and_b32 v48, 1, v38
    v_lshl_add_u32 v47, v48, 3, v47
    v_add_u32 v47, 147456, v47
    v_accvgpr_write_b32 a253, v47
    v_add_u32 v43, s41, v38
    v_mul_u32_u24 v46, 6144, v36
    v_lshl_add_u32 v46, v37, 8, v46
    v_lshlrev_b32 v48, 2, v40
    v_add_u32 v47, 10, v43
    v_xor_b32 v47, v47, v48
    v_lshl_add_u32 v216, v47, 3, v46
    v_add_u32 v47, 14, v43
    v_xor_b32 v47, v47, v48
    v_lshl_add_u32 v217, v47, 3, v46
    v_add_u32 v47, 20, v43
    v_xor_b32 v47, v47, v48
    v_lshl_add_u32 v218, v47, 3, v46
    v_add_u32 v47, 24, v43
    v_xor_b32 v47, v47, v48
    v_lshl_add_u32 v219, v47, 3, v46
    v_lshlrev_b32 v47, 3, v38
    v_mov_b32 v49, 0x13081c12
    v_lshrrev_b32 v47, v47, v49
    v_and_b32 v47, 0xff, v47
    v_add_u32 v47, s41, v47
    v_xor_b32 v47, v47, v48
    v_lshl_add_u32 v220, v47, 3, v46
    v_add_u32 v47, 0, v43
    v_xor_b32 v47, v47, v48
    v_lshl_add_u32 v221, v47, 3, v46
    v_add_u32 v47, 4, v43
    v_xor_b32 v47, v47, v48
    v_lshl_add_u32 v222, v47, 3, v46
    s_cmp_eq_u32 s36, 0
    s_cselect_b32 s42, 0, 1073741824
    v_mov_b32 v43, s42
    v_cmp_eq_u32 vcc, 0, v209
    s_nop 1
    v_cndmask_b32 v255, v50, v43, vcc
    s_and_b32 s42, s37, 15
    s_lshl_b32 s42, s42, 2
    s_add_u32 s42, s42, s36
    s_mul_i32 s42, s42, 9
    v_min_u32 v248, 8, v209
    v_add_u32 v248, s42, v248
    v_cmp_gt_u32 vcc, 9, v209
    s_nop 1
    v_cndmask_b32 v249, v50, 0, vcc
    s_mul_i32 s74, s67, 384
    s_add_u32 s74, s74, s89
    s_add_u32 m0, s80, 49152
    s_nop 0
    buffer_load_dwordx4 v52, s[4:7], s74 offen offset:0  lds
    buffer_load_dwordx4 v53, s[4:7], s74 offen offset:1024  lds
    buffer_load_dwordx4 v54, s[4:7], s74 offen offset:2048  lds
    buffer_load_dwordx4 v55, s[4:7], s74 offen offset:3072  lds
    s_mul_i32 s42, s36, 3648
    s_add_u32 s42, s42, 147456
    v_mov_b32 v18, 96
    v_mov_b32 v8, v36
    v_mad_u32_u24 v9, v39, v18, s42
    v_subrev_u32 v19, 2, v39
    v_ashrrev_i32 v20, 31, v19
    v_and_b32 v20, 4, v20
    v_add3_u32 v10, v20, v36, -4
    v_add_u32 v19, 16, v39
    v_mad_u32_u24 v11, v19, v18, s42
    v_cmp_lt_u32 vcc, 11, v39
    v_add_u32 v19, 28, v39
    v_add_u32 v20, 24, v39
    v_cndmask_b32 v19, v19, v20, vcc
    v_min_u32 v19, 37, v19
    v_mad_u32_u24 v13, v19, v18, s42
    v_add_u32 v12, -4, v36
    v_cmp_eq_u32 s[0:1], 12, v39
    v_mov_b32 v20, 0x30f0
    v_lshrrev_b32 v20, v39, v20
    v_and_b32 v20, 1, v20
    v_cndmask_b32 v12, v12, v36, s[0:1]
    v_cmp_eq_u32 s[2:3], 0, v20
    v_mov_b32 v20, 64
    s_nop 0
    v_cndmask_b32 v12, v12, v20, s[2:3]
    v_add_u32 v19, 0, v8
    v_min_u32 v19, 5, v19
    v_lshl_add_u32 v19, v19, 4, v9
    v_accvgpr_write_b32 a160, v19
    v_add_u32 v19, 0, v10
    v_min_u32 v19, 5, v19
    v_lshl_add_u32 v19, v19, 4, v11
    v_accvgpr_write_b32 a161, v19
    v_add_u32 v19, 0, v12
    v_min_u32 v19, 5, v19
    v_lshl_add_u32 v19, v19, 4, v13
    v_accvgpr_write_b32 a162, v19
    v_add_u32 v19, 4, v8
    v_min_u32 v19, 5, v19
    v_lshl_add_u32 v19, v19, 4, v9
    v_accvgpr_write_b32 a163, v19
    v_add_u32 v19, 4, v10
    v_min_u32 v19, 5, v19
    s_waitcnt vmcnt(12)
    ds_read_b64 v[64:65], v56 offset:0
    ds_read_b64 v[66:67], v57 offset:0
    ds_read_b64 v[68:69], v56 offset:2048
    ds_read_b64 v[70:71], v57 offset:2048
    ds_read_b64 v[72:73], v58 offset:0
    ds_read_b64 v[74:75], v59 offset:0
    ds_read_b64 v[76:77], v58 offset:2048
    ds_read_b64 v[78:79], v59 offset:2048
    s_add_u32 s74, s74, 128
    s_add_u32 m0, s80, 65536
    s_nop 0
    buffer_load_dwordx4 v52, s[4:7], s74 offen offset:0  lds
    buffer_load_dwordx4 v53, s[4:7], s74 offen offset:1024  lds
    buffer_load_dwordx4 v54, s[4:7], s74 offen offset:2048  lds
    buffer_load_dwordx4 v55, s[4:7], s74 offen offset:3072  lds
    v_lshl_add_u32 v19, v19, 4, v11
    v_accvgpr_write_b32 a164, v19
    v_add_u32 v19, 4, v12
    v_min_u32 v19, 5, v19
    v_lshl_add_u32 v19, v19, 4, v13
    v_accvgpr_write_b32 a165, v19
    v_add_u32 v19, 8, v10
    v_min_u32 v19, 5, v19
    v_lshl_add_u32 v19, v19, 4, v11
    v_accvgpr_write_b32 a166, v19
    v_add_u32 v19, 8, v12
    v_min_u32 v19, 5, v19
    v_lshl_add_u32 v19, v19, 4, v13
    v_accvgpr_write_b32 a167, v19
    v_and_b32 v8, 1, v39
    v_lshlrev_b32 v8, 4, v8
    v_mov_b32 v9, 0x3f80
    v_lshlrev_b32 v8, v8, v9
    v_lshrrev_b32 v9, 1, v39
    v_lshlrev_b32 v10, 1, v36
    v_sub_u32 v9, v9, v10
    v_cmp_eq_u32 s[0:1], 0, v9
    v_cmp_eq_u32 s[2:3], 1, v9
    s_nop 0
    v_cndmask_b32 v9, 0, v8, s[0:1]
    v_cndmask_b32 v10, 0, v8, s[2:3]
    v_accvgpr_write_b32 a168, v9
    v_accvgpr_write_b32 a169, v10
    s_mul_i32 s42, s36, 57
    v_add_u32 v8, s42, v209
    v_mul_u32_u24 v9, 171, v8
    v_lshrrev_b32 v9, 10, v9
    v_mul_u32_u24 v10, 6, v9
    v_sub_u32 v10, v8, v10
    v_cmp_lt_u32 s[0:1], 17, v9
    v_cmp_eq_u32 s[2:3], 36, v9
    v_mov_b32 v11, 0
    s_nop 0
    s_andn2_b64 s[0:1], s[0:1], s[2:3]
    v_cndmask_b32 v11, v11, 4, s[0:1]
    v_add_u32 v11, v10, v11
    v_mul_u32_u24 v9, 136, v9
    v_lshl_add_u32 v8, v11, 3, v9
    v_and_b32 v9, 8, v11
    v_lshl_add_u32 v8, v9, 1, v8
    v_add_u32 v8, 147456, v8
    s_waitcnt vmcnt(12)
    ds_read_b64 v[80:81], v56 offset:16384
    ds_read_b64 v[82:83], v57 offset:16384
    ds_read_b64 v[84:85], v56 offset:18432
    ds_read_b64 v[86:87], v57 offset:18432
    ds_read_b64 v[88:89], v58 offset:16384
    ds_read_b64 v[90:91], v59 offset:16384
    ds_read_b64 v[92:93], v58 offset:18432
    ds_read_b64 v[94:95], v59 offset:18432
    s_waitcnt lgkmcnt(14)
    v_mfma_f32_16x16x32_bf16 v[232:235], v[0:3], v[64:67], 0
    v_mfma_f32_16x16x32_bf16 v[240:243], v[64:67], v[64:67], 0
    s_waitcnt lgkmcnt(12)
    v_mfma_f32_16x16x32_bf16 v[236:239], v[0:3], v[68:71], 0
    v_mfma_f32_16x16x32_bf16 v[244:247], v[68:71], v[68:71], 0
    s_waitcnt lgkmcnt(10)
    v_mfma_f32_16x16x32_bf16 v[232:235], v[0:3], v[72:75], v[232:235]
    v_mfma_f32_16x16x32_bf16 v[240:243], v[72:75], v[72:75], v[240:243]
    s_waitcnt lgkmcnt(8)
    v_mfma_f32_16x16x32_bf16 v[236:239], v[0:3], v[76:79], v[236:239]
    v_mfma_f32_16x16x32_bf16 v[244:247], v[76:79], v[76:79], v[244:247]
    s_add_u32 s74, s74, 128
    s_add_u32 m0, s80, 81920
    s_nop 0
    buffer_load_dwordx4 v52, s[4:7], s74 offen offset:0  lds
    buffer_load_dwordx4 v53, s[4:7], s74 offen offset:1024  lds
    buffer_load_dwordx4 v54, s[4:7], s74 offen offset:2048  lds
    buffer_load_dwordx4 v55, s[4:7], s74 offen offset:3072  lds
    v_cmp_lt_u32 s[0:1], 4, v10
    v_cmp_lt_u32 s[2:3], 56, v209
    v_lshrrev_b32 v9, 1, v208
    v_add_u32 v9, 162880, v9
    s_or_b64 s[0:1], s[0:1], s[2:3]
    v_cndmask_b32 v8, v8, v9, s[0:1]
    v_accvgpr_write_b32 a176, v8
    v_cmp_eq_u32 s[0:1], 4, v11
    v_cmp_eq_u32 s[2:3], 4, v10
    v_mov_b32 v9, -1
    s_nop 0
    s_and_b64 s[2:3], s[2:3], s[0:1]
    s_andn2_b64 s[0:1], s[0:1], s[2:3]
    v_cndmask_b32 v8, v9, 0, s[0:1]
    v_cndmask_b32 v9, v9, 0, s[2:3]
    v_accvgpr_write_b32 a177, v8
    v_accvgpr_write_b32 a178, v9
    v_lshlrev_b32 v8, 3, v36
    v_add_u32 v8, 147456, v8
    v_mov_b32 v18, 136
    v_mad_u32_u24 v9, v39, v18, v8
    v_accvgpr_write_b32 a179, v9
    v_add_u32 v9, 32, v39
    v_min_u32 v9, 37, v9
    v_mad_u32_u24 v9, v9, v18, v8
    v_accvgpr_write_b32 a180, v9
    v_bfe_u32 v9, v39, 1, 1
    v_add_u32 v9, 36, v9
    v_mad_u32_u24 v9, v9, v18, v8
    v_accvgpr_write_b32 a181, v9
    v_lshlrev_b32 v9, 3, v39
    v_lshl_add_u32 v9, v36, 10, v9
    v_cmp_gt_u32 vcc, 32, v209
    s_nop 1
    v_cndmask_b32 v9, v50, v9, vcc
    v_accvgpr_write_b32 a182, v9
    v_cndmask_b32 v9, v50, v208, vcc
    v_accvgpr_write_b32 a194, v9
    v_mul_u32_u24 v8, 1152, v44
    v_lshlrev_b32 v9, 4, v45
    v_add3_u32 v8, v8, v9, s90
    v_accvgpr_write_b32 a192, v8
    s_mul_i32 s42, s36, 2304
    s_add_u32 s42, s42, 49152
    v_mul_u32_u24 v8, 144, v44
    v_add3_u32 v8, v8, v9, s42
    v_accvgpr_write_b32 a196, v8
    v_mul_u32_u24 v8, 144, v39
    v_add_u32 v8, s42, v8
    v_lshl_add_u32 v9, v36, 3, v8
    v_accvgpr_write_b32 a195, v9
    v_add_u32 v8, 128, v8
    v_accvgpr_write_b32 a197, v8
    v_mul_u32_u24 v8, 1152, v209
    v_add_u32 v8, s73, v8
    v_cmp_gt_u32 vcc, 16, v209
    s_nop 1
    v_cndmask_b32 v8, v50, v8, vcc
    v_accvgpr_write_b32 a193, v8
    v_sub_u32 v8, s88, v44
    v_and_b32 v8, 3, v8
    v_accvgpr_write_b32 a198, v8
    s_waitcnt vmcnt(12)
    ds_read_b64 v[96:97], v56 offset:32768
    ds_read_b64 v[98:99], v57 offset:32768
    ds_read_b64 v[100:101], v56 offset:34816
    ds_read_b64 v[102:103], v57 offset:34816
    ds_read_b64 v[104:105], v58 offset:32768
    ds_read_b64 v[106:107], v59 offset:32768
    ds_read_b64 v[108:109], v58 offset:34816
    ds_read_b64 v[110:111], v59 offset:34816
    s_waitcnt lgkmcnt(14)
    v_mfma_f32_16x16x32_bf16 v[232:235], v[0:3], v[80:83], v[232:235]
    v_mfma_f32_16x16x32_bf16 v[240:243], v[80:83], v[80:83], v[240:243]
    s_waitcnt lgkmcnt(12)
    v_mfma_f32_16x16x32_bf16 v[236:239], v[0:3], v[84:87], v[236:239]
    v_mfma_f32_16x16x32_bf16 v[244:247], v[84:87], v[84:87], v[244:247]
    s_waitcnt lgkmcnt(10)
    v_mfma_f32_16x16x32_bf16 v[232:235], v[0:3], v[88:91], v[232:235]
    v_mfma_f32_16x16x32_bf16 v[240:243], v[88:91], v[88:91], v[240:243]
    s_waitcnt lgkmcnt(8)
    v_mfma_f32_16x16x32_bf16 v[236:239], v[0:3], v[92:95], v[236:239]
    v_mfma_f32_16x16x32_bf16 v[244:247], v[92:95], v[92:95], v[244:247]
    s_mul_i32 s74, s68, 384
    s_add_u32 s74, s74, s89
    s_add_u32 m0, s80, 98304
    s_nop 0
    buffer_load_dwordx4 v52, s[4:7], s74 offen offset:0  lds
    buffer_load_dwordx4 v53, s[4:7], s74 offen offset:1024  lds
    buffer_load_dwordx4 v54, s[4:7], s74 offen offset:2048  lds
    buffer_load_dwordx4 v55, s[4:7], s74 offen offset:3072  lds
    s_waitcnt vmcnt(12)
    v_add_u32 v56, 49152, v56
    v_add_u32 v57, 49152, v57
    v_add_u32 v58, 49152, v58
    v_add_u32 v59, 49152, v59
    ds_read_b64 v[112:113], v56 offset:0
    ds_read_b64 v[114:115], v57 offset:0
    ds_read_b64 v[116:117], v56 offset:2048
    ds_read_b64 v[118:119], v57 offset:2048
    ds_read_b64 v[120:121], v58 offset:0
    ds_read_b64 v[122:123], v59 offset:0
    ds_read_b64 v[124:125], v58 offset:2048
    ds_read_b64 v[126:127], v59 offset:2048
    s_waitcnt lgkmcnt(14)
    v_mfma_f32_16x16x32_bf16 v[232:235], v[0:3], v[96:99], v[232:235]
    v_mfma_f32_16x16x32_bf16 v[240:243], v[96:99], v[96:99], v[240:243]
    s_waitcnt lgkmcnt(12)
    v_mfma_f32_16x16x32_bf16 v[236:239], v[0:3], v[100:103], v[236:239]
    v_mfma_f32_16x16x32_bf16 v[244:247], v[100:103], v[100:103], v[244:247]
    s_waitcnt lgkmcnt(10)
    v_mfma_f32_16x16x32_bf16 v[232:235], v[0:3], v[104:107], v[232:235]
    v_mfma_f32_16x16x32_bf16 v[240:243], v[104:107], v[104:107], v[240:243]
    s_waitcnt lgkmcnt(8)
    v_mfma_f32_16x16x32_bf16 v[236:239], v[0:3], v[108:111], v[236:239]
    v_mfma_f32_16x16x32_bf16 v[244:247], v[108:111], v[108:111], v[244:247]
    s_add_u32 s74, s74, 128
    s_add_u32 m0, s80, 114688
    s_nop 0
    buffer_load_dwordx4 v52, s[4:7], s74 offen offset:0  lds
    buffer_load_dwordx4 v53, s[4:7], s74 offen offset:1024  lds
    buffer_load_dwordx4 v54, s[4:7], s74 offen offset:2048  lds
    buffer_load_dwordx4 v55, s[4:7], s74 offen offset:3072  lds
    s_waitcnt vmcnt(12)
    ds_read_b64 v[128:129], v56 offset:16384
    ds_read_b64 v[130:131], v57 offset:16384
    ds_read_b64 v[132:133], v56 offset:18432
    ds_read_b64 v[134:135], v57 offset:18432
    ds_read_b64 v[136:137], v58 offset:16384
    ds_read_b64 v[138:139], v59 offset:16384
    ds_read_b64 v[140:141], v58 offset:18432
    ds_read_b64 v[142:143], v59 offset:18432
    s_waitcnt lgkmcnt(14)
    v_mfma_f32_16x16x32_bf16 v[232:235], v[0:3], v[112:115], v[232:235]
    v_mfma_f32_16x16x32_bf16 v[240:243], v[112:115], v[112:115], v[240:243]
    s_waitcnt lgkmcnt(12)
    v_mfma_f32_16x16x32_bf16 v[236:239], v[0:3], v[116:119], v[236:239]
    v_mfma_f32_16x16x32_bf16 v[244:247], v[116:119], v[116:119], v[244:247]
    s_waitcnt lgkmcnt(10)
    v_mfma_f32_16x16x32_bf16 v[232:235], v[0:3], v[120:123], v[232:235]
    v_mfma_f32_16x16x32_bf16 v[240:243], v[120:123], v[120:123], v[240:243]
    s_waitcnt lgkmcnt(8)
    v_mfma_f32_16x16x32_bf16 v[236:239], v[0:3], v[124:127], v[236:239]
    v_mfma_f32_16x16x32_bf16 v[244:247], v[124:127], v[124:127], v[244:247]
    s_add_u32 s74, s74, 128
    s_add_u32 m0, s80, 131072
    s_nop 0
    buffer_load_dwordx4 v52, s[4:7], s74 offen offset:0  lds
    buffer_load_dwordx4 v53, s[4:7], s74 offen offset:1024  lds
    buffer_load_dwordx4 v54, s[4:7], s74 offen offset:2048  lds
    buffer_load_dwordx4 v55, s[4:7], s74 offen offset:3072  lds
    s_mov_b32 s44, 47251456
    v_mov_b32 v61, 0
    buffer_load_dword v254, v61, s[32:35], s44 offen sc1
    s_getpc_b64 s[92:93]
L_pc:
    s_add_u32 s92, s92, L_code0-L_pc
    s_addc_u32 s93, s93, 0
    s_mul_i32 s42, s91, 3
    v_min_u32 v62, 2, v209
    v_lshlrev_b32 v62, 7, v62
    v_add_u32 v62, s42, v62
    global_load_dword a215, v62, s[92:93]
    s_waitcnt vmcnt(14)
    ds_read_b64 v[144:145], v56 offset:32768
    ds_read_b64 v[146:147], v57 offset:32768
    ds_read_b64 v[148:149], v56 offset:34816
    ds_read_b64 v[150:151], v57 offset:34816
    ds_read_b64 v[152:153], v58 offset:32768
    ds_read_b64 v[154:155], v59 offset:32768
    ds_read_b64 v[156:157], v58 offset:34816
    ds_read_b64 v[158:159], v59 offset:34816
    s_waitcnt lgkmcnt(14)
    v_mfma_f32_16x16x32_bf16 v[232:235], v[0:3], v[128:131], v[232:235]
    v_mfma_f32_16x16x32_bf16 v[240:243], v[128:131], v[128:131], v[240:243]
    s_waitcnt lgkmcnt(12)
    v_mfma_f32_16x16x32_bf16 v[236:239], v[0:3], v[132:135], v[236:239]
    v_mfma_f32_16x16x32_bf16 v[244:247], v[132:135], v[132:135], v[244:247]
    s_waitcnt lgkmcnt(10)
    v_mfma_f32_16x16x32_bf16 v[232:235], v[0:3], v[136:139], v[232:235]
    v_mfma_f32_16x16x32_bf16 v[240:243], v[136:139], v[136:139], v[240:243]
    s_waitcnt lgkmcnt(8)
    v_mfma_f32_16x16x32_bf16 v[236:239], v[0:3], v[140:143], v[236:239]
    v_mfma_f32_16x16x32_bf16 v[244:247], v[140:143], v[140:143], v[244:247]
    s_barrier
    s_waitcnt vmcnt(10)
    v_add_u32 v56, 49152, v56
    v_add_u32 v57, 49152, v57
    v_add_u32 v58, 49152, v58
    v_add_u32 v59, 49152, v59
    ds_read_b64 v[160:161], v56 offset:0
    ds_read_b64 v[162:163], v57 offset:0
    ds_read_b64 v[164:165], v56 offset:2048
    ds_read_b64 v[166:167], v57 offset:2048
    ds_read_b64 v[168:169], v58 offset:0
    ds_read_b64 v[170:171], v59 offset:0
    ds_read_b64 v[172:173], v58 offset:2048
    ds_read_b64 v[174:175], v59 offset:2048
    s_waitcnt lgkmcnt(14)
    v_mfma_f32_16x16x32_bf16 v[232:235], v[0:3], v[144:147], v[232:235]
    v_mfma_f32_16x16x32_bf16 v[240:243], v[144:147], v[144:147], v[240:243]
    s_waitcnt lgkmcnt(12)
    v_mfma_f32_16x16x32_bf16 v[236:239], v[0:3], v[148:151], v[236:239]
    v_mfma_f32_16x16x32_bf16 v[244:247], v[148:151], v[148:151], v[244:247]
    s_waitcnt lgkmcnt(10)
    v_mfma_f32_16x16x32_bf16 v[232:235], v[0:3], v[152:155], v[232:235]
    v_mfma_f32_16x16x32_bf16 v[240:243], v[152:155], v[152:155], v[240:243]
    s_waitcnt lgkmcnt(8)
    v_mfma_f32_16x16x32_bf16 v[236:239], v[0:3], v[156:159], v[236:239]
    v_mfma_f32_16x16x32_bf16 v[244:247], v[156:159], v[156:159], v[244:247]
    s_add_u32 m0, s39, 0
    s_nop 0
    buffer_load_dwordx4 v224, s[16:19], s48 offen offset:0  lds
    buffer_load_dwordx4 v225, s[20:23], s48 offen offset:1024  lds
    buffer_load_dwordx4 v226, s[16:19], s49 offen offset:2048  lds
    buffer_load_dwordx4 v227, s[20:23], s49 offen offset:3072  lds
    s_add_u32 m0, s39, 4096
    s_nop 0
    buffer_load_dwordx4 v224, s[16:19], s50 offen offset:0  lds
    buffer_load_dwordx4 v225, s[20:23], s50 offen offset:1024  lds
    s_waitcnt vmcnt(12)
    ds_read_b64 v[176:177], v56 offset:16384
    ds_read_b64 v[178:179], v57 offset:16384
    ds_read_b64 v[180:181], v56 offset:18432
    ds_read_b64 v[182:183], v57 offset:18432
    ds_read_b64 v[184:185], v58 offset:16384
    ds_read_b64 v[186:187], v59 offset:16384
    ds_read_b64 v[188:189], v58 offset:18432
    ds_read_b64 v[190:191], v59 offset:18432
    s_waitcnt lgkmcnt(14)
    v_mfma_f32_16x16x32_bf16 v[232:235], v[0:3], v[160:163], v[232:235]
    v_mfma_f32_16x16x32_bf16 v[240:243], v[160:163], v[160:163], v[240:243]
    s_waitcnt lgkmcnt(12)
    v_mfma_f32_16x16x32_bf16 v[236:239], v[0:3], v[164:167], v[236:239]
    v_mfma_f32_16x16x32_bf16 v[244:247], v[164:167], v[164:167], v[244:247]
    s_waitcnt lgkmcnt(10)
    v_mfma_f32_16x16x32_bf16 v[232:235], v[0:3], v[168:171], v[232:235]
    v_mfma_f32_16x16x32_bf16 v[240:243], v[168:171], v[168:171], v[240:243]
    s_waitcnt lgkmcnt(8)
    v_mfma_f32_16x16x32_bf16 v[236:239], v[0:3], v[172:175], v[236:239]
    v_mfma_f32_16x16x32_bf16 v[244:247], v[172:175], v[172:175], v[244:247]
    s_waitcnt vmcnt(8)
    ds_read_b64 v[192:193], v56 offset:32768
    ds_read_b64 v[194:195], v57 offset:32768
    ds_read_b64 v[196:197], v56 offset:34816
    ds_read_b64 v[198:199], v57 offset:34816
    ds_read_b64 v[200:201], v58 offset:32768
    ds_read_b64 v[202:203], v59 offset:32768
    ds_read_b64 v[204:205], v58 offset:34816
    ds_read_b64 v[206:207], v59 offset:34816
    s_waitcnt lgkmcnt(14)
    v_mfma_f32_16x16x32_bf16 v[232:235], v[0:3], v[176:179], v[232:235]
    v_mfma_f32_16x16x32_bf16 v[240:243], v[176:179], v[176:179], v[240:243]
    s_waitcnt lgkmcnt(12)
    v_mfma_f32_16x16x32_bf16 v[236:239], v[0:3], v[180:183], v[236:239]
    v_mfma_f32_16x16x32_bf16 v[244:247], v[180:183], v[180:183], v[244:247]
    s_waitcnt lgkmcnt(10)
    v_mfma_f32_16x16x32_bf16 v[232:235], v[0:3], v[184:187], v[232:235]
    v_mfma_f32_16x16x32_bf16 v[240:243], v[184:187], v[184:187], v[240:243]
    s_waitcnt lgkmcnt(8)
    v_mfma_f32_16x16x32_bf16 v[236:239], v[0:3], v[188:191], v[236:239]
    v_mfma_f32_16x16x32_bf16 v[244:247], v[188:191], v[188:191], v[244:247]
    s_mul_i32 s66, s66, 663552
    s_mul_i32 s67, s67, 663552
    s_mul_i32 s68, s68, 663552
    s_waitcnt lgkmcnt(0)
    s_barrier
    v_mfma_f32_16x16x32_bf16 v[232:235], v[0:3], v[192:195], v[232:235]
    v_mfma_f32_16x16x32_bf16 v[240:243], v[192:195], v[192:195], v[240:243]
    v_mfma_f32_16x16x32_bf16 v[236:239], v[0:3], v[196:199], v[236:239]
    v_mfma_f32_16x16x32_bf16 v[244:247], v[196:199], v[196:199], v[244:247]
    v_mfma_f32_16x16x32_bf16 v[232:235], v[0:3], v[200:203], v[232:235]
    v_mfma_f32_16x16x32_bf16 v[240:243], v[200:203], v[200:203], v[240:243]
    v_mfma_f32_16x16x32_bf16 v[236:239], v[0:3], v[204:207], v[236:239]
    v_mfma_f32_16x16x32_bf16 v[244:247], v[204:207], v[204:207], v[244:247]
    s_nop 4
    v_mul_f32 v232, 0x3ae38e39, v232
    v_cvt_pk_bf16_f32 v28, v232, v232
    v_lshlrev_b32 v28, 16, v28
    v_xor_b32 v28, 0x80000000, v28
    v_mov_b32 v29, v28
    v_mov_b32 v30, v28
    v_mov_b32 v31, v28
    v_mul_f32 v236, 0x3ae38e39, v236
    v_cvt_pk_bf16_f32 v32, v236, v236
    v_lshlrev_b32 v32, 16, v32
    v_xor_b32 v32, 0x80000000, v32
    v_mov_b32 v33, v32
    v_mov_b32 v34, v32
    v_mov_b32 v35, v32
L_code0:
    v_mfma_f32_4x4x4_16b_bf16 v[36:39], v[4:5], v[64:65], v[28:31]
    v_mfma_f32_4x4x4_16b_bf16 v[40:43], v[4:5], v[66:67], v[28:31]
    v_mfma_f32_4x4x4_16b_bf16 v[44:47], v[4:5], v[68:69], v[32:35]
    v_mfma_f32_4x4x4_16b_bf16 v[48:51], v[4:5], v[70:71], v[32:35]
    s_add_u32 m0, s39, 24576
    v_mfma_f32_4x4x4_16b_bf16 v[52:55], v[4:5], v[72:73], v[28:31]
    s_nop 2
    v_cvt_pk_bf16_f32 v64, v36, v37
    v_cvt_pk_bf16_f32 v65, v38, v39
    v_mfma_f32_4x4x4_16b_bf16 v[56:59], v[4:5], v[74:75], v[28:31]
    v_cvt_pk_bf16_f32 v66, v40, v41
    v_cvt_pk_bf16_f32 v67, v42, v43
    v_mfma_f32_4x4x4_16b_bf16 v[36:39], v[4:5], v[76:77], v[32:35]
    v_cvt_pk_bf16_f32 v68, v44, v45
    v_cvt_pk_bf16_f32 v69, v46, v47
    v_mfma_f32_4x4x4_16b_bf16 v[40:43], v[4:5], v[78:79], v[32:35]
    v_cvt_pk_bf16_f32 v70, v48, v49
    v_cvt_pk_bf16_f32 v71, v50, v51
    v_mfma_f32_4x4x4_16b_bf16 v[44:47], v[4:5], v[80:81], v[28:31]
    v_cvt_pk_bf16_f32 v72, v52, v53
    v_cvt_pk_bf16_f32 v73, v54, v55
    v_mfma_f32_4x4x4_16b_bf16 v[48:51], v[4:5], v[82:83], v[28:31]
    v_cvt_pk_bf16_f32 v74, v56, v57
    v_cvt_pk_bf16_f32 v75, v58, v59
    v_mfma_f32_4x4x4_16b_bf16 v[52:55], v[4:5], v[84:85], v[32:35]
    v_cvt_pk_bf16_f32 v76, v36, v37
    v_cvt_pk_bf16_f32 v77, v38, v39
    v_mfma_f32_4x4x4_16b_bf16 v[56:59], v[4:5], v[86:87], v[32:35]
    v_cvt_pk_bf16_f32 v78, v40, v41
    v_cvt_pk_bf16_f32 v79, v42, v43
    buffer_load_dwordx4 v224, s[16:19], s51 offen offset:0  lds
    v_mfma_f32_4x4x4_16b_bf16 v[36:39], v[4:5], v[88:89], v[28:31]
    v_cvt_pk_bf16_f32 v80, v44, v45
    v_cvt_pk_bf16_f32 v81, v46, v47
    v_mfma_f32_4x4x4_16b_bf16 v[40:43], v[4:5], v[90:91], v[28:31]
    v_cvt_pk_bf16_f32 v82, v48, v49
    v_cvt_pk_bf16_f32 v83, v50, v51
    v_mfma_f32_4x4x4_16b_bf16 v[44:47], v[4:5], v[92:93], v[32:35]
    v_cvt_pk_bf16_f32 v84, v52, v53
    v_cvt_pk_bf16_f32 v85, v54, v55
    v_mfma_f32_4x4x4_16b_bf16 v[48:51], v[4:5], v[94:95], v[32:35]
    v_cvt_pk_bf16_f32 v86, v56, v57
    v_cvt_pk_bf16_f32 v87, v58, v59
    v_mfma_f32_4x4x4_16b_bf16 v[52:55], v[4:5], v[96:97], v[28:31]
    v_cvt_pk_bf16_f32 v88, v36, v37
    v_cvt_pk_bf16_f32 v89, v38, v39
    v_mfma_f32_4x4x4_16b_bf16 v[56:59], v[4:5], v[98:99], v[28:31]
    v_cvt_pk_bf16_f32 v90, v40, v41
    v_cvt_pk_bf16_f32 v91, v42, v43
    v_mfma_f32_4x4x4_16b_bf16 v[36:39], v[4:5], v[100:101], v[32:35]
    v_cvt_pk_bf16_f32 v92, v44, v45
    v_cvt_pk_bf16_f32 v93, v46, v47
    v_mfma_f32_4x4x4_16b_bf16 v[40:43], v[4:5], v[102:103], v[32:35]
    v_cvt_pk_bf16_f32 v94, v48, v49
    v_cvt_pk_bf16_f32 v95, v50, v51
    buffer_load_dwordx4 v225, s[20:23], s51 offen offset:1024  lds
    v_mfma_f32_4x4x4_16b_bf16 v[44:47], v[4:5], v[104:105], v[28:31]
    v_cvt_pk_bf16_f32 v96, v52, v53
    v_cvt_pk_bf16_f32 v97, v54, v55
    v_mfma_f32_4x4x4_16b_bf16 v[48:51], v[4:5], v[106:107], v[28:31]
    v_cvt_pk_bf16_f32 v98, v56, v57
    v_cvt_pk_bf16_f32 v99, v58, v59
    v_mfma_f32_4x4x4_16b_bf16 v[52:55], v[4:5], v[108:109], v[32:35]
    v_cvt_pk_bf16_f32 v100, v36, v37
    v_cvt_pk_bf16_f32 v101, v38, v39
    v_mfma_f32_4x4x4_16b_bf16 v[56:59], v[4:5], v[110:111], v[32:35]
    v_cvt_pk_bf16_f32 v102, v40, v41
    v_cvt_pk_bf16_f32 v103, v42, v43
    v_mfma_f32_4x4x4_16b_bf16 v[36:39], v[4:5], v[112:113], v[28:31]
    v_cvt_pk_bf16_f32 v104, v44, v45
    v_cvt_pk_bf16_f32 v105, v46, v47
    v_mfma_f32_4x4x4_16b_bf16 v[40:43], v[4:5], v[114:115], v[28:31]
    v_cvt_pk_bf16_f32 v106, v48, v49
    v_cvt_pk_bf16_f32 v107, v50, v51
    v_mfma_f32_4x4x4_16b_bf16 v[44:47], v[4:5], v[116:117], v[32:35]
    v_cvt_pk_bf16_f32 v108, v52, v53
    v_cvt_pk_bf16_f32 v109, v54, v55
    v_mfma_f32_4x4x4_16b_bf16 v[48:51], v[4:5], v[118:119], v[32:35]
    v_cvt_pk_bf16_f32 v110, v56, v57
    v_cvt_pk_bf16_f32 v111, v58, v59
    buffer_load_dwordx4 v226, s[16:19], s52 offen offset:2048  lds
    v_mfma_f32_4x4x4_16b_bf16 v[52:55], v[4:5], v[120:121], v[28:31]
    v_cvt_pk_bf16_f32 v112, v36, v37
    v_cvt_pk_bf16_f32 v113, v38, v39
    v_mfma_f32_4x4x4_16b_bf16 v[56:59], v[4:5], v[122:123], v[28:31]
    v_cvt_pk_bf16_f32 v114, v40, v41
    v_cvt_pk_bf16_f32 v115, v42, v43
    v_mfma_f32_4x4x4_16b_bf16 v[36:39], v[4:5], v[124:125], v[32:35]
    v_cvt_pk_bf16_f32 v116, v44, v45
    v_cvt_pk_bf16_f32 v117, v46, v47
    v_mfma_f32_4x4x4_16b_bf16 v[40:43], v[4:5], v[126:127], v[32:35]
    v_cvt_pk_bf16_f32 v118, v48, v49
    v_cvt_pk_bf16_f32 v119, v50, v51
    v_mfma_f32_4x4x4_16b_bf16 v[44:47], v[4:5], v[128:129], v[28:31]
    v_cvt_pk_bf16_f32 v120, v52, v53
    v_cvt_pk_bf16_f32 v121, v54, v55
    v_mfma_f32_4x4x4_16b_bf16 v[48:51], v[4:5], v[130:131], v[28:31]
    v_cvt_pk_bf16_f32 v122, v56, v57
    v_cvt_pk_bf16_f32 v123, v58, v59
    v_mfma_f32_4x4x4_16b_bf16 v[52:55], v[4:5], v[132:133], v[32:35]
    v_cvt_pk_bf16_f32 v124, v36, v37
    v_cvt_pk_bf16_f32 v125, v38, v39
    v_mfma_f32_4x4x4_16b_bf16 v[56:59], v[4:5], v[134:135], v[32:35]
    v_cvt_pk_bf16_f32 v126, v40, v41
    v_cvt_pk_bf16_f32 v127, v42, v43
    buffer_load_dwordx4 v227, s[20:23], s52 offen offset:3072  lds
    v_mfma_f32_4x4x4_16b_bf16 v[36:39], v[4:5], v[136:137], v[28:31]
    v_cvt_pk_bf16_f32 v128, v44, v45
    v_cvt_pk_bf16_f32 v129, v46, v47
    v_mfma_f32_4x4x4_16b_bf16 v[40:43], v[4:5], v[138:139], v[28:31]
    v_cvt_pk_bf16_f32 v130, v48, v49
    v_cvt_pk_bf16_f32 v131, v50, v51
    v_mfma_f32_4x4x4_16b_bf16 v[44:47], v[4:5], v[140:141], v[32:35]
    v_cvt_pk_bf16_f32 v132, v52, v53
    v_cvt_pk_bf16_f32 v133, v54, v55
    v_mfma_f32_4x4x4_16b_bf16 v[48:51], v[4:5], v[142:143], v[32:35]
    v_cvt_pk_bf16_f32 v134, v56, v57
    v_cvt_pk_bf16_f32 v135, v58, v59
    v_mfma_f32_4x4x4_16b_bf16 v[52:55], v[4:5], v[144:145], v[28:31]
    v_cvt_pk_bf16_f32 v136, v36, v37
    v_cvt_pk_bf16_f32 v137, v38, v39
    v_mfma_f32_4x4x4_16b_bf16 v[56:59], v[4:5], v[146:147], v[28:31]
    v_cvt_pk_bf16_f32 v138, v40, v41
    v_cvt_pk_bf16_f32 v139, v42, v43
    v_mfma_f32_4x4x4_16b_bf16 v[36:39], v[4:5], v[148:149], v[32:35]
    v_cvt_pk_bf16_f32 v140, v44, v45
    v_cvt_pk_bf16_f32 v141, v46, v47
    v_mfma_f32_4x4x4_16b_bf16 v[40:43], v[4:5], v[150:151], v[32:35]
    v_cvt_pk_bf16_f32 v142, v48, v49
    v_cvt_pk_bf16_f32 v143, v50, v51
    s_add_u32 m0, s39, 28672
    v_mfma_f32_4x4x4_16b_bf16 v[44:47], v[4:5], v[152:153], v[28:31]
    v_cvt_pk_bf16_f32 v144, v52, v53
    v_cvt_pk_bf16_f32 v145, v54, v55
    v_mfma_f32_4x4x4_16b_bf16 v[48:51], v[4:5], v[154:155], v[28:31]
    v_cvt_pk_bf16_f32 v146, v56, v57
    v_cvt_pk_bf16_f32 v147, v58, v59
    v_mfma_f32_4x4x4_16b_bf16 v[52:55], v[4:5], v[156:157], v[32:35]
    v_cvt_pk_bf16_f32 v148, v36, v37
    v_cvt_pk_bf16_f32 v149, v38, v39
    v_mfma_f32_4x4x4_16b_bf16 v[56:59], v[4:5], v[158:159], v[32:35]
    v_cvt_pk_bf16_f32 v150, v40, v41
    v_cvt_pk_bf16_f32 v151, v42, v43
    v_mfma_f32_4x4x4_16b_bf16 v[36:39], v[4:5], v[160:161], v[28:31]
    v_cvt_pk_bf16_f32 v152, v44, v45
    v_cvt_pk_bf16_f32 v153, v46, v47
    v_mfma_f32_4x4x4_16b_bf16 v[40:43], v[4:5], v[162:163], v[28:31]
    v_cvt_pk_bf16_f32 v154, v48, v49
    v_cvt_pk_bf16_f32 v155, v50, v51
    v_mfma_f32_4x4x4_16b_bf16 v[44:47], v[4:5], v[164:165], v[32:35]
    v_cvt_pk_bf16_f32 v156, v52, v53
    v_cvt_pk_bf16_f32 v157, v54, v55
    v_mfma_f32_4x4x4_16b_bf16 v[48:51], v[4:5], v[166:167], v[32:35]
    v_cvt_pk_bf16_f32 v158, v56, v57
    v_cvt_pk_bf16_f32 v159, v58, v59
    buffer_load_dwordx4 v224, s[16:19], s53 offen offset:0  lds
    v_mfma_f32_4x4x4_16b_bf16 v[52:55], v[4:5], v[168:169], v[28:31]
    v_cvt_pk_bf16_f32 v160, v36, v37
    v_cvt_pk_bf16_f32 v161, v38, v39
    v_mfma_f32_4x4x4_16b_bf16 v[56:59], v[4:5], v[170:171], v[28:31]
    v_cvt_pk_bf16_f32 v162, v40, v41
    v_cvt_pk_bf16_f32 v163, v42, v43
    v_mfma_f32_4x4x4_16b_bf16 v[36:39], v[4:5], v[172:173], v[32:35]
    v_cvt_pk_bf16_f32 v164, v44, v45
    v_cvt_pk_bf16_f32 v165, v46, v47
    v_mfma_f32_4x4x4_16b_bf16 v[40:43], v[4:5], v[174:175], v[32:35]
    v_cvt_pk_bf16_f32 v166, v48, v49
    v_cvt_pk_bf16_f32 v167, v50, v51
    v_mfma_f32_4x4x4_16b_bf16 v[44:47], v[4:5], v[176:177], v[28:31]
    v_cvt_pk_bf16_f32 v168, v52, v53
    v_cvt_pk_bf16_f32 v169, v54, v55
    v_mfma_f32_4x4x4_16b_bf16 v[48:51], v[4:5], v[178:179], v[28:31]
    v_cvt_pk_bf16_f32 v170, v56, v57
    v_cvt_pk_bf16_f32 v171, v58, v59
    v_mfma_f32_4x4x4_16b_bf16 v[52:55], v[4:5], v[180:181], v[32:35]
    v_cvt_pk_bf16_f32 v172, v36, v37
    v_cvt_pk_bf16_f32 v173, v38, v39
    v_mfma_f32_4x4x4_16b_bf16 v[56:59], v[4:5], v[182:183], v[32:35]
    v_cvt_pk_bf16_f32 v174, v40, v41
    v_cvt_pk_bf16_f32 v175, v42, v43
    buffer_load_dwordx4 v225, s[20:23], s53 offen offset:1024  lds
    v_mfma_f32_4x4x4_16b_bf16 v[36:39], v[4:5], v[184:185], v[28:31]
    v_cvt_pk_bf16_f32 v176, v44, v45
    v_cvt_pk_bf16_f32 v177, v46, v47
    v_mfma_f32_4x4x4_16b_bf16 v[40:43], v[4:5], v[186:187], v[28:31]
    v_cvt_pk_bf16_f32 v178, v48, v49
    v_cvt_pk_bf16_f32 v179, v50, v51
    v_mfma_f32_4x4x4_16b_bf16 v[44:47], v[4:5], v[188:189], v[32:35]
    v_cvt_pk_bf16_f32 v180, v52, v53
    v_cvt_pk_bf16_f32 v181, v54, v55
    v_mfma_f32_4x4x4_16b_bf16 v[48:51], v[4:5], v[190:191], v[32:35]
    v_cvt_pk_bf16_f32 v182, v56, v57
    v_cvt_pk_bf16_f32 v183, v58, v59
    v_mfma_f32_4x4x4_16b_bf16 v[52:55], v[4:5], v[192:193], v[28:31]
    v_cvt_pk_bf16_f32 v184, v36, v37
    v_cvt_pk_bf16_f32 v185, v38, v39
    v_mfma_f32_4x4x4_16b_bf16 v[56:59], v[4:5], v[194:195], v[28:31]
    v_cvt_pk_bf16_f32 v186, v40, v41
    v_cvt_pk_bf16_f32 v187, v42, v43
    v_mfma_f32_4x4x4_16b_bf16 v[36:39], v[4:5], v[196:197], v[32:35]
    v_cvt_pk_bf16_f32 v188, v44, v45
    v_cvt_pk_bf16_f32 v189, v46, v47
    v_mfma_f32_4x4x4_16b_bf16 v[40:43], v[4:5], v[198:199], v[32:35]
    v_cvt_pk_bf16_f32 v190, v48, v49
    v_cvt_pk_bf16_f32 v191, v50, v51
    v_mfma_f32_4x4x4_16b_bf16 v[44:47], v[4:5], v[200:201], v[28:31]
    v_cvt_pk_bf16_f32 v192, v52, v53
    v_cvt_pk_bf16_f32 v193, v54, v55
    v_mfma_f32_4x4x4_16b_bf16 v[48:51], v[4:5], v[202:203], v[28:31]
    v_cvt_pk_bf16_f32 v194, v56, v57
    v_cvt_pk_bf16_f32 v195, v58, v59
    v_mfma_f32_4x4x4_16b_bf16 v[52:55], v[4:5], v[204:205], v[32:35]
    v_cvt_pk_bf16_f32 v196, v36, v37
    v_cvt_pk_bf16_f32 v197, v38, v39
    v_mfma_f32_4x4x4_16b_bf16 v[56:59], v[4:5], v[206:207], v[32:35]
    v_cvt_pk_bf16_f32 v198, v40, v41
    v_cvt_pk_bf16_f32 v199, v42, v43
    v_cvt_pk_bf16_f32 v200, v44, v45
    v_cvt_pk_bf16_f32 v201, v46, v47
    v_cvt_pk_bf16_f32 v202, v48, v49
    v_cvt_pk_bf16_f32 v203, v50, v51
    v_cvt_pk_bf16_f32 v204, v52, v53
    v_cvt_pk_bf16_f32 v205, v54, v55
    v_cvt_pk_bf16_f32 v206, v56, v57
    v_cvt_pk_bf16_f32 v207, v58, v59
    v_mul_u32_u24 v234, 3456, v248
    v_mul_u32_u24 v233, 9216, v248
    v_mul_u32_u24 v235, 1152, v248
    v_or_b32 v234, v234, v249
    v_or_b32 v233, v233, v249
    v_or_b32 v235, v235, v249
    v_accvgpr_write_b32 a170, v233
    v_accvgpr_write_b32 a171, v235
    s_waitcnt vmcnt(6)
    s_barrier
    ds_read_b64_tr_b16 a[216:217], v212 offset:0
    ds_read_b64_tr_b16 a[218:219], v212 offset:12288
    ds_read_b64_tr_b16 a[220:221], v212 offset:1024
    ds_read_b64_tr_b16 a[222:223], v212 offset:13312
    ds_read_b64_tr_b16 a[224:225], v213 offset:0
    ds_read_b64_tr_b16 a[226:227], v213 offset:12288
    ds_read_b64_tr_b16 a[228:229], v213 offset:1024
    ds_read_b64_tr_b16 a[230:231], v213 offset:13312
    ds_read_b64_tr_b16 a[232:233], v214 offset:0
    ds_read_b64_tr_b16 a[234:235], v214 offset:12288
    ds_read_b64_tr_b16 a[236:237], v214 offset:1024
    ds_read_b64_tr_b16 a[238:239], v214 offset:13312
    ds_read_b64_tr_b16 a[240:241], v215 offset:0
    ds_read_b64_tr_b16 a[242:243], v215 offset:12288
    s_waitcnt lgkmcnt(6)
    v_mfma_f32_16x16x32_bf16 v[0:3], a[216:219], v[64:67], 0
    ds_read_b64_tr_b16 a[244:245], v215 offset:1024
    v_mfma_f32_16x16x32_bf16 v[4:7], a[216:219], v[68:71], 0
    ds_read_b64_tr_b16 a[246:247], v215 offset:13312
    s_add_u32 m0, s39, 49152
    v_mfma_f32_16x16x32_bf16 v[12:15], a[220:223], v[68:71], 0
    ds_read_b64_tr_b16 a[216:217], v212 offset:2048
    buffer_load_dwordx4 v224, s[16:19], s54 offen offset:0  lds
    v_mfma_f32_16x16x32_bf16 v[8:11], a[220:223], v[64:67], 0
    ds_read_b64_tr_b16 a[218:219], v212 offset:14336
    v_mfma_f32_16x16x32_bf16 v[16:19], a[224:227], v[64:67], 0
    ds_read_b64_tr_b16 a[220:221], v212 offset:3072
    v_mfma_f32_16x16x32_bf16 v[20:23], a[224:227], v[68:71], 0
    ds_read_b64_tr_b16 a[222:223], v212 offset:15360
    buffer_load_dwordx4 v225, s[20:23], s54 offen offset:1024  lds
    v_mfma_f32_16x16x32_bf16 v[28:31], a[228:231], v[68:71], 0
    ds_read_b64_tr_b16 a[224:225], v213 offset:2048
    v_mfma_f32_16x16x32_bf16 v[24:27], a[228:231], v[64:67], 0
    ds_read_b64_tr_b16 a[226:227], v213 offset:14336
    s_waitcnt lgkmcnt(6)
    v_mfma_f32_16x16x32_bf16 v[32:35], a[232:235], v[64:67], 0
    ds_read_b64_tr_b16 a[228:229], v213 offset:3072
    buffer_load_dwordx4 v226, s[16:19], s55 offen offset:2048  lds
    v_mfma_f32_16x16x32_bf16 v[36:39], a[232:235], v[68:71], 0
    ds_read_b64_tr_b16 a[230:231], v213 offset:15360
    v_mfma_f32_16x16x32_bf16 v[44:47], a[236:239], v[68:71], 0
    ds_read_b64_tr_b16 a[232:233], v214 offset:2048
    buffer_load_dwordx4 v227, s[20:23], s55 offen offset:3072  lds
    v_mfma_f32_16x16x32_bf16 v[40:43], a[236:239], v[64:67], 0
    ds_read_b64_tr_b16 a[234:235], v214 offset:14336
    v_mfma_f32_16x16x32_bf16 v[48:51], a[240:243], v[64:67], 0
    ds_read_b64_tr_b16 a[236:237], v214 offset:3072
    s_add_u32 m0, s39, 53248
    v_mfma_f32_16x16x32_bf16 v[52:55], a[240:243], v[68:71], 0
    ds_read_b64_tr_b16 a[238:239], v214 offset:15360
    buffer_load_dwordx4 v224, s[16:19], s56 offen offset:0  lds
    v_mfma_f32_16x16x32_bf16 v[60:63], a[244:247], v[68:71], 0
    ds_read_b64_tr_b16 a[240:241], v215 offset:2048
    v_mfma_f32_16x16x32_bf16 v[56:59], a[244:247], v[64:67], 0
    ds_read_b64_tr_b16 a[242:243], v215 offset:14336
    s_waitcnt lgkmcnt(6)
    v_mfma_f32_16x16x32_bf16 v[0:3], a[216:219], v[72:75], v[0:3]
    ds_read_b64_tr_b16 a[244:245], v215 offset:3072
    buffer_load_dwordx4 v225, s[20:23], s56 offen offset:1024  lds
    v_mfma_f32_16x16x32_bf16 v[4:7], a[216:219], v[76:79], v[4:7]
    ds_read_b64_tr_b16 a[246:247], v215 offset:15360
    v_mfma_f32_16x16x32_bf16 v[12:15], a[220:223], v[76:79], v[12:15]
    ds_read_b64_tr_b16 a[216:217], v212 offset:4096
    s_add_u32 m0, s39, 73728
    v_mfma_f32_16x16x32_bf16 v[8:11], a[220:223], v[72:75], v[8:11]
    ds_read_b64_tr_b16 a[218:219], v212 offset:16384
    buffer_load_dwordx4 v224, s[16:19], s57 offen offset:0  lds
    v_mfma_f32_16x16x32_bf16 v[16:19], a[224:227], v[72:75], v[16:19]
    ds_read_b64_tr_b16 a[220:221], v212 offset:5120
    v_mfma_f32_16x16x32_bf16 v[20:23], a[224:227], v[76:79], v[20:23]
    ds_read_b64_tr_b16 a[222:223], v212 offset:17408
    v_mfma_f32_16x16x32_bf16 v[28:31], a[228:231], v[76:79], v[28:31]
    ds_read_b64_tr_b16 a[224:225], v213 offset:4096
    buffer_load_dwordx4 v225, s[20:23], s57 offen offset:1024  lds
    v_mfma_f32_16x16x32_bf16 v[24:27], a[228:231], v[72:75], v[24:27]
    ds_read_b64_tr_b16 a[226:227], v213 offset:16384
    s_waitcnt lgkmcnt(6)
    v_mfma_f32_16x16x32_bf16 v[32:35], a[232:235], v[72:75], v[32:35]
    ds_read_b64_tr_b16 a[228:229], v213 offset:5120
    v_mfma_f32_16x16x32_bf16 v[36:39], a[232:235], v[76:79], v[36:39]
    ds_read_b64_tr_b16 a[230:231], v213 offset:17408
    buffer_load_dwordx4 v226, s[16:19], s58 offen offset:2048  lds
    v_mfma_f32_16x16x32_bf16 v[44:47], a[236:239], v[76:79], v[44:47]
    ds_read_b64_tr_b16 a[232:233], v214 offset:4096
    v_mfma_f32_16x16x32_bf16 v[40:43], a[236:239], v[72:75], v[40:43]
    ds_read_b64_tr_b16 a[234:235], v214 offset:16384
    buffer_load_dwordx4 v227, s[20:23], s58 offen offset:3072  lds
    v_mfma_f32_16x16x32_bf16 v[48:51], a[240:243], v[72:75], v[48:51]
    ds_read_b64_tr_b16 a[236:237], v214 offset:5120
    v_mfma_f32_16x16x32_bf16 v[52:55], a[240:243], v[76:79], v[52:55]
    ds_read_b64_tr_b16 a[238:239], v214 offset:17408
    s_add_u32 m0, s39, 77824
    v_mfma_f32_16x16x32_bf16 v[60:63], a[244:247], v[76:79], v[60:63]
    ds_read_b64_tr_b16 a[240:241], v215 offset:4096
    buffer_load_dwordx4 v224, s[16:19], s59 offen offset:0  lds
    v_mfma_f32_16x16x32_bf16 v[56:59], a[244:247], v[72:75], v[56:59]
    ds_read_b64_tr_b16 a[242:243], v215 offset:16384
    s_waitcnt lgkmcnt(6)
    v_mfma_f32_16x16x32_bf16 v[0:3], a[216:219], v[80:83], v[0:3]
    ds_read_b64_tr_b16 a[244:245], v215 offset:5120
    v_mfma_f32_16x16x32_bf16 v[4:7], a[216:219], v[84:87], v[4:7]
    ds_read_b64_tr_b16 a[246:247], v215 offset:17408
    buffer_load_dwordx4 v225, s[20:23], s59 offen offset:1024  lds
    v_mfma_f32_16x16x32_bf16 v[12:15], a[220:223], v[84:87], v[12:15]
    s_waitcnt vmcnt(12)
    s_barrier
    ds_read_b64_tr_b16 a[216:217], v212 offset:24576
    v_mfma_f32_16x16x32_bf16 v[8:11], a[220:223], v[80:83], v[8:11]
    ds_read_b64_tr_b16 a[218:219], v212 offset:36864
    v_mfma_f32_16x16x32_bf16 v[16:19], a[224:227], v[80:83], v[16:19]
    ds_read_b64_tr_b16 a[220:221], v212 offset:25600
    s_add_u32 m0, s39, 98304
    v_mfma_f32_16x16x32_bf16 v[20:23], a[224:227], v[84:87], v[20:23]
    ds_read_b64_tr_b16 a[222:223], v212 offset:37888
    v_mfma_f32_16x16x32_bf16 v[28:31], a[228:231], v[84:87], v[28:31]
    ds_read_b64_tr_b16 a[224:225], v213 offset:24576
    buffer_load_dwordx4 v224, s[16:19], s60 offen offset:0  lds
    v_mfma_f32_16x16x32_bf16 v[24:27], a[228:231], v[80:83], v[24:27]
    ds_read_b64_tr_b16 a[226:227], v213 offset:36864
    s_waitcnt lgkmcnt(6)
    v_mfma_f32_16x16x32_bf16 v[32:35], a[232:235], v[80:83], v[32:35]
    ds_read_b64_tr_b16 a[228:229], v213 offset:25600
    v_mfma_f32_16x16x32_bf16 v[36:39], a[232:235], v[84:87], v[36:39]
    ds_read_b64_tr_b16 a[230:231], v213 offset:37888
    v_mfma_f32_16x16x32_bf16 v[44:47], a[236:239], v[84:87], v[44:47]
    ds_read_b64_tr_b16 a[232:233], v214 offset:24576
    buffer_load_dwordx4 v225, s[20:23], s60 offen offset:1024  lds
    v_mfma_f32_16x16x32_bf16 v[40:43], a[236:239], v[80:83], v[40:43]
    ds_read_b64_tr_b16 a[234:235], v214 offset:36864
    v_mfma_f32_16x16x32_bf16 v[48:51], a[240:243], v[80:83], v[48:51]
    ds_read_b64_tr_b16 a[236:237], v214 offset:25600
    v_mfma_f32_16x16x32_bf16 v[52:55], a[240:243], v[84:87], v[52:55]
    ds_read_b64_tr_b16 a[238:239], v214 offset:37888
    v_mfma_f32_16x16x32_bf16 v[60:63], a[244:247], v[84:87], v[60:63]
    ds_read_b64_tr_b16 a[240:241], v215 offset:24576
    buffer_load_dwordx4 v226, s[16:19], s61 offen offset:2048  lds
    v_mfma_f32_16x16x32_bf16 v[56:59], a[244:247], v[80:83], v[56:59]
    ds_read_b64_tr_b16 a[242:243], v215 offset:36864
    s_waitcnt lgkmcnt(6)
    v_mfma_f32_16x16x32_bf16 v[0:3], a[216:219], v[88:91], v[0:3]
    ds_read_b64_tr_b16 a[244:245], v215 offset:25600
    v_mfma_f32_16x16x32_bf16 v[4:7], a[216:219], v[92:95], v[4:7]
    ds_read_b64_tr_b16 a[246:247], v215 offset:37888
    v_mfma_f32_16x16x32_bf16 v[12:15], a[220:223], v[92:95], v[12:15]
    ds_read_b64_tr_b16 a[216:217], v212 offset:26624
    buffer_load_dwordx4 v227, s[20:23], s61 offen offset:3072  lds
    v_mfma_f32_16x16x32_bf16 v[8:11], a[220:223], v[88:91], v[8:11]
    ds_read_b64_tr_b16 a[218:219], v212 offset:38912
    v_mfma_f32_16x16x32_bf16 v[16:19], a[224:227], v[88:91], v[16:19]
    ds_read_b64_tr_b16 a[220:221], v212 offset:27648
    s_add_u32 m0, s39, 102400
    v_mfma_f32_16x16x32_bf16 v[20:23], a[224:227], v[92:95], v[20:23]
    ds_read_b64_tr_b16 a[222:223], v212 offset:39936
    buffer_load_dwordx4 v224, s[16:19], s62 offen offset:0  lds
    v_mfma_f32_16x16x32_bf16 v[28:31], a[228:231], v[92:95], v[28:31]
    ds_read_b64_tr_b16 a[224:225], v213 offset:26624
    v_mfma_f32_16x16x32_bf16 v[24:27], a[228:231], v[88:91], v[24:27]
    ds_read_b64_tr_b16 a[226:227], v213 offset:38912
    s_waitcnt lgkmcnt(6)
    v_mfma_f32_16x16x32_bf16 v[32:35], a[232:235], v[88:91], v[32:35]
    ds_read_b64_tr_b16 a[228:229], v213 offset:27648
    v_mfma_f32_16x16x32_bf16 v[36:39], a[232:235], v[92:95], v[36:39]
    ds_read_b64_tr_b16 a[230:231], v213 offset:39936
    buffer_load_dwordx4 v225, s[20:23], s62 offen offset:1024  lds
    v_mfma_f32_16x16x32_bf16 v[44:47], a[236:239], v[92:95], v[44:47]
    ds_read_b64_tr_b16 a[232:233], v214 offset:26624
    v_mfma_f32_16x16x32_bf16 v[40:43], a[236:239], v[88:91], v[40:43]
    ds_read_b64_tr_b16 a[234:235], v214 offset:38912
    s_add_u32 m0, s39, 122880
    v_mfma_f32_16x16x32_bf16 v[48:51], a[240:243], v[88:91], v[48:51]
    ds_read_b64_tr_b16 a[236:237], v214 offset:27648
    v_mfma_f32_16x16x32_bf16 v[52:55], a[240:243], v[92:95], v[52:55]
    ds_read_b64_tr_b16 a[238:239], v214 offset:39936
    buffer_load_dwordx4 v224, s[16:19], s63 offen offset:0  lds
    v_mfma_f32_16x16x32_bf16 v[60:63], a[244:247], v[92:95], v[60:63]
    ds_read_b64_tr_b16 a[240:241], v215 offset:26624
    buffer_load_dword a215, v234, s[8:11], s77 offen offset:0
    v_mfma_f32_16x16x32_bf16 v[56:59], a[244:247], v[88:91], v[56:59]
    ds_read_b64_tr_b16 a[242:243], v215 offset:38912
    buffer_load_dword a215, v234, s[8:11], s77 offen offset:76
    s_waitcnt lgkmcnt(6)
    v_mfma_f32_16x16x32_bf16 v[0:3], a[216:219], v[96:99], v[0:3]
    ds_read_b64_tr_b16 a[244:245], v215 offset:27648
    buffer_load_dword a215, v234, s[8:11], s77 offen offset:1152
    v_mfma_f32_16x16x32_bf16 v[4:7], a[216:219], v[100:103], v[4:7]
    ds_read_b64_tr_b16 a[246:247], v215 offset:39936
    buffer_load_dwordx4 v225, s[20:23], s63 offen offset:1024  lds
    v_mfma_f32_16x16x32_bf16 v[12:15], a[220:223], v[100:103], v[12:15]
    ds_read_b64_tr_b16 a[216:217], v212 offset:28672
    buffer_load_dword a215, v234, s[8:11], s77 offen offset:1228
    v_mfma_f32_16x16x32_bf16 v[8:11], a[220:223], v[96:99], v[8:11]
    ds_read_b64_tr_b16 a[218:219], v212 offset:40960
    buffer_load_dword a215, v234, s[8:11], s77 offen offset:2304
    buffer_load_dword a215, v234, s[8:11], s77 offen offset:2380
    v_mfma_f32_16x16x32_bf16 v[16:19], a[224:227], v[96:99], v[16:19]
    ds_read_b64_tr_b16 a[220:221], v212 offset:29696
    v_mfma_f32_16x16x32_bf16 v[20:23], a[224:227], v[100:103], v[20:23]
    ds_read_b64_tr_b16 a[222:223], v212 offset:41984
    buffer_load_dwordx4 v226, s[16:19], s64 offen offset:2048  lds
    v_mfma_f32_16x16x32_bf16 v[28:31], a[228:231], v[100:103], v[28:31]
    ds_read_b64_tr_b16 a[224:225], v213 offset:28672
    v_mfma_f32_16x16x32_bf16 v[24:27], a[228:231], v[96:99], v[24:27]
    ds_read_b64_tr_b16 a[226:227], v213 offset:40960
    s_waitcnt lgkmcnt(6)
    v_mfma_f32_16x16x32_bf16 v[32:35], a[232:235], v[96:99], v[32:35]
    ds_read_b64_tr_b16 a[228:229], v213 offset:29696
    v_mfma_f32_16x16x32_bf16 v[36:39], a[232:235], v[100:103], v[36:39]
    ds_read_b64_tr_b16 a[230:231], v213 offset:41984
    buffer_load_dwordx4 v227, s[20:23], s64 offen offset:3072  lds
    v_mfma_f32_16x16x32_bf16 v[44:47], a[236:239], v[100:103], v[44:47]
    ds_read_b64_tr_b16 a[232:233], v214 offset:28672
    v_mfma_f32_16x16x32_bf16 v[40:43], a[236:239], v[96:99], v[40:43]
    ds_read_b64_tr_b16 a[234:235], v214 offset:40960
    s_add_u32 m0, s39, 126976
    v_mfma_f32_16x16x32_bf16 v[48:51], a[240:243], v[96:99], v[48:51]
    ds_read_b64_tr_b16 a[236:237], v214 offset:29696
    v_mfma_f32_16x16x32_bf16 v[52:55], a[240:243], v[100:103], v[52:55]
    ds_read_b64_tr_b16 a[238:239], v214 offset:41984
    buffer_load_dwordx4 v224, s[16:19], s65 offen offset:0  lds
    v_mfma_f32_16x16x32_bf16 v[60:63], a[244:247], v[100:103], v[60:63]
    ds_read_b64_tr_b16 a[240:241], v215 offset:28672
    v_mfma_f32_16x16x32_bf16 v[56:59], a[244:247], v[96:99], v[56:59]
    ds_read_b64_tr_b16 a[242:243], v215 offset:40960
    s_waitcnt lgkmcnt(6)
    v_mfma_f32_16x16x32_bf16 v[0:3], a[216:219], v[104:107], v[0:3]
    ds_read_b64_tr_b16 a[244:245], v215 offset:29696
    v_mfma_f32_16x16x32_bf16 v[4:7], a[216:219], v[108:111], v[4:7]
    ds_read_b64_tr_b16 a[246:247], v215 offset:41984
    buffer_load_dwordx4 v225, s[20:23], s65 offen offset:1024  lds
    v_mfma_f32_16x16x32_bf16 v[12:15], a[220:223], v[108:111], v[12:15]
    s_waitcnt vmcnt(24)
    s_barrier
    v_add_u32 v212, 0xc000, v212
    ds_read_b64_tr_b16 a[216:217], v212 offset:0
    v_and_b32 v248, 3, v209
    v_mfma_f32_16x16x32_bf16 v[8:11], a[220:223], v[104:107], v[8:11]
    ds_read_b64_tr_b16 a[218:219], v212 offset:12288
    v_and_b32 v249, 15, v209
    v_cmp_eq_u32 s[0:1], 1, v248
    v_mfma_f32_16x16x32_bf16 v[16:19], a[224:227], v[104:107], v[16:19]
    ds_read_b64_tr_b16 a[220:221], v212 offset:1024
    s_add_u32 m0, s39, 0
    v_mfma_f32_16x16x32_bf16 v[20:23], a[224:227], v[108:111], v[20:23]
    ds_read_b64_tr_b16 a[222:223], v212 offset:13312
    v_cmp_eq_u32 s[2:3], 2, v248
    v_mfma_f32_16x16x32_bf16 v[28:31], a[228:231], v[108:111], v[28:31]
    v_add_u32 v213, 0xc000, v213
    ds_read_b64_tr_b16 a[224:225], v213 offset:0
    v_lshrrev_b32 v250, 2, v249
    v_lshl_add_u32 v250, v250, 4, v249
    v_mfma_f32_16x16x32_bf16 v[24:27], a[228:231], v[104:107], v[24:27]
    ds_read_b64_tr_b16 a[226:227], v213 offset:12288
    s_add_u32 s69, s66, 0
    v_lshlrev_b32 v250, 2, v250
    s_waitcnt lgkmcnt(6)
    v_mfma_f32_16x16x32_bf16 v[32:35], a[232:235], v[104:107], v[32:35]
    ds_read_b64_tr_b16 a[228:229], v213 offset:1024
    v_cndmask_b32 v240, v240, v241, s[0:1]
    v_cndmask_b32 v240, v240, v242, s[2:3]
    v_mfma_f32_16x16x32_bf16 v[36:39], a[232:235], v[108:111], v[36:39]
    ds_read_b64_tr_b16 a[230:231], v213 offset:13312
    buffer_load_dwordx4 v228, s[8:11], s69 offen offset:0  lds
    v_cndmask_b32 v244, v244, v245, s[0:1]
    v_mfma_f32_16x16x32_bf16 v[44:47], a[236:239], v[108:111], v[44:47]
    v_add_u32 v214, 0xc000, v214
    ds_read_b64_tr_b16 a[232:233], v214 offset:0
    v_cndmask_b32 v244, v244, v246, s[2:3]
    v_mfma_f32_16x16x32_bf16 v[40:43], a[236:239], v[104:107], v[40:43]
    ds_read_b64_tr_b16 a[234:235], v214 offset:12288
    v_cmp_eq_u32 s[0:1], 3, v248
    v_mfma_f32_16x16x32_bf16 v[48:51], a[240:243], v[104:107], v[48:51]
    ds_read_b64_tr_b16 a[236:237], v214 offset:1024
    s_lshl_b32 s42, s36, 7
    s_add_u32 s42, s42, 162048
    v_lshl_add_u32 v249, v249, 2, s42
    v_mfma_f32_16x16x32_bf16 v[52:55], a[240:243], v[108:111], v[52:55]
    ds_read_b64_tr_b16 a[238:239], v214 offset:13312
    s_add_u32 s69, s66, 55296
    v_cndmask_b32 v240, v240, v243, s[0:1]
    v_mfma_f32_16x16x32_bf16 v[60:63], a[244:247], v[108:111], v[60:63]
    v_add_u32 v215, 0xc000, v215
    ds_read_b64_tr_b16 a[240:241], v215 offset:0
    ds_bpermute_b32 v241, v250, v240
    v_mfma_f32_16x16x32_bf16 v[56:59], a[244:247], v[104:107], v[56:59]
    ds_read_b64_tr_b16 a[242:243], v215 offset:12288
    v_cndmask_b32 v244, v244, v247, s[0:1]
    s_waitcnt lgkmcnt(7)
    v_mfma_f32_16x16x32_bf16 v[0:3], a[216:219], v[112:115], v[0:3]
    ds_read_b64_tr_b16 a[244:245], v215 offset:1024
    ds_bpermute_b32 v245, v250, v244
    v_mul_f32 v232, v232, v232
    v_mfma_f32_16x16x32_bf16 v[4:7], a[216:219], v[116:119], v[4:7]
    ds_read_b64_tr_b16 a[246:247], v215 offset:13312
    buffer_load_dwordx4 v229, s[8:11], s69 offen offset:1024  lds
    v_mul_f32 v236, v236, v236
    v_mfma_f32_16x16x32_bf16 v[12:15], a[220:223], v[116:119], v[12:15]
    ds_read_b64_tr_b16 a[216:217], v212 offset:2048
    s_waitcnt lgkmcnt(5)
    v_mul_f32 v241, 0x3ae38e39, v241
    v_mfma_f32_16x16x32_bf16 v[8:11], a[220:223], v[112:115], v[8:11]
    ds_read_b64_tr_b16 a[218:219], v212 offset:14336
    s_waitcnt lgkmcnt(3)
    v_mul_f32 v245, 0x3ae38e39, v245
    v_mfma_f32_16x16x32_bf16 v[16:19], a[224:227], v[112:115], v[16:19]
    ds_read_b64_tr_b16 a[220:221], v212 offset:3072
    v_sub_f32 v241, v241, v232
    v_sub_f32 v245, v245, v236
    v_mfma_f32_16x16x32_bf16 v[20:23], a[224:227], v[116:119], v[20:23]
    ds_read_b64_tr_b16 a[222:223], v212 offset:15360
    s_add_u32 s69, s66, 110592
    v_max_f32 v241, 0, v241
    v_mfma_f32_16x16x32_bf16 v[28:31], a[228:231], v[116:119], v[28:31]
    ds_read_b64_tr_b16 a[224:225], v213 offset:2048
    v_max_f32 v245, 0, v245
    v_mfma_f32_16x16x32_bf16 v[24:27], a[228:231], v[112:115], v[24:27]
    ds_read_b64_tr_b16 a[226:227], v213 offset:14336
    v_cvt_pk_bf16_f32 v241, v241, v241
    s_waitcnt lgkmcnt(6)
    v_mfma_f32_16x16x32_bf16 v[32:35], a[232:235], v[112:115], v[32:35]
    ds_read_b64_tr_b16 a[228:229], v213 offset:3072
    v_cvt_pk_bf16_f32 v245, v245, v245
    v_and_b32 v241, 0xffff0000, v241
    v_mfma_f32_16x16x32_bf16 v[36:39], a[232:235], v[116:119], v[36:39]
    ds_read_b64_tr_b16 a[230:231], v213 offset:15360
    buffer_load_dwordx4 v230, s[8:11], s69 offen offset:2048  lds
    v_and_b32 v245, 0xffff0000, v245
    v_mfma_f32_16x16x32_bf16 v[44:47], a[236:239], v[116:119], v[44:47]
    ds_read_b64_tr_b16 a[232:233], v214 offset:2048
    v_add_f32 v241, 0x3727c5ac, v241
    v_mfma_f32_16x16x32_bf16 v[40:43], a[236:239], v[112:115], v[40:43]
    ds_read_b64_tr_b16 a[234:235], v214 offset:14336
    v_add_f32 v245, 0x3727c5ac, v245
    v_mfma_f32_16x16x32_bf16 v[48:51], a[240:243], v[112:115], v[48:51]
    ds_read_b64_tr_b16 a[236:237], v214 offset:3072
    v_cvt_pk_bf16_f32 v241, v241, v241
    v_cvt_pk_bf16_f32 v245, v245, v245
    v_mfma_f32_16x16x32_bf16 v[52:55], a[240:243], v[116:119], v[52:55]
    ds_read_b64_tr_b16 a[238:239], v214 offset:15360
    s_add_u32 s69, s66, 165888
    v_and_b32 v241, 0xffff0000, v241
    v_and_b32 v245, 0xffff0000, v245
    v_sqrt_f32 v241, v241
    v_sqrt_f32 v245, v245
    v_cvt_pk_bf16_f32 v241, v241, v241
    v_cvt_pk_bf16_f32 v245, v245, v245
    v_and_b32 v241, 0xffff0000, v241
    v_and_b32 v245, 0xffff0000, v245
    v_rcp_f32 v210, v241
    v_rcp_f32 v211, v245
    ds_write_b32 v249, v210 offset:0
    ds_write_b32 v249, v211 offset:64
    v_mfma_f32_16x16x32_bf16 v[60:63], a[244:247], v[116:119], v[60:63]
    ds_read_b64_tr_b16 a[240:241], v215 offset:2048
    v_mfma_f32_16x16x32_bf16 v[56:59], a[244:247], v[112:115], v[56:59]
    ds_read_b64_tr_b16 a[242:243], v215 offset:14336
    v_readfirstlane_b32 s40, v254
    s_waitcnt lgkmcnt(8)
    v_mfma_f32_16x16x32_bf16 v[0:3], a[216:219], v[120:123], v[0:3]
    ds_read_b64_tr_b16 a[244:245], v215 offset:3072
    v_mfma_f32_16x16x32_bf16 v[4:7], a[216:219], v[124:127], v[4:7]
    ds_read_b64_tr_b16 a[246:247], v215 offset:15360
    buffer_load_dwordx4 v231, s[8:11], s69 offen offset:3072  lds
    v_mfma_f32_16x16x32_bf16 v[12:15], a[220:223], v[124:127], v[12:15]
    ds_read_b64_tr_b16 a[216:217], v212 offset:4096
    s_mul_i32 s40, s40, 0x9e3779b1
    s_add_u32 s40, s40, 0x7f4a7c15
    v_mfma_f32_16x16x32_bf16 v[8:11], a[220:223], v[120:123], v[8:11]
    ds_read_b64_tr_b16 a[218:219], v212 offset:16384
    s_add_u32 m0, s39, 4096
    v_mfma_f32_16x16x32_bf16 v[16:19], a[224:227], v[120:123], v[16:19]
    ds_read_b64_tr_b16 a[220:221], v212 offset:5120
    v_accvgpr_write_b32 a64, v128
    v_mfma_f32_16x16x32_bf16 v[20:23], a[224:227], v[124:127], v[20:23]
    ds_read_b64_tr_b16 a[222:223], v212 offset:17408
    v_accvgpr_write_b32 a65, v129
    v_mfma_f32_16x16x32_bf16 v[28:31], a[228:231], v[124:127], v[28:31]
    ds_read_b64_tr_b16 a[224:225], v213 offset:4096
    s_add_u32 s69, s66, 221184
    v_mfma_f32_16x16x32_bf16 v[24:27], a[228:231], v[120:123], v[24:27]
    ds_read_b64_tr_b16 a[226:227], v213 offset:16384
    v_accvgpr_write_b32 a66, v130
    s_waitcnt lgkmcnt(6)
    v_mfma_f32_16x16x32_bf16 v[32:35], a[232:235], v[120:123], v[32:35]
    ds_read_b64_tr_b16 a[228:229], v213 offset:5120
    buffer_load_dwordx4 v228, s[8:11], s69 offen offset:0  lds
    v_mfma_f32_16x16x32_bf16 v[36:39], a[232:235], v[124:127], v[36:39]
    ds_read_b64_tr_b16 a[230:231], v213 offset:17408
    v_accvgpr_write_b32 a67, v131
    v_mfma_f32_16x16x32_bf16 v[44:47], a[236:239], v[124:127], v[44:47]
    ds_read_b64_tr_b16 a[232:233], v214 offset:4096
    v_mfma_f32_16x16x32_bf16 v[40:43], a[236:239], v[120:123], v[40:43]
    ds_read_b64_tr_b16 a[234:235], v214 offset:16384
    v_accvgpr_write_b32 a68, v132
    v_mfma_f32_16x16x32_bf16 v[48:51], a[240:243], v[120:123], v[48:51]
    ds_read_b64_tr_b16 a[236:237], v214 offset:5120
    s_add_u32 s69, s66, 276480
    v_mfma_f32_16x16x32_bf16 v[52:55], a[240:243], v[124:127], v[52:55]
    ds_read_b64_tr_b16 a[238:239], v214 offset:17408
    v_accvgpr_write_b32 a69, v133
    v_mfma_f32_16x16x32_bf16 v[60:63], a[244:247], v[124:127], v[60:63]
    ds_read_b64_tr_b16 a[240:241], v215 offset:4096
    v_mfma_f32_16x16x32_bf16 v[56:59], a[244:247], v[120:123], v[56:59]
    ds_read_b64_tr_b16 a[242:243], v215 offset:16384
    s_waitcnt lgkmcnt(6)
    v_mfma_f32_16x16x32_bf16 v[0:3], a[216:219], v[128:131], v[0:3]
    ds_read_b64_tr_b16 a[244:245], v215 offset:5120
    buffer_load_dwordx4 v229, s[8:11], s69 offen offset:1024  lds
    v_mfma_f32_16x16x32_bf16 v[4:7], a[216:219], v[132:135], v[4:7]
    ds_read_b64_tr_b16 a[246:247], v215 offset:17408
    v_accvgpr_write_b32 a70, v134
    v_mfma_f32_16x16x32_bf16 v[12:15], a[220:223], v[132:135], v[12:15]
    s_waitcnt vmcnt(24)
    s_barrier
    ds_read_b64_tr_b16 a[216:217], v212 offset:24576
    v_accvgpr_write_b32 a71, v135
    v_mfma_f32_16x16x32_bf16 v[8:11], a[220:223], v[128:131], v[8:11]
    ds_read_b64_tr_b16 a[218:219], v212 offset:36864
    v_mfma_f32_16x16x32_bf16 v[16:19], a[224:227], v[128:131], v[16:19]
    ds_read_b64_tr_b16 a[220:221], v212 offset:25600
    s_add_u32 m0, s39, 24576
    v_mfma_f32_16x16x32_bf16 v[20:23], a[224:227], v[132:135], v[20:23]
    ds_read_b64_tr_b16 a[222:223], v212 offset:37888
    v_accvgpr_write_b32 a72, v136
    v_mfma_f32_16x16x32_bf16 v[28:31], a[228:231], v[132:135], v[28:31]
    ds_read_b64_tr_b16 a[224:225], v213 offset:24576
    v_accvgpr_write_b32 a73, v137
    v_mfma_f32_16x16x32_bf16 v[24:27], a[228:231], v[128:131], v[24:27]
    ds_read_b64_tr_b16 a[226:227], v213 offset:36864
    s_add_u32 s69, s66, 331776
    s_waitcnt lgkmcnt(6)
    v_mfma_f32_16x16x32_bf16 v[32:35], a[232:235], v[128:131], v[32:35]
    ds_read_b64_tr_b16 a[228:229], v213 offset:25600
    v_accvgpr_write_b32 a74, v138
    v_mfma_f32_16x16x32_bf16 v[36:39], a[232:235], v[132:135], v[36:39]
    ds_read_b64_tr_b16 a[230:231], v213 offset:37888
    buffer_load_dwordx4 v228, s[8:11], s69 offen offset:0  lds
    v_mfma_f32_16x16x32_bf16 v[44:47], a[236:239], v[132:135], v[44:47]
    ds_read_b64_tr_b16 a[232:233], v214 offset:24576
    v_accvgpr_write_b32 a75, v139
    v_mfma_f32_16x16x32_bf16 v[40:43], a[236:239], v[128:131], v[40:43]
    ds_read_b64_tr_b16 a[234:235], v214 offset:36864
    v_mfma_f32_16x16x32_bf16 v[48:51], a[240:243], v[128:131], v[48:51]
    ds_read_b64_tr_b16 a[236:237], v214 offset:25600
    v_accvgpr_write_b32 a76, v140
    v_mfma_f32_16x16x32_bf16 v[52:55], a[240:243], v[132:135], v[52:55]
    ds_read_b64_tr_b16 a[238:239], v214 offset:37888
    s_add_u32 s69, s66, 387072
    v_mfma_f32_16x16x32_bf16 v[60:63], a[244:247], v[132:135], v[60:63]
    ds_read_b64_tr_b16 a[240:241], v215 offset:24576
    v_accvgpr_write_b32 a77, v141
    v_mfma_f32_16x16x32_bf16 v[56:59], a[244:247], v[128:131], v[56:59]
    ds_read_b64_tr_b16 a[242:243], v215 offset:36864
    s_waitcnt lgkmcnt(6)
    v_mfma_f32_16x16x32_bf16 v[0:3], a[216:219], v[136:139], v[0:3]
    ds_read_b64_tr_b16 a[244:245], v215 offset:25600
    v_mfma_f32_16x16x32_bf16 v[4:7], a[216:219], v[140:143], v[4:7]
    ds_read_b64_tr_b16 a[246:247], v215 offset:37888
    buffer_load_dwordx4 v229, s[8:11], s69 offen offset:1024  lds
    v_mfma_f32_16x16x32_bf16 v[12:15], a[220:223], v[140:143], v[12:15]
    ds_read_b64_tr_b16 a[216:217], v212 offset:26624
    v_accvgpr_write_b32 a78, v142
    v_mfma_f32_16x16x32_bf16 v[8:11], a[220:223], v[136:139], v[8:11]
    ds_read_b64_tr_b16 a[218:219], v212 offset:38912
    v_accvgpr_write_b32 a79, v143
    v_mfma_f32_16x16x32_bf16 v[16:19], a[224:227], v[136:139], v[16:19]
    ds_read_b64_tr_b16 a[220:221], v212 offset:27648
    v_mfma_f32_16x16x32_bf16 v[20:23], a[224:227], v[140:143], v[20:23]
    ds_read_b64_tr_b16 a[222:223], v212 offset:39936
    s_add_u32 s69, s66, 442368
    v_mfma_f32_16x16x32_bf16 v[28:31], a[228:231], v[140:143], v[28:31]
    ds_read_b64_tr_b16 a[224:225], v213 offset:26624
    v_accvgpr_write_b32 a80, v144
    v_mfma_f32_16x16x32_bf16 v[24:27], a[228:231], v[136:139], v[24:27]
    ds_read_b64_tr_b16 a[226:227], v213 offset:38912
    v_accvgpr_write_b32 a81, v145
    s_waitcnt lgkmcnt(6)
    v_mfma_f32_16x16x32_bf16 v[32:35], a[232:235], v[136:139], v[32:35]
    ds_read_b64_tr_b16 a[228:229], v213 offset:27648
    v_mfma_f32_16x16x32_bf16 v[36:39], a[232:235], v[140:143], v[36:39]
    ds_read_b64_tr_b16 a[230:231], v213 offset:39936
    buffer_load_dwordx4 v230, s[8:11], s69 offen offset:2048  lds
    v_mfma_f32_16x16x32_bf16 v[44:47], a[236:239], v[140:143], v[44:47]
    ds_read_b64_tr_b16 a[232:233], v214 offset:26624
    v_accvgpr_write_b32 a82, v146
    v_mfma_f32_16x16x32_bf16 v[40:43], a[236:239], v[136:139], v[40:43]
    ds_read_b64_tr_b16 a[234:235], v214 offset:38912
    v_accvgpr_write_b32 a83, v147
    v_mfma_f32_16x16x32_bf16 v[48:51], a[240:243], v[136:139], v[48:51]
    ds_read_b64_tr_b16 a[236:237], v214 offset:27648
    v_mfma_f32_16x16x32_bf16 v[52:55], a[240:243], v[140:143], v[52:55]
    ds_read_b64_tr_b16 a[238:239], v214 offset:39936
    s_add_u32 s69, s66, 497664
    v_mfma_f32_16x16x32_bf16 v[60:63], a[244:247], v[140:143], v[60:63]
    ds_read_b64_tr_b16 a[240:241], v215 offset:26624
    v_accvgpr_write_b32 a84, v148
    v_mfma_f32_16x16x32_bf16 v[56:59], a[244:247], v[136:139], v[56:59]
    ds_read_b64_tr_b16 a[242:243], v215 offset:38912
    v_accvgpr_write_b32 a85, v149
    s_waitcnt lgkmcnt(6)
    v_mfma_f32_16x16x32_bf16 v[0:3], a[216:219], v[144:147], v[0:3]
    ds_read_b64_tr_b16 a[244:245], v215 offset:27648
    v_mfma_f32_16x16x32_bf16 v[4:7], a[216:219], v[148:151], v[4:7]
    ds_read_b64_tr_b16 a[246:247], v215 offset:39936
    buffer_load_dwordx4 v231, s[8:11], s69 offen offset:3072  lds
    v_mfma_f32_16x16x32_bf16 v[12:15], a[220:223], v[148:151], v[12:15]
    ds_read_b64_tr_b16 a[216:217], v212 offset:28672
    v_accvgpr_write_b32 a86, v150
    v_mfma_f32_16x16x32_bf16 v[8:11], a[220:223], v[144:147], v[8:11]
    ds_read_b64_tr_b16 a[218:219], v212 offset:40960
    s_add_u32 m0, s39, 28672
    v_mfma_f32_16x16x32_bf16 v[16:19], a[224:227], v[144:147], v[16:19]
    ds_read_b64_tr_b16 a[220:221], v212 offset:29696
    v_accvgpr_write_b32 a87, v151
    v_mfma_f32_16x16x32_bf16 v[20:23], a[224:227], v[148:151], v[20:23]
    ds_read_b64_tr_b16 a[222:223], v212 offset:41984
    v_mfma_f32_16x16x32_bf16 v[28:31], a[228:231], v[148:151], v[28:31]
    ds_read_b64_tr_b16 a[224:225], v213 offset:28672
    s_add_u32 s69, s66, 552960
    v_mfma_f32_16x16x32_bf16 v[24:27], a[228:231], v[144:147], v[24:27]
    ds_read_b64_tr_b16 a[226:227], v213 offset:40960
    v_accvgpr_write_b32 a88, v152
    s_waitcnt lgkmcnt(6)
    v_mfma_f32_16x16x32_bf16 v[32:35], a[232:235], v[144:147], v[32:35]
    ds_read_b64_tr_b16 a[228:229], v213 offset:29696
    buffer_load_dwordx4 v228, s[8:11], s69 offen offset:0  lds
    v_mfma_f32_16x16x32_bf16 v[36:39], a[232:235], v[148:151], v[36:39]
    ds_read_b64_tr_b16 a[230:231], v213 offset:41984
    v_accvgpr_write_b32 a89, v153
    v_mfma_f32_16x16x32_bf16 v[44:47], a[236:239], v[148:151], v[44:47]
    ds_read_b64_tr_b16 a[232:233], v214 offset:28672
    v_accvgpr_write_b32 a90, v154
    v_mfma_f32_16x16x32_bf16 v[40:43], a[236:239], v[144:147], v[40:43]
    ds_read_b64_tr_b16 a[234:235], v214 offset:40960
    v_mfma_f32_16x16x32_bf16 v[48:51], a[240:243], v[144:147], v[48:51]
    ds_read_b64_tr_b16 a[236:237], v214 offset:29696
    s_add_u32 s69, s66, 608256
    v_mfma_f32_16x16x32_bf16 v[52:55], a[240:243], v[148:151], v[52:55]
    ds_read_b64_tr_b16 a[238:239], v214 offset:41984
    v_accvgpr_write_b32 a91, v155
    v_mfma_f32_16x16x32_bf16 v[60:63], a[244:247], v[148:151], v[60:63]
    ds_read_b64_tr_b16 a[240:241], v215 offset:28672
    v_accvgpr_write_b32 a92, v156
    v_mfma_f32_16x16x32_bf16 v[56:59], a[244:247], v[144:147], v[56:59]
    ds_read_b64_tr_b16 a[242:243], v215 offset:40960
    s_waitcnt lgkmcnt(6)
    v_mfma_f32_16x16x32_bf16 v[0:3], a[216:219], v[152:155], v[0:3]
    ds_read_b64_tr_b16 a[244:245], v215 offset:29696
    buffer_load_dwordx4 v229, s[8:11], s69 offen offset:1024  lds
    v_mfma_f32_16x16x32_bf16 v[4:7], a[216:219], v[156:159], v[4:7]
    ds_read_b64_tr_b16 a[246:247], v215 offset:41984
    v_accvgpr_write_b32 a93, v157
    v_mfma_f32_16x16x32_bf16 v[12:15], a[220:223], v[156:159], v[12:15]
    s_waitcnt vmcnt(24)
    s_barrier
    v_add_u32 v212, 0xc000, v212
    ds_read_b64_tr_b16 a[216:217], v212 offset:0
    v_accvgpr_write_b32 a94, v158
    v_mfma_f32_16x16x32_bf16 v[8:11], a[220:223], v[152:155], v[8:11]
    ds_read_b64_tr_b16 a[218:219], v212 offset:12288
    v_mfma_f32_16x16x32_bf16 v[16:19], a[224:227], v[152:155], v[16:19]
    ds_read_b64_tr_b16 a[220:221], v212 offset:1024
    s_add_u32 m0, s39, 49152
    v_mfma_f32_16x16x32_bf16 v[20:23], a[224:227], v[156:159], v[20:23]
    ds_read_b64_tr_b16 a[222:223], v212 offset:13312
    v_accvgpr_write_b32 a95, v159
    v_mfma_f32_16x16x32_bf16 v[28:31], a[228:231], v[156:159], v[28:31]
    v_add_u32 v213, 0xc000, v213
    ds_read_b64_tr_b16 a[224:225], v213 offset:0
    v_mfma_f32_16x16x32_bf16 v[24:27], a[228:231], v[152:155], v[24:27]
    ds_read_b64_tr_b16 a[226:227], v213 offset:12288
    s_add_u32 s69, s67, 0
    s_waitcnt lgkmcnt(6)
    v_mfma_f32_16x16x32_bf16 v[32:35], a[232:235], v[152:155], v[32:35]
    ds_read_b64_tr_b16 a[228:229], v213 offset:1024
    v_accvgpr_write_b32 a96, v160
    v_mfma_f32_16x16x32_bf16 v[36:39], a[232:235], v[156:159], v[36:39]
    ds_read_b64_tr_b16 a[230:231], v213 offset:13312
    buffer_load_dwordx4 v228, s[8:11], s69 offen offset:0  lds
    v_mfma_f32_16x16x32_bf16 v[44:47], a[236:239], v[156:159], v[44:47]
    v_add_u32 v214, 0xc000, v214
    ds_read_b64_tr_b16 a[232:233], v214 offset:0
    v_accvgpr_write_b32 a97, v161
    v_mfma_f32_16x16x32_bf16 v[40:43], a[236:239], v[152:155], v[40:43]
    ds_read_b64_tr_b16 a[234:235], v214 offset:12288
    v_accvgpr_write_b32 a98, v162
    v_mfma_f32_16x16x32_bf16 v[48:51], a[240:243], v[152:155], v[48:51]
    ds_read_b64_tr_b16 a[236:237], v214 offset:1024
    v_mfma_f32_16x16x32_bf16 v[52:55], a[240:243], v[156:159], v[52:55]
    ds_read_b64_tr_b16 a[238:239], v214 offset:13312
    s_add_u32 s69, s67, 55296
    v_mfma_f32_16x16x32_bf16 v[60:63], a[244:247], v[156:159], v[60:63]
    v_add_u32 v215, 0xc000, v215
    ds_read_b64_tr_b16 a[240:241], v215 offset:0
    v_accvgpr_write_b32 a99, v163
    v_mfma_f32_16x16x32_bf16 v[56:59], a[244:247], v[152:155], v[56:59]
    ds_read_b64_tr_b16 a[242:243], v215 offset:12288
    v_accvgpr_write_b32 a100, v164
    s_waitcnt lgkmcnt(6)
    v_mfma_f32_16x16x32_bf16 v[0:3], a[216:219], v[160:163], v[0:3]
    ds_read_b64_tr_b16 a[244:245], v215 offset:1024
    v_mfma_f32_16x16x32_bf16 v[4:7], a[216:219], v[164:167], v[4:7]
    ds_read_b64_tr_b16 a[246:247], v215 offset:13312
    buffer_load_dwordx4 v229, s[8:11], s69 offen offset:1024  lds
    v_mfma_f32_16x16x32_bf16 v[12:15], a[220:223], v[164:167], v[12:15]
    ds_read_b64_tr_b16 a[216:217], v212 offset:2048
    v_accvgpr_write_b32 a101, v165
    v_mfma_f32_16x16x32_bf16 v[8:11], a[220:223], v[160:163], v[8:11]
    ds_read_b64_tr_b16 a[218:219], v212 offset:14336
    v_accvgpr_write_b32 a102, v166
    v_mfma_f32_16x16x32_bf16 v[16:19], a[224:227], v[160:163], v[16:19]
    ds_read_b64_tr_b16 a[220:221], v212 offset:3072
    v_mfma_f32_16x16x32_bf16 v[20:23], a[224:227], v[164:167], v[20:23]
    ds_read_b64_tr_b16 a[222:223], v212 offset:15360
    s_add_u32 s69, s67, 110592
    v_mfma_f32_16x16x32_bf16 v[28:31], a[228:231], v[164:167], v[28:31]
    ds_read_b64_tr_b16 a[224:225], v213 offset:2048
    v_accvgpr_write_b32 a103, v167
    v_mfma_f32_16x16x32_bf16 v[24:27], a[228:231], v[160:163], v[24:27]
    ds_read_b64_tr_b16 a[226:227], v213 offset:14336
    s_waitcnt lgkmcnt(6)
    v_mfma_f32_16x16x32_bf16 v[32:35], a[232:235], v[160:163], v[32:35]
    ds_read_b64_tr_b16 a[228:229], v213 offset:3072
    v_accvgpr_write_b32 a104, v168
    v_mfma_f32_16x16x32_bf16 v[36:39], a[232:235], v[164:167], v[36:39]
    ds_read_b64_tr_b16 a[230:231], v213 offset:15360
    buffer_load_dwordx4 v230, s[8:11], s69 offen offset:2048  lds
    v_mfma_f32_16x16x32_bf16 v[44:47], a[236:239], v[164:167], v[44:47]
    ds_read_b64_tr_b16 a[232:233], v214 offset:2048
    v_accvgpr_write_b32 a105, v169
    v_mfma_f32_16x16x32_bf16 v[40:43], a[236:239], v[160:163], v[40:43]
    ds_read_b64_tr_b16 a[234:235], v214 offset:14336
    v_mfma_f32_16x16x32_bf16 v[48:51], a[240:243], v[160:163], v[48:51]
    ds_read_b64_tr_b16 a[236:237], v214 offset:3072
    v_accvgpr_write_b32 a106, v170
    v_mfma_f32_16x16x32_bf16 v[52:55], a[240:243], v[164:167], v[52:55]
    ds_read_b64_tr_b16 a[238:239], v214 offset:15360
    s_add_u32 s69, s67, 165888
    v_mfma_f32_16x16x32_bf16 v[60:63], a[244:247], v[164:167], v[60:63]
    ds_read_b64_tr_b16 a[240:241], v215 offset:2048
    v_accvgpr_write_b32 a107, v171
    v_mfma_f32_16x16x32_bf16 v[56:59], a[244:247], v[160:163], v[56:59]
    ds_read_b64_tr_b16 a[242:243], v215 offset:14336
    s_waitcnt lgkmcnt(6)
    v_mfma_f32_16x16x32_bf16 v[0:3], a[216:219], v[168:171], v[0:3]
    ds_read_b64_tr_b16 a[244:245], v215 offset:3072
    v_accvgpr_write_b32 a108, v172
    v_mfma_f32_16x16x32_bf16 v[4:7], a[216:219], v[172:175], v[4:7]
    ds_read_b64_tr_b16 a[246:247], v215 offset:15360
    buffer_load_dwordx4 v231, s[8:11], s69 offen offset:3072  lds
    v_mfma_f32_16x16x32_bf16 v[12:15], a[220:223], v[172:175], v[12:15]
    ds_read_b64_tr_b16 a[216:217], v212 offset:4096
    v_accvgpr_write_b32 a109, v173
    v_mfma_f32_16x16x32_bf16 v[8:11], a[220:223], v[168:171], v[8:11]
    ds_read_b64_tr_b16 a[218:219], v212 offset:16384
    s_add_u32 m0, s39, 53248
    v_mfma_f32_16x16x32_bf16 v[16:19], a[224:227], v[168:171], v[16:19]
    ds_read_b64_tr_b16 a[220:221], v212 offset:5120
    v_accvgpr_write_b32 a110, v174
    v_mfma_f32_16x16x32_bf16 v[20:23], a[224:227], v[172:175], v[20:23]
    ds_read_b64_tr_b16 a[222:223], v212 offset:17408
    v_mfma_f32_16x16x32_bf16 v[28:31], a[228:231], v[172:175], v[28:31]
    ds_read_b64_tr_b16 a[224:225], v213 offset:4096
    s_add_u32 s69, s67, 221184
    v_mfma_f32_16x16x32_bf16 v[24:27], a[228:231], v[168:171], v[24:27]
    ds_read_b64_tr_b16 a[226:227], v213 offset:16384
    v_accvgpr_write_b32 a111, v175
    s_waitcnt lgkmcnt(6)
    v_mfma_f32_16x16x32_bf16 v[32:35], a[232:235], v[168:171], v[32:35]
    ds_read_b64_tr_b16 a[228:229], v213 offset:5120
    buffer_load_dwordx4 v228, s[8:11], s69 offen offset:0  lds
    v_mfma_f32_16x16x32_bf16 v[36:39], a[232:235], v[172:175], v[36:39]
    ds_read_b64_tr_b16 a[230:231], v213 offset:17408
    v_accvgpr_write_b32 a112, v176
    v_mfma_f32_16x16x32_bf16 v[44:47], a[236:239], v[172:175], v[44:47]
    ds_read_b64_tr_b16 a[232:233], v214 offset:4096
    v_mfma_f32_16x16x32_bf16 v[40:43], a[236:239], v[168:171], v[40:43]
    ds_read_b64_tr_b16 a[234:235], v214 offset:16384
    v_accvgpr_write_b32 a113, v177
    v_mfma_f32_16x16x32_bf16 v[48:51], a[240:243], v[168:171], v[48:51]
    ds_read_b64_tr_b16 a[236:237], v214 offset:5120
    s_add_u32 s69, s67, 276480
    v_mfma_f32_16x16x32_bf16 v[52:55], a[240:243], v[172:175], v[52:55]
    ds_read_b64_tr_b16 a[238:239], v214 offset:17408
    v_accvgpr_write_b32 a114, v178
    v_mfma_f32_16x16x32_bf16 v[60:63], a[244:247], v[172:175], v[60:63]
    ds_read_b64_tr_b16 a[240:241], v215 offset:4096
    v_mfma_f32_16x16x32_bf16 v[56:59], a[244:247], v[168:171], v[56:59]
    ds_read_b64_tr_b16 a[242:243], v215 offset:16384
    v_accvgpr_write_b32 a115, v179
    s_waitcnt lgkmcnt(6)
    v_mfma_f32_16x16x32_bf16 v[0:3], a[216:219], v[176:179], v[0:3]
    ds_read_b64_tr_b16 a[244:245], v215 offset:5120
    buffer_load_dwordx4 v229, s[8:11], s69 offen offset:1024  lds
    v_mfma_f32_16x16x32_bf16 v[4:7], a[216:219], v[180:183], v[4:7]
    ds_read_b64_tr_b16 a[246:247], v215 offset:17408
    v_accvgpr_write_b32 a116, v180
    v_mfma_f32_16x16x32_bf16 v[12:15], a[220:223], v[180:183], v[12:15]
    s_waitcnt vmcnt(18)
    s_barrier
    ds_read_b64_tr_b16 a[216:217], v212 offset:24576
    v_mfma_f32_16x16x32_bf16 v[8:11], a[220:223], v[176:179], v[8:11]
    ds_read_b64_tr_b16 a[218:219], v212 offset:36864
    s_add_u32 m0, s39, 73728
    v_mfma_f32_16x16x32_bf16 v[16:19], a[224:227], v[176:179], v[16:19]
    ds_read_b64_tr_b16 a[220:221], v212 offset:25600
    v_accvgpr_write_b32 a117, v181
    v_mfma_f32_16x16x32_bf16 v[20:23], a[224:227], v[180:183], v[20:23]
    ds_read_b64_tr_b16 a[222:223], v212 offset:37888
    s_add_u32 s69, s67, 331776
    v_accvgpr_write_b32 a118, v182
    v_mfma_f32_16x16x32_bf16 v[28:31], a[228:231], v[180:183], v[28:31]
    ds_read_b64_tr_b16 a[224:225], v213 offset:24576
    buffer_load_dwordx4 v228, s[8:11], s69 offen offset:0  lds
    v_mfma_f32_16x16x32_bf16 v[24:27], a[228:231], v[176:179], v[24:27]
    ds_read_b64_tr_b16 a[226:227], v213 offset:36864
    s_waitcnt lgkmcnt(6)
    v_mfma_f32_16x16x32_bf16 v[32:35], a[232:235], v[176:179], v[32:35]
    ds_read_b64_tr_b16 a[228:229], v213 offset:25600
    s_add_u32 s69, s67, 387072
    v_accvgpr_write_b32 a119, v183
    v_mfma_f32_16x16x32_bf16 v[36:39], a[232:235], v[180:183], v[36:39]
    ds_read_b64_tr_b16 a[230:231], v213 offset:37888
    buffer_load_dwordx4 v229, s[8:11], s69 offen offset:1024  lds
    v_mfma_f32_16x16x32_bf16 v[44:47], a[236:239], v[180:183], v[44:47]
    ds_read_b64_tr_b16 a[232:233], v214 offset:24576
    v_accvgpr_write_b32 a120, v184
    v_mfma_f32_16x16x32_bf16 v[40:43], a[236:239], v[176:179], v[40:43]
    ds_read_b64_tr_b16 a[234:235], v214 offset:36864
    s_add_u32 s69, s67, 442368
    v_mfma_f32_16x16x32_bf16 v[48:51], a[240:243], v[176:179], v[48:51]
    ds_read_b64_tr_b16 a[236:237], v214 offset:25600
    v_accvgpr_write_b32 a121, v185
    v_mfma_f32_16x16x32_bf16 v[52:55], a[240:243], v[180:183], v[52:55]
    ds_read_b64_tr_b16 a[238:239], v214 offset:37888
    buffer_load_dwordx4 v230, s[8:11], s69 offen offset:2048  lds
    v_mfma_f32_16x16x32_bf16 v[60:63], a[244:247], v[180:183], v[60:63]
    ds_read_b64_tr_b16 a[240:241], v215 offset:24576
    v_accvgpr_write_b32 a122, v186
    v_mfma_f32_16x16x32_bf16 v[56:59], a[244:247], v[176:179], v[56:59]
    ds_read_b64_tr_b16 a[242:243], v215 offset:36864
    s_add_u32 s69, s67, 497664
    s_waitcnt lgkmcnt(6)
    v_mfma_f32_16x16x32_bf16 v[0:3], a[216:219], v[184:187], v[0:3]
    ds_read_b64_tr_b16 a[244:245], v215 offset:25600
    v_accvgpr_write_b32 a123, v187
    v_mfma_f32_16x16x32_bf16 v[4:7], a[216:219], v[188:191], v[4:7]
    ds_read_b64_tr_b16 a[246:247], v215 offset:37888
    buffer_load_dwordx4 v231, s[8:11], s69 offen offset:3072  lds
    v_mfma_f32_16x16x32_bf16 v[12:15], a[220:223], v[188:191], v[12:15]
    ds_read_b64_tr_b16 a[216:217], v212 offset:26624
    s_add_u32 m0, s39, 77824
    v_accvgpr_write_b32 a124, v188
    v_mfma_f32_16x16x32_bf16 v[8:11], a[220:223], v[184:187], v[8:11]
    ds_read_b64_tr_b16 a[218:219], v212 offset:38912
    s_add_u32 s69, s67, 552960
    v_mfma_f32_16x16x32_bf16 v[16:19], a[224:227], v[184:187], v[16:19]
    ds_read_b64_tr_b16 a[220:221], v212 offset:27648
    buffer_load_dwordx4 v228, s[8:11], s69 offen offset:0  lds
    v_mfma_f32_16x16x32_bf16 v[20:23], a[224:227], v[188:191], v[20:23]
    ds_read_b64_tr_b16 a[222:223], v212 offset:39936
    v_accvgpr_write_b32 a125, v189
    v_mfma_f32_16x16x32_bf16 v[28:31], a[228:231], v[188:191], v[28:31]
    ds_read_b64_tr_b16 a[224:225], v213 offset:26624
    s_add_u32 s69, s67, 608256
    v_mfma_f32_16x16x32_bf16 v[24:27], a[228:231], v[184:187], v[24:27]
    ds_read_b64_tr_b16 a[226:227], v213 offset:38912
    v_accvgpr_write_b32 a126, v190
    s_waitcnt lgkmcnt(6)
    v_mfma_f32_16x16x32_bf16 v[32:35], a[232:235], v[184:187], v[32:35]
    ds_read_b64_tr_b16 a[228:229], v213 offset:27648
    buffer_load_dwordx4 v229, s[8:11], s69 offen offset:1024  lds
    v_mfma_f32_16x16x32_bf16 v[36:39], a[232:235], v[188:191], v[36:39]
    ds_read_b64_tr_b16 a[230:231], v213 offset:39936
    v_accvgpr_write_b32 a127, v191
    v_mfma_f32_16x16x32_bf16 v[44:47], a[236:239], v[188:191], v[44:47]
    ds_read_b64_tr_b16 a[232:233], v214 offset:26624
    v_accvgpr_read_b32 v254, a170
    v_mfma_f32_16x16x32_bf16 v[40:43], a[236:239], v[184:187], v[40:43]
    ds_read_b64_tr_b16 a[234:235], v214 offset:38912
    v_accvgpr_write_b32 a128, v192
    v_mfma_f32_16x16x32_bf16 v[48:51], a[240:243], v[184:187], v[48:51]
    ds_read_b64_tr_b16 a[236:237], v214 offset:27648
    buffer_load_dword a215, v254, s[16:19], s100 offen offset:128
    buffer_load_dword a215, v254, s[20:23], s100 offen offset:128
    v_mfma_f32_16x16x32_bf16 v[52:55], a[240:243], v[188:191], v[52:55]
    ds_read_b64_tr_b16 a[238:239], v214 offset:39936
    v_accvgpr_write_b32 a129, v193
    v_mfma_f32_16x16x32_bf16 v[60:63], a[244:247], v[188:191], v[60:63]
    ds_read_b64_tr_b16 a[240:241], v215 offset:26624
    v_mfma_f32_16x16x32_bf16 v[56:59], a[244:247], v[184:187], v[56:59]
    ds_read_b64_tr_b16 a[242:243], v215 offset:38912
    v_accvgpr_write_b32 a130, v194
    s_waitcnt lgkmcnt(6)
    v_mfma_f32_16x16x32_bf16 v[0:3], a[216:219], v[192:195], v[0:3]
    ds_read_b64_tr_b16 a[244:245], v215 offset:27648
    v_mfma_f32_16x16x32_bf16 v[4:7], a[216:219], v[196:199], v[4:7]
    ds_read_b64_tr_b16 a[246:247], v215 offset:39936
    v_accvgpr_write_b32 a131, v195
    v_mfma_f32_16x16x32_bf16 v[12:15], a[220:223], v[196:199], v[12:15]
    ds_read_b64_tr_b16 a[216:217], v212 offset:28672
    v_mfma_f32_16x16x32_bf16 v[8:11], a[220:223], v[192:195], v[8:11]
    ds_read_b64_tr_b16 a[218:219], v212 offset:40960
    v_accvgpr_write_b32 a132, v196
    v_mfma_f32_16x16x32_bf16 v[16:19], a[224:227], v[192:195], v[16:19]
    ds_read_b64_tr_b16 a[220:221], v212 offset:29696
    v_mfma_f32_16x16x32_bf16 v[20:23], a[224:227], v[196:199], v[20:23]
    ds_read_b64_tr_b16 a[222:223], v212 offset:41984
    v_accvgpr_write_b32 a133, v197
    v_mfma_f32_16x16x32_bf16 v[28:31], a[228:231], v[196:199], v[28:31]
    ds_read_b64_tr_b16 a[224:225], v213 offset:28672
    v_mfma_f32_16x16x32_bf16 v[24:27], a[228:231], v[192:195], v[24:27]
    ds_read_b64_tr_b16 a[226:227], v213 offset:40960
    v_accvgpr_write_b32 a134, v198
    s_waitcnt lgkmcnt(6)
    v_mfma_f32_16x16x32_bf16 v[32:35], a[232:235], v[192:195], v[32:35]
    ds_read_b64_tr_b16 a[228:229], v213 offset:29696
    v_mfma_f32_16x16x32_bf16 v[36:39], a[232:235], v[196:199], v[36:39]
    ds_read_b64_tr_b16 a[230:231], v213 offset:41984
    v_accvgpr_write_b32 a135, v199
    v_mfma_f32_16x16x32_bf16 v[44:47], a[236:239], v[196:199], v[44:47]
    ds_read_b64_tr_b16 a[232:233], v214 offset:28672
    v_mfma_f32_16x16x32_bf16 v[40:43], a[236:239], v[192:195], v[40:43]
    ds_read_b64_tr_b16 a[234:235], v214 offset:40960
    v_mfma_f32_16x16x32_bf16 v[48:51], a[240:243], v[192:195], v[48:51]
    ds_read_b64_tr_b16 a[236:237], v214 offset:29696
    v_accvgpr_write_b32 a136, v200
    v_mfma_f32_16x16x32_bf16 v[52:55], a[240:243], v[196:199], v[52:55]
    ds_read_b64_tr_b16 a[238:239], v214 offset:41984
    v_mfma_f32_16x16x32_bf16 v[60:63], a[244:247], v[196:199], v[60:63]
    ds_read_b64_tr_b16 a[240:241], v215 offset:28672
    v_accvgpr_write_b32 a137, v201
    v_mfma_f32_16x16x32_bf16 v[56:59], a[244:247], v[192:195], v[56:59]
    ds_read_b64_tr_b16 a[242:243], v215 offset:40960
    s_waitcnt lgkmcnt(6)
    v_mfma_f32_16x16x32_bf16 v[0:3], a[216:219], v[200:203], v[0:3]
    ds_read_b64_tr_b16 a[244:245], v215 offset:29696
    v_accvgpr_write_b32 a138, v202
    v_mfma_f32_16x16x32_bf16 v[4:7], a[216:219], v[204:207], v[4:7]
    ds_read_b64_tr_b16 a[246:247], v215 offset:41984
    v_mfma_f32_16x16x32_bf16 v[12:15], a[220:223], v[204:207], v[12:15]
    s_waitcnt vmcnt(20)
    s_barrier
    ds_read_b64_tr_b16 a[216:217], v216 offset:0
    v_accvgpr_write_b32 a139, v203
    v_mfma_f32_16x16x32_bf16 v[8:11], a[220:223], v[200:203], v[8:11]
    ds_read_b64_tr_b16 a[218:219], v216 offset:1024
    v_mfma_f32_16x16x32_bf16 v[16:19], a[224:227], v[200:203], v[16:19]
    ds_read_b64_tr_b16 a[220:221], v217 offset:0
    v_accvgpr_write_b32 a140, v204
    v_mfma_f32_16x16x32_bf16 v[20:23], a[224:227], v[204:207], v[20:23]
    ds_read_b64_tr_b16 a[222:223], v217 offset:1024
    v_mfma_f32_16x16x32_bf16 v[28:31], a[228:231], v[204:207], v[28:31]
    ds_read_b64_tr_b16 a[224:225], v218 offset:0
    v_accvgpr_write_b32 a141, v205
    v_mfma_f32_16x16x32_bf16 v[24:27], a[228:231], v[200:203], v[24:27]
    ds_read_b64_tr_b16 a[226:227], v218 offset:1024
    s_waitcnt lgkmcnt(6)
    v_mfma_f32_16x16x32_bf16 v[32:35], a[232:235], v[200:203], v[32:35]
    ds_read_b64_tr_b16 a[228:229], v219 offset:0
    v_accvgpr_write_b32 a142, v206
    v_mfma_f32_16x16x32_bf16 v[36:39], a[232:235], v[204:207], v[36:39]
    ds_read_b64_tr_b16 a[230:231], v219 offset:1024
    v_mfma_f32_16x16x32_bf16 v[44:47], a[236:239], v[204:207], v[44:47]
    ds_read_b64_tr_b16 a[232:233], v220 offset:0
    v_accvgpr_write_b32 a143, v207
    v_mfma_f32_16x16x32_bf16 v[40:43], a[236:239], v[200:203], v[40:43]
    ds_read_b64_tr_b16 a[234:235], v220 offset:1024
    v_mfma_f32_16x16x32_bf16 v[48:51], a[240:243], v[200:203], v[48:51]
    ds_read_b64_tr_b16 a[236:237], v221 offset:0
    v_mfma_f32_16x16x32_bf16 v[52:55], a[240:243], v[204:207], v[52:55]
    ds_read_b64_tr_b16 a[238:239], v221 offset:1024
    v_mfma_f32_16x16x32_bf16 v[60:63], a[244:247], v[204:207], v[60:63]
    ds_read_b64_tr_b16 a[240:241], v222 offset:0
    v_mfma_f32_16x16x32_bf16 v[56:59], a[244:247], v[200:203], v[56:59]
    ds_read_b64_tr_b16 a[242:243], v222 offset:1024
    s_waitcnt lgkmcnt(6)
    v_mfma_f32_16x16x32_bf16 v[160:163], v[64:67], a[216:219], 0
    ds_read_b64_tr_b16 a[244:245], v216 offset:2048
    v_mfma_f32_16x16x32_bf16 v[164:167], v[68:71], a[216:219], 0
    ds_read_b64_tr_b16 a[246:247], v216 offset:3072
    v_mfma_f32_16x16x32_bf16 v[172:175], v[68:71], a[220:223], 0
    ds_read_b64_tr_b16 a[216:217], v217 offset:2048
    v_mfma_f32_16x16x32_bf16 v[168:171], v[64:67], a[220:223], 0
    ds_read_b64_tr_b16 a[218:219], v217 offset:3072
    v_mfma_f32_16x16x32_bf16 v[144:147], v[64:67], a[224:227], 0
    ds_read_b64_tr_b16 a[220:221], v218 offset:2048
    v_mfma_f32_16x16x32_bf16 v[148:151], v[68:71], a[224:227], 0
    ds_read_b64_tr_b16 a[222:223], v218 offset:3072
    s_add_u32 m0, s39, 98304
    v_mfma_f32_16x16x32_bf16 v[156:159], v[68:71], a[228:231], 0
    ds_read_b64_tr_b16 a[224:225], v219 offset:2048
    v_mfma_f32_16x16x32_bf16 v[152:155], v[64:67], a[228:231], 0
    ds_read_b64_tr_b16 a[226:227], v219 offset:3072
    s_add_u32 s69, s68, 0
    s_waitcnt lgkmcnt(6)
    v_mfma_f32_16x16x32_bf16 v[200:203], v[64:67], a[232:235], 0
    ds_read_b64_tr_b16 a[228:229], v220 offset:2048
    buffer_load_dwordx4 v228, s[8:11], s69 offen offset:0  lds
    v_mfma_f32_16x16x32_bf16 v[204:207], v[68:71], a[232:235], 0
    ds_read_b64_tr_b16 a[230:231], v220 offset:3072
    v_mul_f32 v0, v0, v8
    v_mfma_f32_16x16x32_bf16 v[180:183], a[236:239], v[68:71], 0
    ds_read_b64_tr_b16 a[232:233], v221 offset:2048
    s_add_u32 s69, s68, 55296
    v_mfma_f32_16x16x32_bf16 v[176:179], a[236:239], v[64:67], 0
    ds_read_b64_tr_b16 a[234:235], v221 offset:3072
    v_mul_f32 v1, v1, v9
    v_mfma_f32_16x16x32_bf16 v[184:187], a[240:243], v[64:67], 0
    ds_read_b64_tr_b16 a[236:237], v222 offset:2048
    buffer_load_dwordx4 v229, s[8:11], s69 offen offset:1024  lds
    v_mfma_f32_16x16x32_bf16 v[188:191], a[240:243], v[68:71], 0
    ds_read_b64_tr_b16 a[238:239], v222 offset:3072
    v_mul_f32 v2, v2, v10
    v_mfma_f32_16x16x32_bf16 v[164:167], v[76:79], a[244:247], v[164:167]
    ds_read_b64_tr_b16 a[240:241], v216 offset:4096
    s_add_u32 s69, s68, 110592
    v_mul_f32 v3, v3, v11
    v_mfma_f32_16x16x32_bf16 v[160:163], v[72:75], a[244:247], v[160:163]
    ds_read_b64_tr_b16 a[242:243], v216 offset:5120
    buffer_load_dwordx4 v230, s[8:11], s69 offen offset:2048  lds
    s_waitcnt lgkmcnt(6)
    v_mfma_f32_16x16x32_bf16 v[168:171], v[72:75], a[216:219], v[168:171]
    ds_read_b64_tr_b16 a[244:245], v217 offset:4096
    v_cvt_pk_bf16_f32 v128, v0, v1
    v_mfma_f32_16x16x32_bf16 v[172:175], v[76:79], a[216:219], v[172:175]
    ds_read_b64_tr_b16 a[246:247], v217 offset:5120
    s_add_u32 s69, s68, 165888
    v_mfma_f32_16x16x32_bf16 v[148:151], v[76:79], a[220:223], v[148:151]
    ds_read_b64_tr_b16 a[216:217], v218 offset:4096
    v_cvt_pk_bf16_f32 v129, v2, v3
    v_mfma_f32_16x16x32_bf16 v[144:147], v[72:75], a[220:223], v[144:147]
    ds_read_b64_tr_b16 a[218:219], v218 offset:5120
    buffer_load_dwordx4 v231, s[8:11], s69 offen offset:3072  lds
    v_mul_f32 v4, v4, v12
    v_mfma_f32_16x16x32_bf16 v[152:155], v[72:75], a[224:227], v[152:155]
    ds_read_b64_tr_b16 a[220:221], v219 offset:4096
    s_add_u32 m0, s39, 102400
    v_mfma_f32_16x16x32_bf16 v[156:159], v[76:79], a[224:227], v[156:159]
    ds_read_b64_tr_b16 a[222:223], v219 offset:5120
    v_mul_f32 v5, v5, v13
    v_mfma_f32_16x16x32_bf16 v[204:207], v[76:79], a[228:231], v[204:207]
    ds_read_b64_tr_b16 a[224:225], v220 offset:4096
    s_add_u32 s69, s68, 221184
    v_mfma_f32_16x16x32_bf16 v[200:203], v[72:75], a[228:231], v[200:203]
    ds_read_b64_tr_b16 a[226:227], v220 offset:5120
    buffer_load_dwordx4 v228, s[8:11], s69 offen offset:0  lds
    s_waitcnt lgkmcnt(6)
    v_mfma_f32_16x16x32_bf16 v[176:179], a[232:235], v[72:75], v[176:179]
    ds_read_b64_tr_b16 a[228:229], v221 offset:4096
    v_mul_f32 v6, v6, v14
    v_mfma_f32_16x16x32_bf16 v[180:183], a[232:235], v[76:79], v[180:183]
    ds_read_b64_tr_b16 a[230:231], v221 offset:5120
    s_add_u32 s69, s68, 276480
    v_mfma_f32_16x16x32_bf16 v[188:191], a[236:239], v[76:79], v[188:191]
    ds_read_b64_tr_b16 a[232:233], v222 offset:4096
    v_mul_f32 v7, v7, v15
    v_mfma_f32_16x16x32_bf16 v[184:187], a[236:239], v[72:75], v[184:187]
    ds_read_b64_tr_b16 a[234:235], v222 offset:5120
    buffer_load_dwordx4 v229, s[8:11], s69 offen offset:1024  lds
    v_mfma_f32_16x16x32_bf16 v[160:163], v[80:83], a[240:243], v[160:163]
    s_waitcnt vmcnt(20)
    s_barrier
    ds_read_b64_tr_b16 a[236:237], v216 offset:24576
    v_cvt_pk_bf16_f32 v132, v4, v5
    v_mfma_f32_16x16x32_bf16 v[164:167], v[84:87], a[240:243], v[164:167]
    ds_read_b64_tr_b16 a[238:239], v216 offset:25600
    v_cvt_pk_bf16_f32 v133, v6, v7
    v_mfma_f32_16x16x32_bf16 v[172:175], v[84:87], a[244:247], v[172:175]
    ds_read_b64_tr_b16 a[240:241], v217 offset:24576
    s_add_u32 m0, s39, 122880
    v_mfma_f32_16x16x32_bf16 v[168:171], v[80:83], a[244:247], v[168:171]
    ds_read_b64_tr_b16 a[242:243], v217 offset:25600
    v_mul_f32 v16, v16, v24
    s_waitcnt lgkmcnt(6)
    v_mfma_f32_16x16x32_bf16 v[144:147], v[80:83], a[216:219], v[144:147]
    ds_read_b64_tr_b16 a[244:245], v218 offset:24576
    s_add_u32 s69, s68, 331776
    v_mfma_f32_16x16x32_bf16 v[148:151], v[84:87], a[216:219], v[148:151]
    ds_read_b64_tr_b16 a[246:247], v218 offset:25600
    v_mul_f32 v17, v17, v25
    v_mfma_f32_16x16x32_bf16 v[156:159], v[84:87], a[220:223], v[156:159]
    ds_read_b64_tr_b16 a[216:217], v219 offset:24576
    buffer_load_dwordx4 v228, s[8:11], s69 offen offset:0  lds
    v_mfma_f32_16x16x32_bf16 v[152:155], v[80:83], a[220:223], v[152:155]
    ds_read_b64_tr_b16 a[218:219], v219 offset:25600
    v_mul_f32 v18, v18, v26
    v_mfma_f32_16x16x32_bf16 v[200:203], v[80:83], a[224:227], v[200:203]
    ds_read_b64_tr_b16 a[220:221], v220 offset:24576
    v_mul_f32 v19, v19, v27
    v_mfma_f32_16x16x32_bf16 v[204:207], v[84:87], a[224:227], v[204:207]
    ds_read_b64_tr_b16 a[222:223], v220 offset:25600
    v_cvt_pk_bf16_f32 v130, v16, v17
    v_mfma_f32_16x16x32_bf16 v[180:183], a[228:231], v[84:87], v[180:183]
    ds_read_b64_tr_b16 a[224:225], v221 offset:24576
    s_add_u32 s69, s68, 387072
    v_mfma_f32_16x16x32_bf16 v[176:179], a[228:231], v[80:83], v[176:179]
    ds_read_b64_tr_b16 a[226:227], v221 offset:25600
    v_cvt_pk_bf16_f32 v131, v18, v19
    s_waitcnt lgkmcnt(6)
    v_mfma_f32_16x16x32_bf16 v[184:187], a[232:235], v[80:83], v[184:187]
    ds_read_b64_tr_b16 a[228:229], v222 offset:24576
    v_mfma_f32_16x16x32_bf16 v[188:191], a[232:235], v[84:87], v[188:191]
    ds_read_b64_tr_b16 a[230:231], v222 offset:25600
    buffer_load_dwordx4 v229, s[8:11], s69 offen offset:1024  lds
    v_mfma_f32_16x16x32_bf16 v[164:167], v[92:95], a[236:239], v[164:167]
    ds_read_b64_tr_b16 a[232:233], v216 offset:26624
    v_mul_f32 v20, v20, v28
    v_mfma_f32_16x16x32_bf16 v[160:163], v[88:91], a[236:239], v[160:163]
    ds_read_b64_tr_b16 a[234:235], v216 offset:27648
    v_mul_f32 v21, v21, v29
    v_mfma_f32_16x16x32_bf16 v[168:171], v[88:91], a[240:243], v[168:171]
    ds_read_b64_tr_b16 a[236:237], v217 offset:26624
    v_mfma_f32_16x16x32_bf16 v[172:175], v[92:95], a[240:243], v[172:175]
    ds_read_b64_tr_b16 a[238:239], v217 offset:27648
    s_add_u32 s69, s68, 442368
    v_mfma_f32_16x16x32_bf16 v[148:151], v[92:95], a[244:247], v[148:151]
    ds_read_b64_tr_b16 a[240:241], v218 offset:26624
    v_mul_f32 v22, v22, v30
    v_mfma_f32_16x16x32_bf16 v[144:147], v[88:91], a[244:247], v[144:147]
    ds_read_b64_tr_b16 a[242:243], v218 offset:27648
    v_mul_f32 v23, v23, v31
    s_waitcnt lgkmcnt(6)
    v_mfma_f32_16x16x32_bf16 v[152:155], v[88:91], a[216:219], v[152:155]
    ds_read_b64_tr_b16 a[244:245], v219 offset:26624
    buffer_load_dwordx4 v230, s[8:11], s69 offen offset:2048  lds
    v_mfma_f32_16x16x32_bf16 v[156:159], v[92:95], a[216:219], v[156:159]
    ds_read_b64_tr_b16 a[246:247], v219 offset:27648
    v_cvt_pk_bf16_f32 v134, v20, v21
    v_mfma_f32_16x16x32_bf16 v[204:207], v[92:95], a[220:223], v[204:207]
    ds_read_b64_tr_b16 a[216:217], v220 offset:26624
    v_cvt_pk_bf16_f32 v135, v22, v23
    v_mfma_f32_16x16x32_bf16 v[200:203], v[88:91], a[220:223], v[200:203]
    ds_read_b64_tr_b16 a[218:219], v220 offset:27648
    v_mfma_f32_16x16x32_bf16 v[176:179], a[224:227], v[88:91], v[176:179]
    ds_read_b64_tr_b16 a[220:221], v221 offset:26624
    s_add_u32 s69, s68, 497664
    v_mfma_f32_16x16x32_bf16 v[180:183], a[224:227], v[92:95], v[180:183]
    ds_read_b64_tr_b16 a[222:223], v221 offset:27648
    v_mul_f32 v32, v32, v40
    v_mfma_f32_16x16x32_bf16 v[188:191], a[228:231], v[92:95], v[188:191]
    ds_read_b64_tr_b16 a[224:225], v222 offset:26624
    v_mul_f32 v33, v33, v41
    v_mfma_f32_16x16x32_bf16 v[184:187], a[228:231], v[88:91], v[184:187]
    ds_read_b64_tr_b16 a[226:227], v222 offset:27648
    buffer_load_dwordx4 v231, s[8:11], s69 offen offset:3072  lds
    s_waitcnt lgkmcnt(6)
    v_mfma_f32_16x16x32_bf16 v[160:163], v[96:99], a[232:235], v[160:163]
    ds_read_b64_tr_b16 a[228:229], v216 offset:28672
    v_mul_f32 v34, v34, v42
    v_mfma_f32_16x16x32_bf16 v[164:167], v[100:103], a[232:235], v[164:167]
    ds_read_b64_tr_b16 a[230:231], v216 offset:29696
    s_add_u32 m0, s39, 126976
    v_mfma_f32_16x16x32_bf16 v[172:175], v[100:103], a[236:239], v[172:175]
    ds_read_b64_tr_b16 a[232:233], v217 offset:28672
    v_mul_f32 v35, v35, v43
    v_mfma_f32_16x16x32_bf16 v[168:171], v[96:99], a[236:239], v[168:171]
    ds_read_b64_tr_b16 a[234:235], v217 offset:29696
    v_cvt_pk_bf16_f32 v136, v32, v33
    v_mfma_f32_16x16x32_bf16 v[144:147], v[96:99], a[240:243], v[144:147]
    ds_read_b64_tr_b16 a[236:237], v218 offset:28672
    s_add_u32 s69, s68, 552960
    v_mfma_f32_16x16x32_bf16 v[148:151], v[100:103], a[240:243], v[148:151]
    ds_read_b64_tr_b16 a[238:239], v218 offset:29696
    v_cvt_pk_bf16_f32 v137, v34, v35
    v_mfma_f32_16x16x32_bf16 v[156:159], v[100:103], a[244:247], v[156:159]
    ds_read_b64_tr_b16 a[240:241], v219 offset:28672
    buffer_load_dwordx4 v228, s[8:11], s69 offen offset:0  lds
    v_mfma_f32_16x16x32_bf16 v[152:155], v[96:99], a[244:247], v[152:155]
    ds_read_b64_tr_b16 a[242:243], v219 offset:29696
    v_mul_f32 v36, v36, v44
    s_waitcnt lgkmcnt(6)
    v_mfma_f32_16x16x32_bf16 v[200:203], v[96:99], a[216:219], v[200:203]
    ds_read_b64_tr_b16 a[244:245], v220 offset:28672
    v_mfma_f32_16x16x32_bf16 v[204:207], v[100:103], a[216:219], v[204:207]
    ds_read_b64_tr_b16 a[246:247], v220 offset:29696
    s_add_u32 s69, s68, 608256
    v_mfma_f32_16x16x32_bf16 v[180:183], a[220:223], v[100:103], v[180:183]
    ds_read_b64_tr_b16 a[216:217], v221 offset:28672
    v_mul_f32 v37, v37, v45
    v_mfma_f32_16x16x32_bf16 v[176:179], a[220:223], v[96:99], v[176:179]
    ds_read_b64_tr_b16 a[218:219], v221 offset:29696
    v_mul_f32 v38, v38, v46
    v_mfma_f32_16x16x32_bf16 v[184:187], a[224:227], v[96:99], v[184:187]
    ds_read_b64_tr_b16 a[220:221], v222 offset:28672
    buffer_load_dwordx4 v229, s[8:11], s69 offen offset:1024  lds
    v_mfma_f32_16x16x32_bf16 v[188:191], a[224:227], v[100:103], v[188:191]
    ds_read_b64_tr_b16 a[222:223], v222 offset:29696
    v_mul_f32 v39, v39, v47
    v_mfma_f32_16x16x32_bf16 v[164:167], v[108:111], a[228:231], v[164:167]
    s_waitcnt vmcnt(20)
    s_barrier
    v_add_u32 v216, 0xc000, v216
    ds_read_b64_tr_b16 a[224:225], v216 offset:0
    v_cvt_pk_bf16_f32 v140, v36, v37
    v_mfma_f32_16x16x32_bf16 v[160:163], v[104:107], a[228:231], v[160:163]
    ds_read_b64_tr_b16 a[226:227], v216 offset:1024
    s_add_u32 m0, s39, 0
    s_waitcnt lgkmcnt(6)
    v_mfma_f32_16x16x32_bf16 v[168:171], v[104:107], a[232:235], v[168:171]
    v_add_u32 v217, 0xc000, v217
    ds_read_b64_tr_b16 a[228:229], v217 offset:0
    v_add_u32 v224, 128, v224
    v_cvt_pk_bf16_f32 v141, v38, v39
    v_mfma_f32_16x16x32_bf16 v[172:175], v[108:111], a[232:235], v[172:175]
    ds_read_b64_tr_b16 a[230:231], v217 offset:1024
    v_add_u32 v225, 128, v225
    v_mfma_f32_16x16x32_bf16 v[148:151], v[108:111], a[236:239], v[148:151]
    v_add_u32 v218, 0xc000, v218
    ds_read_b64_tr_b16 a[232:233], v218 offset:0
    v_add_u32 v226, 128, v226
    v_mul_f32 v48, v48, v56
    v_mfma_f32_16x16x32_bf16 v[144:147], v[104:107], a[236:239], v[144:147]
    ds_read_b64_tr_b16 a[234:235], v218 offset:1024
    v_add_u32 v227, 128, v227
    v_mul_f32 v49, v49, v57
    v_mfma_f32_16x16x32_bf16 v[152:155], v[104:107], a[240:243], v[152:155]
    v_add_u32 v219, 0xc000, v219
    ds_read_b64_tr_b16 a[236:237], v219 offset:0
    buffer_load_dwordx4 v224, s[16:19], s48 offen offset:0  lds
    v_mfma_f32_16x16x32_bf16 v[156:159], v[108:111], a[240:243], v[156:159]
    ds_read_b64_tr_b16 a[238:239], v219 offset:1024
    v_mul_f32 v50, v50, v58
    v_mfma_f32_16x16x32_bf16 v[204:207], v[108:111], a[244:247], v[204:207]
    v_add_u32 v220, 0xc000, v220
    ds_read_b64_tr_b16 a[240:241], v220 offset:0
    v_mfma_f32_16x16x32_bf16 v[200:203], v[104:107], a[244:247], v[200:203]
    ds_read_b64_tr_b16 a[242:243], v220 offset:1024
    v_mul_f32 v51, v51, v59
    s_waitcnt lgkmcnt(6)
    v_mfma_f32_16x16x32_bf16 v[176:179], a[216:219], v[104:107], v[176:179]
    v_add_u32 v221, 0xc000, v221
    ds_read_b64_tr_b16 a[244:245], v221 offset:0
    v_mfma_f32_16x16x32_bf16 v[180:183], a[216:219], v[108:111], v[180:183]
    ds_read_b64_tr_b16 a[246:247], v221 offset:1024
    v_cvt_pk_bf16_f32 v138, v48, v49
    v_mfma_f32_16x16x32_bf16 v[188:191], a[220:223], v[108:111], v[188:191]
    v_add_u32 v222, 0xc000, v222
    ds_read_b64_tr_b16 a[216:217], v222 offset:0
    v_mfma_f32_16x16x32_bf16 v[184:187], a[220:223], v[104:107], v[184:187]
    ds_read_b64_tr_b16 a[218:219], v222 offset:1024
    buffer_load_dwordx4 v225, s[20:23], s48 offen offset:1024  lds
    v_mfma_f32_16x16x32_bf16 v[160:163], v[112:115], a[224:227], v[160:163]
    ds_read_b64_tr_b16 a[220:221], v216 offset:2048
    v_cvt_pk_bf16_f32 v139, v50, v51
    v_mfma_f32_16x16x32_bf16 v[164:167], v[116:119], a[224:227], v[164:167]
    ds_read_b64_tr_b16 a[222:223], v216 offset:3072
    v_mul_f32 v52, v52, v60
    v_mfma_f32_16x16x32_bf16 v[172:175], v[116:119], a[228:231], v[172:175]
    ds_read_b64_tr_b16 a[224:225], v217 offset:2048
    v_mul_f32 v53, v53, v61
    v_mfma_f32_16x16x32_bf16 v[168:171], v[112:115], a[228:231], v[168:171]
    ds_read_b64_tr_b16 a[226:227], v217 offset:3072
    s_waitcnt lgkmcnt(6)
    v_mfma_f32_16x16x32_bf16 v[144:147], v[112:115], a[232:235], v[144:147]
    ds_read_b64_tr_b16 a[228:229], v218 offset:2048
    v_mul_f32 v54, v54, v62
    v_mfma_f32_16x16x32_bf16 v[148:151], v[116:119], a[232:235], v[148:151]
    ds_read_b64_tr_b16 a[230:231], v218 offset:3072
    v_mfma_f32_16x16x32_bf16 v[156:159], v[116:119], a[236:239], v[156:159]
    ds_read_b64_tr_b16 a[232:233], v219 offset:2048
    buffer_load_dwordx4 v226, s[16:19], s49 offen offset:2048  lds
    v_mfma_f32_16x16x32_bf16 v[152:155], v[112:115], a[236:239], v[152:155]
    ds_read_b64_tr_b16 a[234:235], v219 offset:3072
    v_mul_f32 v55, v55, v63
    v_mfma_f32_16x16x32_bf16 v[200:203], v[112:115], a[240:243], v[200:203]
    ds_read_b64_tr_b16 a[236:237], v220 offset:2048
    v_cvt_pk_bf16_f32 v142, v52, v53
    v_mfma_f32_16x16x32_bf16 v[204:207], v[116:119], a[240:243], v[204:207]
    ds_read_b64_tr_b16 a[238:239], v220 offset:3072
    v_mfma_f32_16x16x32_bf16 v[180:183], a[244:247], v[116:119], v[180:183]
    ds_read_b64_tr_b16 a[240:241], v221 offset:2048
    v_cvt_pk_bf16_f32 v143, v54, v55
    v_mfma_f32_16x16x32_bf16 v[176:179], a[244:247], v[112:115], v[176:179]
    ds_read_b64_tr_b16 a[242:243], v221 offset:3072
    v_accvgpr_write_b32 a0, v64
    s_waitcnt lgkmcnt(6)
    v_mfma_f32_16x16x32_bf16 v[184:187], a[216:219], v[112:115], v[184:187]
    ds_read_b64_tr_b16 a[244:245], v222 offset:2048
    v_accvgpr_write_b32 a1, v65
    v_mfma_f32_16x16x32_bf16 v[188:191], a[216:219], v[116:119], v[188:191]
    ds_read_b64_tr_b16 a[246:247], v222 offset:3072
    buffer_load_dwordx4 v227, s[20:23], s49 offen offset:3072  lds
    v_mfma_f32_16x16x32_bf16 v[164:167], v[124:127], a[220:223], v[164:167]
    ds_read_b64_tr_b16 a[216:217], v216 offset:4096
    v_accvgpr_write_b32 a2, v66
    v_mfma_f32_16x16x32_bf16 v[160:163], v[120:123], a[220:223], v[160:163]
    ds_read_b64_tr_b16 a[218:219], v216 offset:5120
    v_accvgpr_write_b32 a3, v67
    v_mfma_f32_16x16x32_bf16 v[168:171], v[120:123], a[224:227], v[168:171]
    ds_read_b64_tr_b16 a[220:221], v217 offset:4096
    v_accvgpr_write_b32 a4, v68
    v_mfma_f32_16x16x32_bf16 v[172:175], v[124:127], a[224:227], v[172:175]
    ds_read_b64_tr_b16 a[222:223], v217 offset:5120
    s_add_u32 m0, s39, 4096
    v_mfma_f32_16x16x32_bf16 v[148:151], v[124:127], a[228:231], v[148:151]
    ds_read_b64_tr_b16 a[224:225], v218 offset:4096
    v_accvgpr_write_b32 a5, v69
    v_mfma_f32_16x16x32_bf16 v[144:147], v[120:123], a[228:231], v[144:147]
    ds_read_b64_tr_b16 a[226:227], v218 offset:5120
    v_accvgpr_write_b32 a6, v70
    s_waitcnt lgkmcnt(6)
    v_mfma_f32_16x16x32_bf16 v[152:155], v[120:123], a[232:235], v[152:155]
    ds_read_b64_tr_b16 a[228:229], v219 offset:4096
    buffer_load_dwordx4 v224, s[16:19], s50 offen offset:0  lds
    v_mfma_f32_16x16x32_bf16 v[156:159], v[124:127], a[232:235], v[156:159]
    ds_read_b64_tr_b16 a[230:231], v219 offset:5120
    v_accvgpr_write_b32 a7, v71
    v_mfma_f32_16x16x32_bf16 v[204:207], v[124:127], a[236:239], v[204:207]
    ds_read_b64_tr_b16 a[232:233], v220 offset:4096
    v_accvgpr_write_b32 a8, v72
    v_mfma_f32_16x16x32_bf16 v[200:203], v[120:123], a[236:239], v[200:203]
    ds_read_b64_tr_b16 a[234:235], v220 offset:5120
    v_accvgpr_write_b32 a9, v73
    v_mfma_f32_16x16x32_bf16 v[176:179], a[240:243], v[120:123], v[176:179]
    ds_read_b64_tr_b16 a[236:237], v221 offset:4096
    v_accvgpr_write_b32 a10, v74
    v_mfma_f32_16x16x32_bf16 v[180:183], a[240:243], v[124:127], v[180:183]
    ds_read_b64_tr_b16 a[238:239], v221 offset:5120
    v_accvgpr_write_b32 a11, v75
    v_mfma_f32_16x16x32_bf16 v[188:191], a[244:247], v[124:127], v[188:191]
    ds_read_b64_tr_b16 a[240:241], v222 offset:4096
    buffer_load_dwordx4 v225, s[20:23], s50 offen offset:1024  lds
    v_mfma_f32_16x16x32_bf16 v[184:187], a[244:247], v[120:123], v[184:187]
    ds_read_b64_tr_b16 a[242:243], v222 offset:5120
    v_accvgpr_write_b32 a12, v76
    s_waitcnt lgkmcnt(6)
    v_mfma_f32_16x16x32_bf16 v[160:163], a[64:67], a[216:219], v[160:163]
    s_waitcnt vmcnt(20)
    s_barrier
    ds_read_b64_tr_b16 a[244:245], v216 offset:24576
    v_accvgpr_write_b32 a13, v77
    v_mfma_f32_16x16x32_bf16 v[164:167], a[68:71], a[216:219], v[164:167]
    ds_read_b64_tr_b16 a[246:247], v216 offset:25600
    v_accvgpr_write_b32 a14, v78
    v_mfma_f32_16x16x32_bf16 v[172:175], a[68:71], a[220:223], v[172:175]
    ds_read_b64_tr_b16 a[216:217], v217 offset:24576
    s_add_u32 m0, s39, 24576
    v_mfma_f32_16x16x32_bf16 v[168:171], a[64:67], a[220:223], v[168:171]
    ds_read_b64_tr_b16 a[218:219], v217 offset:25600
    v_accvgpr_write_b32 a15, v79
    v_accvgpr_write_b32 a16, v80
    v_mfma_f32_16x16x32_bf16 v[144:147], a[64:67], a[224:227], v[144:147]
    ds_read_b64_tr_b16 a[220:221], v218 offset:24576
    buffer_load_dwordx4 v224, s[16:19], s51 offen offset:0  lds
    v_mfma_f32_16x16x32_bf16 v[148:151], a[68:71], a[224:227], v[148:151]
    ds_read_b64_tr_b16 a[222:223], v218 offset:25600
    v_accvgpr_write_b32 a17, v81
    v_mfma_f32_16x16x32_bf16 v[156:159], a[68:71], a[228:231], v[156:159]
    ds_read_b64_tr_b16 a[224:225], v219 offset:24576
    v_accvgpr_write_b32 a18, v82
    v_mfma_f32_16x16x32_bf16 v[152:155], a[64:67], a[228:231], v[152:155]
    ds_read_b64_tr_b16 a[226:227], v219 offset:25600
    buffer_load_dwordx4 v225, s[20:23], s51 offen offset:1024  lds
    s_waitcnt lgkmcnt(6)
    v_mfma_f32_16x16x32_bf16 v[200:203], a[64:67], a[232:235], v[200:203]
    ds_read_b64_tr_b16 a[228:229], v220 offset:24576
    v_accvgpr_write_b32 a19, v83
    v_mfma_f32_16x16x32_bf16 v[204:207], a[68:71], a[232:235], v[204:207]
    ds_read_b64_tr_b16 a[230:231], v220 offset:25600
    v_accvgpr_write_b32 a20, v84
    v_mfma_f32_16x16x32_bf16 v[180:183], a[236:239], a[68:71], v[180:183]
    ds_read_b64_tr_b16 a[232:233], v221 offset:24576
    v_accvgpr_write_b32 a21, v85
    v_mfma_f32_16x16x32_bf16 v[176:179], a[236:239], a[64:67], v[176:179]
    ds_read_b64_tr_b16 a[234:235], v221 offset:25600
    buffer_load_dwordx4 v226, s[16:19], s52 offen offset:2048  lds
    v_mfma_f32_16x16x32_bf16 v[184:187], a[240:243], a[64:67], v[184:187]
    ds_read_b64_tr_b16 a[236:237], v222 offset:24576
    v_accvgpr_write_b32 a22, v86
    v_mfma_f32_16x16x32_bf16 v[188:191], a[240:243], a[68:71], v[188:191]
    ds_read_b64_tr_b16 a[238:239], v222 offset:25600
    v_accvgpr_write_b32 a23, v87
    v_mfma_f32_16x16x32_bf16 v[164:167], a[76:79], a[244:247], v[164:167]
    ds_read_b64_tr_b16 a[240:241], v216 offset:26624
    v_accvgpr_write_b32 a24, v88
    v_accvgpr_write_b32 a25, v89
    v_mfma_f32_16x16x32_bf16 v[160:163], a[72:75], a[244:247], v[160:163]
    ds_read_b64_tr_b16 a[242:243], v216 offset:27648
    buffer_load_dwordx4 v227, s[20:23], s52 offen offset:3072  lds
    s_waitcnt lgkmcnt(6)
    v_mfma_f32_16x16x32_bf16 v[168:171], a[72:75], a[216:219], v[168:171]
    ds_read_b64_tr_b16 a[244:245], v217 offset:26624
    v_accvgpr_write_b32 a26, v90
    v_mfma_f32_16x16x32_bf16 v[172:175], a[76:79], a[216:219], v[172:175]
    ds_read_b64_tr_b16 a[246:247], v217 offset:27648
    s_add_u32 m0, s39, 28672
    v_accvgpr_write_b32 a27, v91
    v_mfma_f32_16x16x32_bf16 v[148:151], a[76:79], a[220:223], v[148:151]
    ds_read_b64_tr_b16 a[216:217], v218 offset:26624
    buffer_load_dwordx4 v224, s[16:19], s53 offen offset:0  lds
    v_mfma_f32_16x16x32_bf16 v[144:147], a[72:75], a[220:223], v[144:147]
    ds_read_b64_tr_b16 a[218:219], v218 offset:27648
    v_accvgpr_write_b32 a28, v92
    v_mfma_f32_16x16x32_bf16 v[152:155], a[72:75], a[224:227], v[152:155]
    ds_read_b64_tr_b16 a[220:221], v219 offset:26624
    v_accvgpr_write_b32 a29, v93
    v_mfma_f32_16x16x32_bf16 v[156:159], a[76:79], a[224:227], v[156:159]
    ds_read_b64_tr_b16 a[222:223], v219 offset:27648
    v_accvgpr_write_b32 a30, v94
    v_mfma_f32_16x16x32_bf16 v[204:207], a[76:79], a[228:231], v[204:207]
    ds_read_b64_tr_b16 a[224:225], v220 offset:26624
    buffer_load_dwordx4 v225, s[20:23], s53 offen offset:1024  lds
    v_mfma_f32_16x16x32_bf16 v[200:203], a[72:75], a[228:231], v[200:203]
    ds_read_b64_tr_b16 a[226:227], v220 offset:27648
    v_accvgpr_write_b32 a31, v95
    v_accvgpr_write_b32 a32, v96
    s_waitcnt lgkmcnt(6)
    v_mfma_f32_16x16x32_bf16 v[176:179], a[232:235], a[72:75], v[176:179]
    ds_read_b64_tr_b16 a[228:229], v221 offset:26624
    v_accvgpr_read_b32 v254, a170
    v_accvgpr_write_b32 a33, v97
    v_mfma_f32_16x16x32_bf16 v[180:183], a[232:235], a[76:79], v[180:183]
    ds_read_b64_tr_b16 a[230:231], v221 offset:27648
    buffer_load_dword a215, v254, s[16:19], s100 offen offset:256
    v_mfma_f32_16x16x32_bf16 v[188:191], a[236:239], a[76:79], v[188:191]
    ds_read_b64_tr_b16 a[232:233], v222 offset:26624
    buffer_load_dword a215, v254, s[20:23], s100 offen offset:256
    v_mfma_f32_16x16x32_bf16 v[184:187], a[236:239], a[72:75], v[184:187]
    ds_read_b64_tr_b16 a[234:235], v222 offset:27648
    v_accvgpr_write_b32 a34, v98
    v_mfma_f32_16x16x32_bf16 v[160:163], a[80:83], a[240:243], v[160:163]
    ds_read_b64_tr_b16 a[236:237], v216 offset:28672
    v_accvgpr_write_b32 a35, v99
    v_mfma_f32_16x16x32_bf16 v[164:167], a[84:87], a[240:243], v[164:167]
    ds_read_b64_tr_b16 a[238:239], v216 offset:29696
    v_accvgpr_write_b32 a36, v100
    v_mfma_f32_16x16x32_bf16 v[172:175], a[84:87], a[244:247], v[172:175]
    ds_read_b64_tr_b16 a[240:241], v217 offset:28672
    v_accvgpr_write_b32 a37, v101
    v_mfma_f32_16x16x32_bf16 v[168:171], a[80:83], a[244:247], v[168:171]
    ds_read_b64_tr_b16 a[242:243], v217 offset:29696
    v_accvgpr_write_b32 a38, v102
    s_waitcnt lgkmcnt(6)
    v_mfma_f32_16x16x32_bf16 v[144:147], a[80:83], a[216:219], v[144:147]
    ds_read_b64_tr_b16 a[244:245], v218 offset:28672
    v_accvgpr_write_b32 a39, v103
    v_mfma_f32_16x16x32_bf16 v[148:151], a[84:87], a[216:219], v[148:151]
    ds_read_b64_tr_b16 a[246:247], v218 offset:29696
    v_accvgpr_write_b32 a40, v104
    v_mfma_f32_16x16x32_bf16 v[156:159], a[84:87], a[220:223], v[156:159]
    ds_read_b64_tr_b16 a[216:217], v219 offset:28672
    v_accvgpr_write_b32 a41, v105
    v_mfma_f32_16x16x32_bf16 v[152:155], a[80:83], a[220:223], v[152:155]
    ds_read_b64_tr_b16 a[218:219], v219 offset:29696
    v_mfma_f32_16x16x32_bf16 v[200:203], a[80:83], a[224:227], v[200:203]
    ds_read_b64_tr_b16 a[220:221], v220 offset:28672
    v_accvgpr_write_b32 a42, v106
    v_mfma_f32_16x16x32_bf16 v[204:207], a[84:87], a[224:227], v[204:207]
    ds_read_b64_tr_b16 a[222:223], v220 offset:29696
    v_accvgpr_write_b32 a43, v107
    v_mfma_f32_16x16x32_bf16 v[180:183], a[228:231], a[84:87], v[180:183]
    ds_read_b64_tr_b16 a[224:225], v221 offset:28672
    v_accvgpr_write_b32 a44, v108
    v_mfma_f32_16x16x32_bf16 v[176:179], a[228:231], a[80:83], v[176:179]
    ds_read_b64_tr_b16 a[226:227], v221 offset:29696
    v_accvgpr_write_b32 a45, v109
    s_waitcnt lgkmcnt(6)
    v_mfma_f32_16x16x32_bf16 v[184:187], a[232:235], a[80:83], v[184:187]
    ds_read_b64_tr_b16 a[228:229], v222 offset:28672
    v_mfma_f32_16x16x32_bf16 v[188:191], a[232:235], a[84:87], v[188:191]
    ds_read_b64_tr_b16 a[230:231], v222 offset:29696
    v_accvgpr_write_b32 a46, v110
    v_mfma_f32_16x16x32_bf16 v[164:167], a[92:95], a[236:239], v[164:167]
    s_waitcnt vmcnt(20)
    s_barrier
    v_add_u32 v216, 0xc000, v216
    ds_read_b64_tr_b16 a[232:233], v216 offset:0
    v_accvgpr_write_b32 a47, v111
    v_mfma_f32_16x16x32_bf16 v[160:163], a[88:91], a[236:239], v[160:163]
    ds_read_b64_tr_b16 a[234:235], v216 offset:1024
    v_accvgpr_write_b32 a48, v112
    v_mfma_f32_16x16x32_bf16 v[168:171], a[88:91], a[240:243], v[168:171]
    v_add_u32 v217, 0xc000, v217
    ds_read_b64_tr_b16 a[236:237], v217 offset:0
    v_accvgpr_write_b32 a49, v113
    v_mfma_f32_16x16x32_bf16 v[172:175], a[92:95], a[240:243], v[172:175]
    ds_read_b64_tr_b16 a[238:239], v217 offset:1024
    v_mfma_f32_16x16x32_bf16 v[148:151], a[92:95], a[244:247], v[148:151]
    v_add_u32 v218, 0xc000, v218
    ds_read_b64_tr_b16 a[240:241], v218 offset:0
    v_accvgpr_write_b32 a50, v114
    v_mfma_f32_16x16x32_bf16 v[144:147], a[88:91], a[244:247], v[144:147]
    ds_read_b64_tr_b16 a[242:243], v218 offset:1024
    v_accvgpr_write_b32 a51, v115
    s_waitcnt lgkmcnt(6)
    v_mfma_f32_16x16x32_bf16 v[152:155], a[88:91], a[216:219], v[152:155]
    v_add_u32 v219, 0xc000, v219
    ds_read_b64_tr_b16 a[244:245], v219 offset:0
    v_accvgpr_write_b32 a52, v116
    v_mfma_f32_16x16x32_bf16 v[156:159], a[92:95], a[216:219], v[156:159]
    ds_read_b64_tr_b16 a[246:247], v219 offset:1024
    v_accvgpr_write_b32 a53, v117
    v_mfma_f32_16x16x32_bf16 v[204:207], a[92:95], a[220:223], v[204:207]
    v_add_u32 v220, 0xc000, v220
    ds_read_b64_tr_b16 a[216:217], v220 offset:0
    v_mfma_f32_16x16x32_bf16 v[200:203], a[88:91], a[220:223], v[200:203]
    ds_read_b64_tr_b16 a[218:219], v220 offset:1024
    v_accvgpr_write_b32 a54, v118
    v_mfma_f32_16x16x32_bf16 v[176:179], a[224:227], a[88:91], v[176:179]
    v_add_u32 v221, 0xc000, v221
    ds_read_b64_tr_b16 a[220:221], v221 offset:0
    v_accvgpr_write_b32 a55, v119
    v_mfma_f32_16x16x32_bf16 v[180:183], a[224:227], a[92:95], v[180:183]
    ds_read_b64_tr_b16 a[222:223], v221 offset:1024
    v_accvgpr_write_b32 a56, v120
    v_mfma_f32_16x16x32_bf16 v[188:191], a[228:231], a[92:95], v[188:191]
    v_add_u32 v222, 0xc000, v222
    ds_read_b64_tr_b16 a[224:225], v222 offset:0
    v_accvgpr_write_b32 a57, v121
    v_mfma_f32_16x16x32_bf16 v[184:187], a[228:231], a[88:91], v[184:187]
    ds_read_b64_tr_b16 a[226:227], v222 offset:1024
    s_add_u32 s92, s92, 16384
    s_addc_u32 s93, s93, 0
    v_mov_b32 v254, s91
    global_load_dword a215, v254, s[92:93]
    s_waitcnt lgkmcnt(6)
    v_mfma_f32_16x16x32_bf16 v[160:163], a[96:99], a[232:235], v[160:163]
    ds_read_b64_tr_b16 a[228:229], v216 offset:2048
    v_accvgpr_write_b32 a58, v122
    v_mfma_f32_16x16x32_bf16 v[164:167], a[100:103], a[232:235], v[164:167]
    ds_read_b64_tr_b16 a[230:231], v216 offset:3072
    v_accvgpr_write_b32 a59, v123
    v_mfma_f32_16x16x32_bf16 v[172:175], a[100:103], a[236:239], v[172:175]
    ds_read_b64_tr_b16 a[232:233], v217 offset:2048
    v_accvgpr_write_b32 a60, v124
    v_mfma_f32_16x16x32_bf16 v[168:171], a[96:99], a[236:239], v[168:171]
    ds_read_b64_tr_b16 a[234:235], v217 offset:3072
    v_accvgpr_write_b32 a61, v125
    v_mfma_f32_16x16x32_bf16 v[144:147], a[96:99], a[240:243], v[144:147]
    ds_read_b64_tr_b16 a[236:237], v218 offset:2048
    v_mfma_f32_16x16x32_bf16 v[148:151], a[100:103], a[240:243], v[148:151]
    ds_read_b64_tr_b16 a[238:239], v218 offset:3072
    v_accvgpr_write_b32 a62, v126
    v_mfma_f32_16x16x32_bf16 v[156:159], a[100:103], a[244:247], v[156:159]
    ds_read_b64_tr_b16 a[240:241], v219 offset:2048
    s_add_u32 m0, s39, 49152
    v_accvgpr_write_b32 a63, v127
    v_mfma_f32_16x16x32_bf16 v[152:155], a[96:99], a[244:247], v[152:155]
    ds_read_b64_tr_b16 a[242:243], v219 offset:3072
    s_waitcnt lgkmcnt(6)
    v_mfma_f32_16x16x32_bf16 v[200:203], a[96:99], a[216:219], v[200:203]
    ds_read_b64_tr_b16 a[244:245], v220 offset:2048
    buffer_load_dwordx4 v224, s[16:19], s54 offen offset:0  lds
    v_mfma_f32_16x16x32_bf16 v[204:207], a[100:103], a[216:219], v[204:207]
    ds_read_b64_tr_b16 a[246:247], v220 offset:3072
    v_mfma_f32_16x16x32_bf16 v[180:183], a[220:223], a[100:103], v[180:183]
    ds_read_b64_tr_b16 a[216:217], v221 offset:2048
    v_mfma_f32_16x16x32_bf16 v[176:179], a[220:223], a[96:99], v[176:179]
    ds_read_b64_tr_b16 a[218:219], v221 offset:3072
    v_mfma_f32_16x16x32_bf16 v[184:187], a[224:227], a[96:99], v[184:187]
    ds_read_b64_tr_b16 a[220:221], v222 offset:2048
    buffer_load_dwordx4 v225, s[20:23], s54 offen offset:1024  lds
    v_mfma_f32_16x16x32_bf16 v[188:191], a[224:227], a[100:103], v[188:191]
    ds_read_b64_tr_b16 a[222:223], v222 offset:3072
    v_mfma_f32_16x16x32_bf16 v[164:167], a[108:111], a[228:231], v[164:167]
    ds_read_b64_tr_b16 a[224:225], v216 offset:4096
    v_mfma_f32_16x16x32_bf16 v[160:163], a[104:107], a[228:231], v[160:163]
    ds_read_b64_tr_b16 a[226:227], v216 offset:5120
    buffer_load_dwordx4 v226, s[16:19], s55 offen offset:2048  lds
    s_waitcnt lgkmcnt(6)
    v_mfma_f32_16x16x32_bf16 v[168:171], a[104:107], a[232:235], v[168:171]
    ds_read_b64_tr_b16 a[228:229], v217 offset:4096
    v_mfma_f32_16x16x32_bf16 v[172:175], a[108:111], a[232:235], v[172:175]
    ds_read_b64_tr_b16 a[230:231], v217 offset:5120
    v_mfma_f32_16x16x32_bf16 v[148:151], a[108:111], a[236:239], v[148:151]
    ds_read_b64_tr_b16 a[232:233], v218 offset:4096
    v_mfma_f32_16x16x32_bf16 v[144:147], a[104:107], a[236:239], v[144:147]
    ds_read_b64_tr_b16 a[234:235], v218 offset:5120
    buffer_load_dwordx4 v227, s[20:23], s55 offen offset:3072  lds
    v_mfma_f32_16x16x32_bf16 v[152:155], a[104:107], a[240:243], v[152:155]
    ds_read_b64_tr_b16 a[236:237], v219 offset:4096
    v_mfma_f32_16x16x32_bf16 v[156:159], a[108:111], a[240:243], v[156:159]
    ds_read_b64_tr_b16 a[238:239], v219 offset:5120
    s_add_u32 m0, s39, 53248
    v_mfma_f32_16x16x32_bf16 v[204:207], a[108:111], a[244:247], v[204:207]
    ds_read_b64_tr_b16 a[240:241], v220 offset:4096
    v_mfma_f32_16x16x32_bf16 v[200:203], a[104:107], a[244:247], v[200:203]
    ds_read_b64_tr_b16 a[242:243], v220 offset:5120
    buffer_load_dwordx4 v224, s[16:19], s56 offen offset:0  lds
    s_waitcnt lgkmcnt(6)
    v_mfma_f32_16x16x32_bf16 v[176:179], a[216:219], a[104:107], v[176:179]
    ds_read_b64_tr_b16 a[244:245], v221 offset:4096
    v_mfma_f32_16x16x32_bf16 v[180:183], a[216:219], a[108:111], v[180:183]
    ds_read_b64_tr_b16 a[246:247], v221 offset:5120
    v_mfma_f32_16x16x32_bf16 v[188:191], a[220:223], a[108:111], v[188:191]
    ds_read_b64_tr_b16 a[216:217], v222 offset:4096
    v_mfma_f32_16x16x32_bf16 v[184:187], a[220:223], a[104:107], v[184:187]
    ds_read_b64_tr_b16 a[218:219], v222 offset:5120
    buffer_load_dwordx4 v225, s[20:23], s56 offen offset:1024  lds
    v_mfma_f32_16x16x32_bf16 v[160:163], a[112:115], a[224:227], v[160:163]
    s_waitcnt vmcnt(21)
    s_barrier
    ds_read_b64_tr_b16 a[220:221], v216 offset:24576
    v_mfma_f32_16x16x32_bf16 v[164:167], a[116:119], a[224:227], v[164:167]
    ds_read_b64_tr_b16 a[222:223], v216 offset:25600
    v_mfma_f32_16x16x32_bf16 v[172:175], a[116:119], a[228:231], v[172:175]
    ds_read_b64_tr_b16 a[224:225], v217 offset:24576
    v_mfma_f32_16x16x32_bf16 v[168:171], a[112:115], a[228:231], v[168:171]
    ds_read_b64_tr_b16 a[226:227], v217 offset:25600
    s_add_u32 m0, s39, 73728
    s_waitcnt lgkmcnt(6)
    v_mfma_f32_16x16x32_bf16 v[144:147], a[112:115], a[232:235], v[144:147]
    ds_read_b64_tr_b16 a[228:229], v218 offset:24576
    v_mfma_f32_16x16x32_bf16 v[148:151], a[116:119], a[232:235], v[148:151]
    ds_read_b64_tr_b16 a[230:231], v218 offset:25600
    v_mfma_f32_16x16x32_bf16 v[156:159], a[116:119], a[236:239], v[156:159]
    ds_read_b64_tr_b16 a[232:233], v219 offset:24576
    buffer_load_dwordx4 v224, s[16:19], s57 offen offset:0  lds
    v_mfma_f32_16x16x32_bf16 v[152:155], a[112:115], a[236:239], v[152:155]
    ds_read_b64_tr_b16 a[234:235], v219 offset:25600
    v_mfma_f32_16x16x32_bf16 v[200:203], a[112:115], a[240:243], v[200:203]
    ds_read_b64_tr_b16 a[236:237], v220 offset:24576
    v_mfma_f32_16x16x32_bf16 v[204:207], a[116:119], a[240:243], v[204:207]
    ds_read_b64_tr_b16 a[238:239], v220 offset:25600
    v_mfma_f32_16x16x32_bf16 v[180:183], a[244:247], a[116:119], v[180:183]
    ds_read_b64_tr_b16 a[240:241], v221 offset:24576
    v_mfma_f32_16x16x32_bf16 v[176:179], a[244:247], a[112:115], v[176:179]
    ds_read_b64_tr_b16 a[242:243], v221 offset:25600
    s_waitcnt lgkmcnt(6)
    v_mfma_f32_16x16x32_bf16 v[184:187], a[216:219], a[112:115], v[184:187]
    ds_read_b64_tr_b16 a[244:245], v222 offset:24576
    v_mfma_f32_16x16x32_bf16 v[188:191], a[216:219], a[116:119], v[188:191]
    ds_read_b64_tr_b16 a[246:247], v222 offset:25600
    buffer_load_dwordx4 v225, s[20:23], s57 offen offset:1024  lds
    v_mfma_f32_16x16x32_bf16 v[164:167], a[124:127], a[220:223], v[164:167]
    ds_read_b64_tr_b16 a[216:217], v216 offset:26624
    v_mfma_f32_16x16x32_bf16 v[160:163], a[120:123], a[220:223], v[160:163]
    ds_read_b64_tr_b16 a[218:219], v216 offset:27648
    v_mfma_f32_16x16x32_bf16 v[168:171], a[120:123], a[224:227], v[168:171]
    ds_read_b64_tr_b16 a[220:221], v217 offset:26624
    v_mfma_f32_16x16x32_bf16 v[172:175], a[124:127], a[224:227], v[172:175]
    ds_read_b64_tr_b16 a[222:223], v217 offset:27648
    v_mfma_f32_16x16x32_bf16 v[148:151], a[124:127], a[228:231], v[148:151]
    ds_read_b64_tr_b16 a[224:225], v218 offset:26624
    v_mfma_f32_16x16x32_bf16 v[144:147], a[120:123], a[228:231], v[144:147]
    ds_read_b64_tr_b16 a[226:227], v218 offset:27648
    s_waitcnt lgkmcnt(6)
    v_mfma_f32_16x16x32_bf16 v[152:155], a[120:123], a[232:235], v[152:155]
    ds_read_b64_tr_b16 a[228:229], v219 offset:26624
    buffer_load_dwordx4 v226, s[16:19], s58 offen offset:2048  lds
    v_mfma_f32_16x16x32_bf16 v[156:159], a[124:127], a[232:235], v[156:159]
    ds_read_b64_tr_b16 a[230:231], v219 offset:27648
    v_lshrrev_b32 v248, 4, v209
    v_mfma_f32_16x16x32_bf16 v[204:207], a[124:127], a[236:239], v[204:207]
    ds_read_b64_tr_b16 a[232:233], v220 offset:26624
    s_lshl_b32 s42, s36, 7
    s_add_u32 s42, s42, 162048
    v_lshl_add_u32 v248, v248, 4, s42
    v_mfma_f32_16x16x32_bf16 v[200:203], a[120:123], a[236:239], v[200:203]
    ds_read_b64_tr_b16 a[234:235], v220 offset:27648
    ds_read_b128 v[8:11], v248
    v_mfma_f32_16x16x32_bf16 v[176:179], a[240:243], a[120:123], v[176:179]
    ds_read_b64_tr_b16 a[236:237], v221 offset:26624
    ds_read_b128 v[12:15], v248 offset:64
    v_mfma_f32_16x16x32_bf16 v[180:183], a[240:243], a[124:127], v[180:183]
    ds_read_b64_tr_b16 a[238:239], v221 offset:27648
    v_mfma_f32_16x16x32_bf16 v[188:191], a[244:247], a[124:127], v[188:191]
    ds_read_b64_tr_b16 a[240:241], v222 offset:26624
    v_and_b32 v249, 15, v209
    v_mfma_f32_16x16x32_bf16 v[184:187], a[244:247], a[120:123], v[184:187]
    ds_read_b64_tr_b16 a[242:243], v222 offset:27648
    buffer_load_dwordx4 v227, s[20:23], s58 offen offset:3072  lds
    s_waitcnt lgkmcnt(8)
    v_mfma_f32_16x16x32_bf16 v[160:163], a[128:131], a[216:219], v[160:163]
    ds_read_b64_tr_b16 a[244:245], v216 offset:28672
    v_and_b32 v250, 4, v209
    v_mfma_f32_16x16x32_bf16 v[164:167], a[132:135], a[216:219], v[164:167]
    ds_read_b64_tr_b16 a[246:247], v216 offset:29696
    v_cmp_gt_u32 s[0:1], 12, v249
    v_mfma_f32_16x16x32_bf16 v[172:175], a[132:135], a[220:223], v[172:175]
    ds_read_b64_tr_b16 a[216:217], v217 offset:28672
    v_cmp_eq_u32 s[2:3], 0, v250
    v_accvgpr_read_b32 v0, a160
    v_mfma_f32_16x16x32_bf16 v[168:171], a[128:131], a[220:223], v[168:171]
    ds_read_b64_tr_b16 a[218:219], v217 offset:29696
    s_add_u32 m0, s39, 77824
    v_mfma_f32_16x16x32_bf16 v[144:147], a[128:131], a[224:227], v[144:147]
    ds_read_b64_tr_b16 a[220:221], v218 offset:28672
    v_accvgpr_read_b32 v1, a161
    v_mfma_f32_16x16x32_bf16 v[148:151], a[132:135], a[224:227], v[148:151]
    ds_read_b64_tr_b16 a[222:223], v218 offset:29696
    v_accvgpr_read_b32 v2, a162
    v_mfma_f32_16x16x32_bf16 v[156:159], a[132:135], a[228:231], v[156:159]
    ds_read_b64_tr_b16 a[224:225], v219 offset:28672
    buffer_load_dwordx4 v224, s[16:19], s59 offen offset:0  lds
    v_mfma_f32_16x16x32_bf16 v[152:155], a[128:131], a[228:231], v[152:155]
    ds_read_b64_tr_b16 a[226:227], v219 offset:29696
    v_accvgpr_read_b32 v3, a163
    s_waitcnt lgkmcnt(6)
    v_mfma_f32_16x16x32_bf16 v[200:203], a[128:131], a[232:235], v[200:203]
    ds_read_b64_tr_b16 a[228:229], v220 offset:28672
    v_accvgpr_read_b32 v4, a164
    v_mfma_f32_16x16x32_bf16 v[204:207], a[132:135], a[232:235], v[204:207]
    ds_read_b64_tr_b16 a[230:231], v220 offset:29696
    v_accvgpr_read_b32 v5, a165
    v_mfma_f32_16x16x32_bf16 v[180:183], a[236:239], a[132:135], v[180:183]
    ds_read_b64_tr_b16 a[232:233], v221 offset:28672
    v_accvgpr_read_b32 v6, a166
    v_mfma_f32_16x16x32_bf16 v[176:179], a[236:239], a[128:131], v[176:179]
    ds_read_b64_tr_b16 a[234:235], v221 offset:29696
    v_accvgpr_read_b32 v7, a167
    v_mov_b32 v40, 0
    v_mfma_f32_16x16x32_bf16 v[184:187], a[240:243], a[128:131], v[184:187]
    ds_read_b64_tr_b16 a[236:237], v222 offset:28672
    buffer_load_dwordx4 v225, s[20:23], s59 offen offset:1024  lds
    v_mfma_f32_16x16x32_bf16 v[188:191], a[240:243], a[132:135], v[188:191]
    ds_read_b64_tr_b16 a[238:239], v222 offset:29696
    v_mov_b32 v41, 0
    v_mfma_f32_16x16x32_bf16 v[164:167], a[140:143], a[244:247], v[164:167]
    s_waitcnt vmcnt(21)
    s_barrier
    v_add_u32 v212, 0xfffe8000, v212
    ds_read_b64_tr_b16 a[240:241], v212 offset:0
    v_mov_b32 v44, 0
    v_mfma_f32_16x16x32_bf16 v[160:163], a[136:139], a[244:247], v[160:163]
    ds_read_b64_tr_b16 a[242:243], v212 offset:12288
    v_mov_b32 v45, 0
    s_waitcnt lgkmcnt(6)
    v_mfma_f32_16x16x32_bf16 v[168:171], a[136:139], a[216:219], v[168:171]
    ds_read_b64_tr_b16 a[244:245], v212 offset:1024
    v_accvgpr_read_b32 v42, a168
    v_mfma_f32_16x16x32_bf16 v[172:175], a[140:143], a[216:219], v[172:175]
    ds_read_b64_tr_b16 a[246:247], v212 offset:13312
    v_accvgpr_read_b32 v43, a169
    v_mfma_f32_16x16x32_bf16 v[148:151], a[140:143], a[220:223], v[148:151]
    v_add_u32 v213, 0xfffe8000, v213
    ds_read_b64_tr_b16 a[216:217], v213 offset:0
    s_add_u32 m0, s39, 98304
    v_mfma_f32_16x16x32_bf16 v[144:147], a[136:139], a[220:223], v[144:147]
    ds_read_b64_tr_b16 a[218:219], v213 offset:12288
    v_mfma_f32_16x16x32_bf16 v[152:155], a[136:139], a[224:227], v[152:155]
    ds_read_b64_tr_b16 a[220:221], v213 offset:1024
    v_mfma_f32_16x16x32_bf16 v[156:159], a[140:143], a[224:227], v[156:159]
    ds_read_b64_tr_b16 a[222:223], v213 offset:13312
    buffer_load_dwordx4 v224, s[16:19], s60 offen offset:0  lds
    v_mfma_f32_16x16x32_bf16 v[204:207], a[140:143], a[228:231], v[204:207]
    v_add_u32 v214, 0xfffe8000, v214
    ds_read_b64_tr_b16 a[224:225], v214 offset:0
    v_mfma_f32_16x16x32_bf16 v[200:203], a[136:139], a[228:231], v[200:203]
    ds_read_b64_tr_b16 a[226:227], v214 offset:12288
    s_waitcnt lgkmcnt(6)
    v_mfma_f32_16x16x32_bf16 v[176:179], a[232:235], a[136:139], v[176:179]
    ds_read_b64_tr_b16 a[228:229], v214 offset:1024
    v_mfma_f32_16x16x32_bf16 v[180:183], a[232:235], a[140:143], v[180:183]
    ds_read_b64_tr_b16 a[230:231], v214 offset:13312
    v_mfma_f32_16x16x32_bf16 v[188:191], a[236:239], a[140:143], v[188:191]
    v_add_u32 v215, 0xfffe8000, v215
    ds_read_b64_tr_b16 a[232:233], v215 offset:0
    v_mfma_f32_16x16x32_bf16 v[184:187], a[236:239], a[136:139], v[184:187]
    ds_read_b64_tr_b16 a[234:235], v215 offset:12288
    v_mfma_f32_16x16x32_bf16 v[64:67], a[240:243], a[0:3], 0
    ds_read_b64_tr_b16 a[236:237], v215 offset:1024
    v_mfma_f32_16x16x32_bf16 v[68:71], a[240:243], a[4:7], 0
    ds_read_b64_tr_b16 a[238:239], v215 offset:13312
    buffer_load_dwordx4 v225, s[20:23], s60 offen offset:1024  lds
    v_mfma_f32_16x16x32_bf16 v[76:79], a[244:247], a[4:7], 0
    ds_read_b64_tr_b16 a[240:241], v212 offset:2048
    v_mfma_f32_16x16x32_bf16 v[72:75], a[244:247], a[0:3], 0
    ds_read_b64_tr_b16 a[242:243], v212 offset:14336
    s_waitcnt lgkmcnt(6)
    v_mfma_f32_16x16x32_bf16 v[80:83], a[216:219], a[0:3], 0
    ds_read_b64_tr_b16 a[244:245], v212 offset:3072
    v_mfma_f32_16x16x32_bf16 v[84:87], a[216:219], a[4:7], 0
    ds_read_b64_tr_b16 a[246:247], v212 offset:15360
    v_mfma_f32_16x16x32_bf16 v[92:95], a[220:223], a[4:7], 0
    ds_read_b64_tr_b16 a[216:217], v213 offset:2048
    v_mul_f32 v144, v144, v8
    v_mfma_f32_16x16x32_bf16 v[88:91], a[220:223], a[0:3], 0
    ds_read_b64_tr_b16 a[218:219], v213 offset:14336
    v_mul_f32 v145, v145, v9
    v_mfma_f32_16x16x32_bf16 v[96:99], a[224:227], a[0:3], 0
    ds_read_b64_tr_b16 a[220:221], v213 offset:3072
    v_mul_f32 v146, v146, v10
    v_mfma_f32_16x16x32_bf16 v[100:103], a[224:227], a[4:7], 0
    ds_read_b64_tr_b16 a[222:223], v213 offset:15360
    buffer_load_dwordx4 v226, s[16:19], s61 offen offset:2048  lds
    v_mfma_f32_16x16x32_bf16 v[108:111], a[228:231], a[4:7], 0
    ds_read_b64_tr_b16 a[224:225], v214 offset:2048
    v_mul_f32 v147, v147, v11
    v_mfma_f32_16x16x32_bf16 v[104:107], a[228:231], a[0:3], 0
    ds_read_b64_tr_b16 a[226:227], v214 offset:14336
    v_mul_f32 v148, v148, v12
    s_waitcnt lgkmcnt(6)
    v_mfma_f32_16x16x32_bf16 v[112:115], a[232:235], a[0:3], 0
    ds_read_b64_tr_b16 a[228:229], v214 offset:3072
    v_mul_f32 v149, v149, v13
    v_mfma_f32_16x16x32_bf16 v[116:119], a[232:235], a[4:7], 0
    ds_read_b64_tr_b16 a[230:231], v214 offset:15360
    v_mul_f32 v150, v150, v14
    v_mfma_f32_16x16x32_bf16 v[124:127], a[236:239], a[4:7], 0
    ds_read_b64_tr_b16 a[232:233], v215 offset:2048
    v_mul_f32 v151, v151, v15
    v_mfma_f32_16x16x32_bf16 v[120:123], a[236:239], a[0:3], 0
    ds_read_b64_tr_b16 a[234:235], v215 offset:14336
    v_cvt_pk_bf16_f32 v24, v144, v145
    v_mfma_f32_16x16x32_bf16 v[64:67], a[240:243], a[8:11], v[64:67]
    ds_read_b64_tr_b16 a[236:237], v215 offset:3072
    v_cvt_pk_bf16_f32 v25, v146, v147
    v_mfma_f32_16x16x32_bf16 v[68:71], a[240:243], a[12:15], v[68:71]
    ds_read_b64_tr_b16 a[238:239], v215 offset:15360
    buffer_load_dwordx4 v227, s[20:23], s61 offen offset:3072  lds
    v_mfma_f32_16x16x32_bf16 v[76:79], a[244:247], a[12:15], v[76:79]
    ds_read_b64_tr_b16 a[240:241], v212 offset:4096
    v_cvt_pk_bf16_f32 v26, v148, v149
    v_mfma_f32_16x16x32_bf16 v[72:75], a[244:247], a[8:11], v[72:75]
    ds_read_b64_tr_b16 a[242:243], v212 offset:16384
    v_cvt_pk_bf16_f32 v27, v150, v151
    s_waitcnt lgkmcnt(6)
    v_mfma_f32_16x16x32_bf16 v[80:83], a[216:219], a[8:11], v[80:83]
    ds_read_b64_tr_b16 a[244:245], v212 offset:5120
    v_mul_f32 v152, v152, v8
    v_mfma_f32_16x16x32_bf16 v[84:87], a[216:219], a[12:15], v[84:87]
    ds_read_b64_tr_b16 a[246:247], v212 offset:17408
    s_add_u32 m0, s39, 102400
    v_mfma_f32_16x16x32_bf16 v[92:95], a[220:223], a[12:15], v[92:95]
    ds_read_b64_tr_b16 a[216:217], v213 offset:4096
    v_mul_f32 v153, v153, v9
    v_mfma_f32_16x16x32_bf16 v[88:91], a[220:223], a[8:11], v[88:91]
    ds_read_b64_tr_b16 a[218:219], v213 offset:16384
    v_mul_f32 v154, v154, v10
    v_mul_f32 v155, v155, v11
    v_mfma_f32_16x16x32_bf16 v[96:99], a[224:227], a[8:11], v[96:99]
    ds_read_b64_tr_b16 a[220:221], v213 offset:5120
    buffer_load_dwordx4 v224, s[16:19], s62 offen offset:0  lds
    v_mfma_f32_16x16x32_bf16 v[100:103], a[224:227], a[12:15], v[100:103]
    ds_read_b64_tr_b16 a[222:223], v213 offset:17408
    v_mul_f32 v156, v156, v12
    v_mfma_f32_16x16x32_bf16 v[108:111], a[228:231], a[12:15], v[108:111]
    ds_read_b64_tr_b16 a[224:225], v214 offset:4096
    v_mul_f32 v157, v157, v13
    v_mfma_f32_16x16x32_bf16 v[104:107], a[228:231], a[8:11], v[104:107]
    ds_read_b64_tr_b16 a[226:227], v214 offset:16384
    v_mul_f32 v158, v158, v14
    s_waitcnt lgkmcnt(6)
    v_mfma_f32_16x16x32_bf16 v[112:115], a[232:235], a[8:11], v[112:115]
    ds_read_b64_tr_b16 a[228:229], v214 offset:5120
    v_mul_f32 v159, v159, v15
    v_mfma_f32_16x16x32_bf16 v[116:119], a[232:235], a[12:15], v[116:119]
    ds_read_b64_tr_b16 a[230:231], v214 offset:17408
    v_cvt_pk_bf16_f32 v28, v152, v153
    v_mfma_f32_16x16x32_bf16 v[124:127], a[236:239], a[12:15], v[124:127]
    ds_read_b64_tr_b16 a[232:233], v215 offset:4096
    v_cvt_pk_bf16_f32 v29, v154, v155
    v_mfma_f32_16x16x32_bf16 v[120:123], a[236:239], a[8:11], v[120:123]
    ds_read_b64_tr_b16 a[234:235], v215 offset:16384
    v_cvt_pk_bf16_f32 v30, v156, v157
    v_mfma_f32_16x16x32_bf16 v[64:67], a[240:243], a[16:19], v[64:67]
    ds_read_b64_tr_b16 a[236:237], v215 offset:5120
    buffer_load_dwordx4 v225, s[20:23], s62 offen offset:1024  lds
    v_mfma_f32_16x16x32_bf16 v[68:71], a[240:243], a[20:23], v[68:71]
    ds_read_b64_tr_b16 a[238:239], v215 offset:17408
    v_cvt_pk_bf16_f32 v31, v158, v159
    v_mfma_f32_16x16x32_bf16 v[76:79], a[244:247], a[20:23], v[76:79]
    s_waitcnt vmcnt(21)
    s_barrier
    ds_read_b64_tr_b16 a[240:241], v212 offset:24576
    v_mul_f32 v36, v200, v8
    v_mfma_f32_16x16x32_bf16 v[72:75], a[244:247], a[16:19], v[72:75]
    ds_read_b64_tr_b16 a[242:243], v212 offset:36864
    v_mul_f32 v37, v201, v9
    v_mul_f32 v38, v202, v10
    s_waitcnt lgkmcnt(6)
    v_mfma_f32_16x16x32_bf16 v[80:83], a[216:219], a[16:19], v[80:83]
    ds_read_b64_tr_b16 a[244:245], v212 offset:25600
    s_add_u32 m0, s39, 122880
    v_mfma_f32_16x16x32_bf16 v[84:87], a[216:219], a[20:23], v[84:87]
    ds_read_b64_tr_b16 a[246:247], v212 offset:37888
    v_mul_f32 v39, v203, v11
    v_fmaak_f32 v200, v200, v8, 0x358637bd
    v_mfma_f32_16x16x32_bf16 v[92:95], a[220:223], a[20:23], v[92:95]
    ds_read_b64_tr_b16 a[216:217], v213 offset:24576
    buffer_load_dwordx4 v224, s[16:19], s63 offen offset:0  lds
    v_mfma_f32_16x16x32_bf16 v[88:91], a[220:223], a[16:19], v[88:91]
    ds_read_b64_tr_b16 a[218:219], v213 offset:36864
    v_fmaak_f32 v201, v201, v9, 0x358637bd
    v_mfma_f32_16x16x32_bf16 v[96:99], a[224:227], a[16:19], v[96:99]
    ds_read_b64_tr_b16 a[220:221], v213 offset:25600
    v_fmaak_f32 v202, v202, v10, 0x358637bd
    v_mfma_f32_16x16x32_bf16 v[100:103], a[224:227], a[20:23], v[100:103]
    ds_read_b64_tr_b16 a[222:223], v213 offset:37888
    buffer_load_dwordx4 v225, s[20:23], s63 offen offset:1024  lds
    v_mfma_f32_16x16x32_bf16 v[108:111], a[228:231], a[20:23], v[108:111]
    ds_read_b64_tr_b16 a[224:225], v214 offset:24576
    v_fmaak_f32 v203, v203, v11, 0x358637bd
    v_mfma_f32_16x16x32_bf16 v[104:107], a[228:231], a[16:19], v[104:107]
    ds_read_b64_tr_b16 a[226:227], v214 offset:36864
    v_mul_f32 v248, 0x3fb8aa3b, v200
    s_waitcnt lgkmcnt(6)
    v_mfma_f32_16x16x32_bf16 v[112:115], a[232:235], a[16:19], v[112:115]
    ds_read_b64_tr_b16 a[228:229], v214 offset:25600
    v_mul_f32 v249, 0x3fb8aa3b, v201
    v_mul_f32 v250, 0x3fb8aa3b, v202
    v_mfma_f32_16x16x32_bf16 v[116:119], a[232:235], a[20:23], v[116:119]
    ds_read_b64_tr_b16 a[230:231], v214 offset:37888
    buffer_load_dwordx4 v226, s[16:19], s64 offen offset:2048  lds
    v_mfma_f32_16x16x32_bf16 v[124:127], a[236:239], a[20:23], v[124:127]
    ds_read_b64_tr_b16 a[232:233], v215 offset:24576
    v_mul_f32 v251, 0x3fb8aa3b, v203
    v_mfma_f32_16x16x32_bf16 v[120:123], a[236:239], a[16:19], v[120:123]
    ds_read_b64_tr_b16 a[234:235], v215 offset:36864
    v_max_f32 v200, 0x358637bd, v200
    v_mfma_f32_16x16x32_bf16 v[64:67], a[240:243], a[24:27], v[64:67]
    ds_read_b64_tr_b16 a[236:237], v215 offset:25600
    v_max_f32 v201, 0x358637bd, v201
    v_max_f32 v202, 0x358637bd, v202
    v_mfma_f32_16x16x32_bf16 v[68:71], a[240:243], a[28:31], v[68:71]
    ds_read_b64_tr_b16 a[238:239], v215 offset:37888
    buffer_load_dwordx4 v227, s[20:23], s64 offen offset:3072  lds
    v_mfma_f32_16x16x32_bf16 v[76:79], a[244:247], a[28:31], v[76:79]
    ds_read_b64_tr_b16 a[240:241], v212 offset:26624
    v_max_f32 v203, 0x358637bd, v203
    v_mfma_f32_16x16x32_bf16 v[72:75], a[244:247], a[24:27], v[72:75]
    ds_read_b64_tr_b16 a[242:243], v212 offset:38912
    s_add_u32 m0, s39, 126976
    v_exp_f32_e64 v248, v248 clamp
    s_waitcnt lgkmcnt(6)
    v_mfma_f32_16x16x32_bf16 v[80:83], a[216:219], a[24:27], v[80:83]
    ds_read_b64_tr_b16 a[244:245], v212 offset:27648
    buffer_load_dwordx4 v224, s[16:19], s65 offen offset:0  lds
    v_mfma_f32_16x16x32_bf16 v[84:87], a[216:219], a[28:31], v[84:87]
    ds_read_b64_tr_b16 a[246:247], v212 offset:39936
    v_exp_f32_e64 v249, v249 clamp
    v_mfma_f32_16x16x32_bf16 v[92:95], a[220:223], a[28:31], v[92:95]
    ds_read_b64_tr_b16 a[216:217], v213 offset:26624
    v_exp_f32_e64 v250, v250 clamp
    v_mfma_f32_16x16x32_bf16 v[88:91], a[220:223], a[24:27], v[88:91]
    ds_read_b64_tr_b16 a[218:219], v213 offset:38912
    v_exp_f32_e64 v251, v251 clamp
    v_add_f32 v200, v200, v248
    v_mfma_f32_16x16x32_bf16 v[96:99], a[224:227], a[24:27], v[96:99]
    ds_read_b64_tr_b16 a[220:221], v213 offset:27648
    buffer_load_dwordx4 v225, s[20:23], s65 offen offset:1024  lds
    v_mfma_f32_16x16x32_bf16 v[100:103], a[224:227], a[28:31], v[100:103]
    ds_read_b64_tr_b16 a[222:223], v213 offset:39936
    v_add_f32 v201, v201, v249
    v_add_f32 v202, v202, v250
    v_mfma_f32_16x16x32_bf16 v[108:111], a[228:231], a[28:31], v[108:111]
    ds_read_b64_tr_b16 a[224:225], v214 offset:26624
    v_accvgpr_read_b32 v254, a170
    v_mfma_f32_16x16x32_bf16 v[104:107], a[228:231], a[24:27], v[104:107]
    ds_read_b64_tr_b16 a[226:227], v214 offset:38912
    buffer_load_dword a215, v254, s[16:19], s100 offen offset:384
    v_add_f32 v203, v203, v251
    s_waitcnt lgkmcnt(6)
    v_mfma_f32_16x16x32_bf16 v[112:115], a[232:235], a[24:27], v[112:115]
    ds_read_b64_tr_b16 a[228:229], v214 offset:27648
    buffer_load_dword a215, v254, s[20:23], s100 offen offset:384
    v_mfma_f32_16x16x32_bf16 v[116:119], a[232:235], a[28:31], v[116:119]
    ds_read_b64_tr_b16 a[230:231], v214 offset:39936
    v_cndmask_b32 v36, 1.0, v36, s[0:1]
    v_mfma_f32_16x16x32_bf16 v[124:127], a[236:239], a[28:31], v[124:127]
    ds_read_b64_tr_b16 a[232:233], v215 offset:26624
    v_cndmask_b32 v37, 1.0, v37, s[0:1]
    v_mfma_f32_16x16x32_bf16 v[120:123], a[236:239], a[24:27], v[120:123]
    ds_read_b64_tr_b16 a[234:235], v215 offset:38912
    v_cndmask_b32 v38, 1.0, v38, s[0:1]
    v_mfma_f32_16x16x32_bf16 v[64:67], a[240:243], a[32:35], v[64:67]
    ds_read_b64_tr_b16 a[236:237], v215 offset:27648
    v_cndmask_b32 v39, 1.0, v39, s[0:1]
    v_mfma_f32_16x16x32_bf16 v[68:71], a[240:243], a[36:39], v[68:71]
    ds_read_b64_tr_b16 a[238:239], v215 offset:39936
    v_cndmask_b32 v200, v36, v200, s[2:3]
    v_mfma_f32_16x16x32_bf16 v[76:79], a[244:247], a[36:39], v[76:79]
    ds_read_b64_tr_b16 a[240:241], v212 offset:28672
    v_cndmask_b32 v201, v37, v201, s[2:3]
    v_mfma_f32_16x16x32_bf16 v[72:75], a[244:247], a[32:35], v[72:75]
    ds_read_b64_tr_b16 a[242:243], v212 offset:40960
    v_cndmask_b32 v202, v38, v202, s[2:3]
    s_waitcnt lgkmcnt(6)
    v_mfma_f32_16x16x32_bf16 v[80:83], a[216:219], a[32:35], v[80:83]
    ds_read_b64_tr_b16 a[244:245], v212 offset:29696
    v_cndmask_b32 v203, v39, v203, s[2:3]
    v_mfma_f32_16x16x32_bf16 v[84:87], a[216:219], a[36:39], v[84:87]
    ds_read_b64_tr_b16 a[246:247], v212 offset:41984
    v_mul_f32 v36, v204, v12
    v_mfma_f32_16x16x32_bf16 v[92:95], a[220:223], a[36:39], v[92:95]
    ds_read_b64_tr_b16 a[216:217], v213 offset:28672
    v_mul_f32 v37, v205, v13
    v_mfma_f32_16x16x32_bf16 v[88:91], a[220:223], a[32:35], v[88:91]
    ds_read_b64_tr_b16 a[218:219], v213 offset:40960
    v_mul_f32 v38, v206, v14
    v_mfma_f32_16x16x32_bf16 v[96:99], a[224:227], a[32:35], v[96:99]
    ds_read_b64_tr_b16 a[220:221], v213 offset:29696
    v_mul_f32 v39, v207, v15
    v_mfma_f32_16x16x32_bf16 v[100:103], a[224:227], a[36:39], v[100:103]
    ds_read_b64_tr_b16 a[222:223], v213 offset:41984
    v_fmaak_f32 v204, v204, v12, 0x358637bd
    v_mfma_f32_16x16x32_bf16 v[108:111], a[228:231], a[36:39], v[108:111]
    ds_read_b64_tr_b16 a[224:225], v214 offset:28672
    s_add_u32 s74, s46, 0
    v_mfma_f32_16x16x32_bf16 v[104:107], a[228:231], a[32:35], v[104:107]
    ds_read_b64_tr_b16 a[226:227], v214 offset:40960
    v_fmaak_f32 v205, v205, v13, 0x358637bd
    s_waitcnt lgkmcnt(6)
    v_mfma_f32_16x16x32_bf16 v[112:115], a[232:235], a[32:35], v[112:115]
    ds_read_b64_tr_b16 a[228:229], v214 offset:29696
    v_fmaak_f32 v206, v206, v14, 0x358637bd
    v_mfma_f32_16x16x32_bf16 v[116:119], a[232:235], a[36:39], v[116:119]
    ds_read_b64_tr_b16 a[230:231], v214 offset:41984
    v_fmaak_f32 v207, v207, v15, 0x358637bd
    v_mfma_f32_16x16x32_bf16 v[124:127], a[236:239], a[36:39], v[124:127]
    ds_read_b64_tr_b16 a[232:233], v215 offset:28672
    v_mul_f32 v248, 0x3fb8aa3b, v204
    v_mfma_f32_16x16x32_bf16 v[120:123], a[236:239], a[32:35], v[120:123]
    ds_read_b64_tr_b16 a[234:235], v215 offset:40960
    buffer_store_dwordx4 v[128:131], v208, s[32:35], s74 offen offset:0 sc1
    v_mfma_f32_16x16x32_bf16 v[64:67], a[240:243], a[40:43], v[64:67]
    ds_read_b64_tr_b16 a[236:237], v215 offset:29696
    v_mul_f32 v249, 0x3fb8aa3b, v205
    v_mfma_f32_16x16x32_bf16 v[68:71], a[240:243], a[44:47], v[68:71]
    ds_read_b64_tr_b16 a[238:239], v215 offset:41984
    v_mul_f32 v250, 0x3fb8aa3b, v206
    v_mfma_f32_16x16x32_bf16 v[76:79], a[244:247], a[44:47], v[76:79]
    s_waitcnt vmcnt(21)
    s_barrier
    v_add_u32 v212, 0xc000, v212
    ds_read_b64_tr_b16 a[240:241], v212 offset:0
    v_mul_f32 v251, 0x3fb8aa3b, v207
    v_mfma_f32_16x16x32_bf16 v[72:75], a[244:247], a[40:43], v[72:75]
    ds_read_b64_tr_b16 a[242:243], v212 offset:12288
    v_max_f32 v204, 0x358637bd, v204
    v_max_f32 v205, 0x358637bd, v205
    s_waitcnt lgkmcnt(6)
    v_mfma_f32_16x16x32_bf16 v[80:83], a[216:219], a[40:43], v[80:83]
    ds_read_b64_tr_b16 a[244:245], v212 offset:1024
    buffer_store_dwordx4 v[132:135], v208, s[32:35], s74 offen offset:1024 sc1
    v_mfma_f32_16x16x32_bf16 v[84:87], a[216:219], a[44:47], v[84:87]
    ds_read_b64_tr_b16 a[246:247], v212 offset:13312
    v_max_f32 v206, 0x358637bd, v206
    v_mfma_f32_16x16x32_bf16 v[92:95], a[220:223], a[44:47], v[92:95]
    v_add_u32 v213, 0xc000, v213
    ds_read_b64_tr_b16 a[216:217], v213 offset:0
    v_max_f32 v207, 0x358637bd, v207
    v_mfma_f32_16x16x32_bf16 v[88:91], a[220:223], a[40:43], v[88:91]
    ds_read_b64_tr_b16 a[218:219], v213 offset:12288
    v_exp_f32_e64 v248, v248 clamp
    v_mfma_f32_16x16x32_bf16 v[96:99], a[224:227], a[40:43], v[96:99]
    ds_read_b64_tr_b16 a[220:221], v213 offset:1024
    buffer_store_dwordx4 v[136:139], v208, s[32:35], s74 offen offset:2048 sc1
    v_mfma_f32_16x16x32_bf16 v[100:103], a[224:227], a[44:47], v[100:103]
    ds_read_b64_tr_b16 a[222:223], v213 offset:13312
    v_exp_f32_e64 v249, v249 clamp
    v_mfma_f32_16x16x32_bf16 v[108:111], a[228:231], a[44:47], v[108:111]
    v_add_u32 v214, 0xc000, v214
    ds_read_b64_tr_b16 a[224:225], v214 offset:0
    v_exp_f32_e64 v250, v250 clamp
    v_mfma_f32_16x16x32_bf16 v[104:107], a[228:231], a[40:43], v[104:107]
    ds_read_b64_tr_b16 a[226:227], v214 offset:12288
    v_exp_f32_e64 v251, v251 clamp
    s_waitcnt lgkmcnt(6)
    v_mfma_f32_16x16x32_bf16 v[112:115], a[232:235], a[40:43], v[112:115]
    ds_read_b64_tr_b16 a[228:229], v214 offset:1024
    v_add_f32 v204, v204, v248
    v_add_f32 v205, v205, v249
    v_mfma_f32_16x16x32_bf16 v[116:119], a[232:235], a[44:47], v[116:119]
    ds_read_b64_tr_b16 a[230:231], v214 offset:13312
    buffer_store_dwordx4 v[140:143], v208, s[32:35], s74 offen offset:3072 sc1
    v_mfma_f32_16x16x32_bf16 v[124:127], a[236:239], a[44:47], v[124:127]
    v_add_u32 v215, 0xc000, v215
    ds_read_b64_tr_b16 a[232:233], v215 offset:0
    v_add_f32 v206, v206, v250
    v_mfma_f32_16x16x32_bf16 v[120:123], a[236:239], a[40:43], v[120:123]
    ds_read_b64_tr_b16 a[234:235], v215 offset:12288
    v_add_f32 v207, v207, v251
    v_mfma_f32_16x16x32_bf16 v[64:67], a[240:243], a[48:51], v[64:67]
    ds_read_b64_tr_b16 a[236:237], v215 offset:1024
    v_cndmask_b32 v36, 1.0, v36, s[0:1]
    v_mfma_f32_16x16x32_bf16 v[68:71], a[240:243], a[52:55], v[68:71]
    ds_read_b64_tr_b16 a[238:239], v215 offset:13312
    v_cndmask_b32 v37, 1.0, v37, s[0:1]
    v_mfma_f32_16x16x32_bf16 v[76:79], a[244:247], a[52:55], v[76:79]
    ds_read_b64_tr_b16 a[240:241], v212 offset:2048
    v_cndmask_b32 v38, 1.0, v38, s[0:1]
    v_mfma_f32_16x16x32_bf16 v[72:75], a[244:247], a[48:51], v[72:75]
    ds_read_b64_tr_b16 a[242:243], v212 offset:14336
    v_cndmask_b32 v39, 1.0, v39, s[0:1]
    s_waitcnt lgkmcnt(6)
    v_mfma_f32_16x16x32_bf16 v[80:83], a[216:219], a[48:51], v[80:83]
    ds_read_b64_tr_b16 a[244:245], v212 offset:3072
    v_cndmask_b32 v204, v36, v204, s[2:3]
    v_mfma_f32_16x16x32_bf16 v[84:87], a[216:219], a[52:55], v[84:87]
    ds_read_b64_tr_b16 a[246:247], v212 offset:15360
    v_cndmask_b32 v205, v37, v205, s[2:3]
    v_mfma_f32_16x16x32_bf16 v[92:95], a[220:223], a[52:55], v[92:95]
    ds_read_b64_tr_b16 a[216:217], v213 offset:2048
    v_cndmask_b32 v206, v38, v206, s[2:3]
    v_mfma_f32_16x16x32_bf16 v[88:91], a[220:223], a[48:51], v[88:91]
    ds_read_b64_tr_b16 a[218:219], v213 offset:14336
    v_cndmask_b32 v207, v39, v207, s[2:3]
    v_mfma_f32_16x16x32_bf16 v[96:99], a[224:227], a[48:51], v[96:99]
    ds_read_b64_tr_b16 a[220:221], v213 offset:3072
    v_cvt_pk_bf16_f32 v32, v200, v201
    v_mfma_f32_16x16x32_bf16 v[100:103], a[224:227], a[52:55], v[100:103]
    ds_read_b64_tr_b16 a[222:223], v213 offset:15360
    v_cvt_pk_bf16_f32 v33, v202, v203
    v_mfma_f32_16x16x32_bf16 v[108:111], a[228:231], a[52:55], v[108:111]
    ds_read_b64_tr_b16 a[224:225], v214 offset:2048
    v_cvt_pk_bf16_f32 v34, v204, v205
    v_mfma_f32_16x16x32_bf16 v[104:107], a[228:231], a[48:51], v[104:107]
    ds_read_b64_tr_b16 a[226:227], v214 offset:14336
    s_add_u32 m0, s39, 0
    s_waitcnt lgkmcnt(6)
    v_mfma_f32_16x16x32_bf16 v[112:115], a[232:235], a[48:51], v[112:115]
    ds_read_b64_tr_b16 a[228:229], v214 offset:3072
    v_add_u32 v224, 128, v224
    v_cvt_pk_bf16_f32 v35, v206, v207
    v_mfma_f32_16x16x32_bf16 v[116:119], a[232:235], a[52:55], v[116:119]
    ds_read_b64_tr_b16 a[230:231], v214 offset:15360
    v_add_u32 v225, 128, v225
    v_add_u32 v226, 128, v226
    v_add_u32 v227, 128, v227
    v_mfma_f32_16x16x32_bf16 v[124:127], a[236:239], a[52:55], v[124:127]
    ds_read_b64_tr_b16 a[232:233], v215 offset:2048
    buffer_load_dwordx4 v224, s[16:19], s48 offen offset:0  lds
    v_fmaak_f32 v160, v160, v8, 0x358637bd
    v_mfma_f32_16x16x32_bf16 v[120:123], a[236:239], a[48:51], v[120:123]
    ds_read_b64_tr_b16 a[234:235], v215 offset:14336
    v_fmaak_f32 v161, v161, v9, 0x358637bd
    v_mfma_f32_16x16x32_bf16 v[64:67], a[240:243], a[56:59], v[64:67]
    ds_read_b64_tr_b16 a[236:237], v215 offset:3072
    v_fmaak_f32 v162, v162, v10, 0x358637bd
    v_mfma_f32_16x16x32_bf16 v[68:71], a[240:243], a[60:63], v[68:71]
    ds_read_b64_tr_b16 a[238:239], v215 offset:15360
    v_fmaak_f32 v163, v163, v11, 0x358637bd
    v_mul_f32 v248, 0x3fb8aa3b, v160
    v_mfma_f32_16x16x32_bf16 v[76:79], a[244:247], a[60:63], v[76:79]
    ds_read_b64_tr_b16 a[240:241], v212 offset:4096
    buffer_load_dwordx4 v225, s[20:23], s48 offen offset:1024  lds
    v_mfma_f32_16x16x32_bf16 v[72:75], a[244:247], a[56:59], v[72:75]
    ds_read_b64_tr_b16 a[242:243], v212 offset:16384
    v_mul_f32 v249, 0x3fb8aa3b, v161
    s_waitcnt lgkmcnt(6)
    v_mfma_f32_16x16x32_bf16 v[80:83], a[216:219], a[56:59], v[80:83]
    ds_read_b64_tr_b16 a[244:245], v212 offset:5120
    v_mul_f32 v250, 0x3fb8aa3b, v162
    v_mfma_f32_16x16x32_bf16 v[84:87], a[216:219], a[60:63], v[84:87]
    ds_read_b64_tr_b16 a[246:247], v212 offset:17408
    buffer_load_dwordx4 v226, s[16:19], s49 offen offset:2048  lds
    v_mfma_f32_16x16x32_bf16 v[92:95], a[220:223], a[60:63], v[92:95]
    ds_read_b64_tr_b16 a[216:217], v213 offset:4096
    v_mul_f32 v251, 0x3fb8aa3b, v163
    v_mfma_f32_16x16x32_bf16 v[88:91], a[220:223], a[56:59], v[88:91]
    ds_read_b64_tr_b16 a[218:219], v213 offset:16384
    v_max_f32 v160, 0x358637bd, v160
    v_mfma_f32_16x16x32_bf16 v[96:99], a[224:227], a[56:59], v[96:99]
    ds_read_b64_tr_b16 a[220:221], v213 offset:5120
    v_max_f32 v161, 0x358637bd, v161
    v_max_f32 v162, 0x358637bd, v162
    v_mfma_f32_16x16x32_bf16 v[100:103], a[224:227], a[60:63], v[100:103]
    ds_read_b64_tr_b16 a[222:223], v213 offset:17408
    buffer_load_dwordx4 v227, s[20:23], s49 offen offset:3072  lds
    v_mfma_f32_16x16x32_bf16 v[108:111], a[228:231], a[60:63], v[108:111]
    ds_read_b64_tr_b16 a[224:225], v214 offset:4096
    v_max_f32 v163, 0x358637bd, v163
    v_exp_f32_e64 v248, v248 clamp
    v_mfma_f32_16x16x32_bf16 v[104:107], a[228:231], a[56:59], v[104:107]
    ds_read_b64_tr_b16 a[226:227], v214 offset:16384
    s_add_u32 m0, s39, 4096
    s_waitcnt lgkmcnt(6)
    v_mfma_f32_16x16x32_bf16 v[112:115], a[232:235], a[56:59], v[112:115]
    ds_read_b64_tr_b16 a[228:229], v214 offset:5120
    v_exp_f32_e64 v249, v249 clamp
    v_exp_f32_e64 v250, v250 clamp
    v_mfma_f32_16x16x32_bf16 v[116:119], a[232:235], a[60:63], v[116:119]
    ds_read_b64_tr_b16 a[230:231], v214 offset:17408
    buffer_load_dwordx4 v224, s[16:19], s50 offen offset:0  lds
    v_mfma_f32_16x16x32_bf16 v[124:127], a[236:239], a[60:63], v[124:127]
    ds_read_b64_tr_b16 a[232:233], v215 offset:4096
    v_exp_f32_e64 v251, v251 clamp
    v_mfma_f32_16x16x32_bf16 v[120:123], a[236:239], a[56:59], v[120:123]
    ds_read_b64_tr_b16 a[234:235], v215 offset:16384
    v_add_f32 v160, v160, v248
    v_mfma_f32_16x16x32_bf16 v[64:67], a[240:243], a[64:67], v[64:67]
    ds_read_b64_tr_b16 a[236:237], v215 offset:5120
    v_add_f32 v161, v161, v249
    v_mfma_f32_16x16x32_bf16 v[68:71], a[240:243], a[68:71], v[68:71]
    ds_read_b64_tr_b16 a[238:239], v215 offset:17408
    buffer_load_dwordx4 v225, s[20:23], s50 offen offset:1024  lds
    v_mfma_f32_16x16x32_bf16 v[76:79], a[244:247], a[68:71], v[76:79]
    s_waitcnt vmcnt(24)
    s_barrier
    ds_read_b64_tr_b16 a[240:241], v212 offset:24576
    v_add_f32 v162, v162, v250
    v_mfma_f32_16x16x32_bf16 v[72:75], a[244:247], a[64:67], v[72:75]
    ds_read_b64_tr_b16 a[242:243], v212 offset:36864
    v_add_f32 v163, v163, v251
    v_fmaak_f32 v164, v164, v12, 0x358637bd
    s_waitcnt lgkmcnt(6)
    v_mfma_f32_16x16x32_bf16 v[80:83], a[216:219], a[64:67], v[80:83]
    ds_read_b64_tr_b16 a[244:245], v212 offset:25600
    s_add_u32 m0, s39, 24576
    v_mfma_f32_16x16x32_bf16 v[84:87], a[216:219], a[68:71], v[84:87]
    ds_read_b64_tr_b16 a[246:247], v212 offset:37888
    v_fmaak_f32 v165, v165, v13, 0x358637bd
    v_fmaak_f32 v166, v166, v14, 0x358637bd
    v_mfma_f32_16x16x32_bf16 v[92:95], a[220:223], a[68:71], v[92:95]
    ds_read_b64_tr_b16 a[216:217], v213 offset:24576
    buffer_load_dwordx4 v224, s[16:19], s51 offen offset:0  lds
    v_mfma_f32_16x16x32_bf16 v[88:91], a[220:223], a[64:67], v[88:91]
    ds_read_b64_tr_b16 a[218:219], v213 offset:36864
    v_fmaak_f32 v167, v167, v15, 0x358637bd
    v_mfma_f32_16x16x32_bf16 v[96:99], a[224:227], a[64:67], v[96:99]
    ds_read_b64_tr_b16 a[220:221], v213 offset:25600
    v_mul_f32 v248, 0x3fb8aa3b, v164
    v_mfma_f32_16x16x32_bf16 v[100:103], a[224:227], a[68:71], v[100:103]
    ds_read_b64_tr_b16 a[222:223], v213 offset:37888
    buffer_load_dwordx4 v225, s[20:23], s51 offen offset:1024  lds
    v_mfma_f32_16x16x32_bf16 v[108:111], a[228:231], a[68:71], v[108:111]
    ds_read_b64_tr_b16 a[224:225], v214 offset:24576
    v_mul_f32 v249, 0x3fb8aa3b, v165
    v_mfma_f32_16x16x32_bf16 v[104:107], a[228:231], a[64:67], v[104:107]
    ds_read_b64_tr_b16 a[226:227], v214 offset:36864
    v_mul_f32 v250, 0x3fb8aa3b, v166
    s_waitcnt lgkmcnt(6)
    v_mfma_f32_16x16x32_bf16 v[112:115], a[232:235], a[64:67], v[112:115]
    ds_read_b64_tr_b16 a[228:229], v214 offset:25600
    v_mul_f32 v251, 0x3fb8aa3b, v167
    v_max_f32 v164, 0x358637bd, v164
    v_mfma_f32_16x16x32_bf16 v[116:119], a[232:235], a[68:71], v[116:119]
    ds_read_b64_tr_b16 a[230:231], v214 offset:37888
    buffer_load_dwordx4 v226, s[16:19], s52 offen offset:2048  lds
    v_mfma_f32_16x16x32_bf16 v[124:127], a[236:239], a[68:71], v[124:127]
    ds_read_b64_tr_b16 a[232:233], v215 offset:24576
    v_max_f32 v165, 0x358637bd, v165
    v_mfma_f32_16x16x32_bf16 v[120:123], a[236:239], a[64:67], v[120:123]
    ds_read_b64_tr_b16 a[234:235], v215 offset:36864
    v_max_f32 v166, 0x358637bd, v166
    v_mfma_f32_16x16x32_bf16 v[64:67], a[240:243], a[72:75], v[64:67]
    ds_read_b64_tr_b16 a[236:237], v215 offset:25600
    v_max_f32 v167, 0x358637bd, v167
    v_exp_f32_e64 v248, v248 clamp
    v_mfma_f32_16x16x32_bf16 v[68:71], a[240:243], a[76:79], v[68:71]
    ds_read_b64_tr_b16 a[238:239], v215 offset:37888
    buffer_load_dwordx4 v227, s[20:23], s52 offen offset:3072  lds
    v_mfma_f32_16x16x32_bf16 v[76:79], a[244:247], a[76:79], v[76:79]
    ds_read_b64_tr_b16 a[240:241], v212 offset:26624
    v_exp_f32_e64 v249, v249 clamp
    v_mfma_f32_16x16x32_bf16 v[72:75], a[244:247], a[72:75], v[72:75]
    ds_read_b64_tr_b16 a[242:243], v212 offset:38912
    s_add_u32 m0, s39, 28672
    v_exp_f32_e64 v250, v250 clamp
    s_waitcnt lgkmcnt(6)
    v_mfma_f32_16x16x32_bf16 v[80:83], a[216:219], a[72:75], v[80:83]
    ds_read_b64_tr_b16 a[244:245], v212 offset:27648
    buffer_load_dwordx4 v224, s[16:19], s53 offen offset:0  lds
    v_mfma_f32_16x16x32_bf16 v[84:87], a[216:219], a[76:79], v[84:87]
    ds_read_b64_tr_b16 a[246:247], v212 offset:39936
    v_exp_f32_e64 v251, v251 clamp
    v_mfma_f32_16x16x32_bf16 v[92:95], a[220:223], a[76:79], v[92:95]
    ds_read_b64_tr_b16 a[216:217], v213 offset:26624
    v_add_f32 v164, v164, v248
    v_mfma_f32_16x16x32_bf16 v[88:91], a[220:223], a[72:75], v[88:91]
    ds_read_b64_tr_b16 a[218:219], v213 offset:38912
    v_add_f32 v165, v165, v249
    v_add_f32 v166, v166, v250
    v_mfma_f32_16x16x32_bf16 v[96:99], a[224:227], a[72:75], v[96:99]
    ds_read_b64_tr_b16 a[220:221], v213 offset:27648
    buffer_load_dwordx4 v225, s[20:23], s53 offen offset:1024  lds
    v_mfma_f32_16x16x32_bf16 v[100:103], a[224:227], a[76:79], v[100:103]
    ds_read_b64_tr_b16 a[222:223], v213 offset:39936
    v_add_f32 v167, v167, v251
    v_cvt_pk_bf16_f32 v16, v160, v161
    v_mfma_f32_16x16x32_bf16 v[108:111], a[228:231], a[76:79], v[108:111]
    ds_read_b64_tr_b16 a[224:225], v214 offset:26624
    v_accvgpr_read_b32 v254, a170
    v_cvt_pk_bf16_f32 v17, v162, v163
    v_mfma_f32_16x16x32_bf16 v[104:107], a[228:231], a[72:75], v[104:107]
    ds_read_b64_tr_b16 a[226:227], v214 offset:38912
    buffer_load_dword a215, v254, s[16:19], s100 offen offset:512
    s_waitcnt lgkmcnt(6)
    v_mfma_f32_16x16x32_bf16 v[112:115], a[232:235], a[72:75], v[112:115]
    ds_read_b64_tr_b16 a[228:229], v214 offset:27648
    buffer_load_dword a215, v254, s[20:23], s100 offen offset:512
    v_mfma_f32_16x16x32_bf16 v[116:119], a[232:235], a[76:79], v[116:119]
    ds_read_b64_tr_b16 a[230:231], v214 offset:39936
    v_cvt_pk_bf16_f32 v18, v164, v165
    v_mfma_f32_16x16x32_bf16 v[124:127], a[236:239], a[76:79], v[124:127]
    ds_read_b64_tr_b16 a[232:233], v215 offset:26624
    v_cvt_pk_bf16_f32 v19, v166, v167
    v_mfma_f32_16x16x32_bf16 v[120:123], a[236:239], a[72:75], v[120:123]
    ds_read_b64_tr_b16 a[234:235], v215 offset:38912
    v_mfma_f32_16x16x32_bf16 v[192:195], v[32:35], v[42:45], 0
    v_mfma_f32_16x16x32_bf16 v[64:67], a[240:243], a[80:83], v[64:67]
    ds_read_b64_tr_b16 a[236:237], v215 offset:27648
    v_mfma_f32_16x16x32_bf16 v[196:199], v[32:35], v[40:43], 0
    v_mfma_f32_16x16x32_bf16 v[68:71], a[240:243], a[84:87], v[68:71]
    ds_read_b64_tr_b16 a[238:239], v215 offset:39936
    v_fmaak_f32 v168, v168, v8, 0x358637bd
    v_mfma_f32_16x16x32_bf16 v[76:79], a[244:247], a[84:87], v[76:79]
    ds_read_b64_tr_b16 a[240:241], v212 offset:28672
    v_fmaak_f32 v169, v169, v9, 0x358637bd
    v_mfma_f32_16x16x32_bf16 v[72:75], a[244:247], a[80:83], v[72:75]
    ds_read_b64_tr_b16 a[242:243], v212 offset:40960
    v_fmaak_f32 v170, v170, v10, 0x358637bd
    s_waitcnt lgkmcnt(6)
    v_mfma_f32_16x16x32_bf16 v[80:83], a[216:219], a[80:83], v[80:83]
    ds_read_b64_tr_b16 a[244:245], v212 offset:29696
    v_fmaak_f32 v171, v171, v11, 0x358637bd
    v_mfma_f32_16x16x32_bf16 v[84:87], a[216:219], a[84:87], v[84:87]
    ds_read_b64_tr_b16 a[246:247], v212 offset:41984
    v_mul_f32 v248, 0x3fb8aa3b, v168
    v_mfma_f32_16x16x32_bf16 v[92:95], a[220:223], a[84:87], v[92:95]
    ds_read_b64_tr_b16 a[216:217], v213 offset:28672
    v_mul_f32 v249, 0x3fb8aa3b, v169
    v_mfma_f32_16x16x32_bf16 v[88:91], a[220:223], a[80:83], v[88:91]
    ds_read_b64_tr_b16 a[218:219], v213 offset:40960
    v_mul_f32 v250, 0x3fb8aa3b, v170
    v_mfma_f32_16x16x32_bf16 v[96:99], a[224:227], a[80:83], v[96:99]
    ds_read_b64_tr_b16 a[220:221], v213 offset:29696
    v_mul_f32 v251, 0x3fb8aa3b, v171
    v_mfma_f32_16x16x32_bf16 v[100:103], a[224:227], a[84:87], v[100:103]
    ds_read_b64_tr_b16 a[222:223], v213 offset:41984
    v_max_f32 v168, 0x358637bd, v168
    v_mfma_f32_16x16x32_bf16 v[108:111], a[228:231], a[84:87], v[108:111]
    ds_read_b64_tr_b16 a[224:225], v214 offset:28672
    v_max_f32 v169, 0x358637bd, v169
    v_mfma_f32_16x16x32_bf16 v[104:107], a[228:231], a[80:83], v[104:107]
    ds_read_b64_tr_b16 a[226:227], v214 offset:40960
    v_max_f32 v170, 0x358637bd, v170
    s_waitcnt lgkmcnt(6)
    v_mfma_f32_16x16x32_bf16 v[112:115], a[232:235], a[80:83], v[112:115]
    ds_read_b64_tr_b16 a[228:229], v214 offset:29696
    v_max_f32 v171, 0x358637bd, v171
    v_mfma_f32_16x16x32_bf16 v[116:119], a[232:235], a[84:87], v[116:119]
    ds_read_b64_tr_b16 a[230:231], v214 offset:41984
    v_exp_f32_e64 v248, v248 clamp
    v_mfma_f32_16x16x32_bf16 v[124:127], a[236:239], a[84:87], v[124:127]
    ds_read_b64_tr_b16 a[232:233], v215 offset:28672
    v_mfma_f32_16x16x32_bf16 v[120:123], a[236:239], a[80:83], v[120:123]
    ds_read_b64_tr_b16 a[234:235], v215 offset:40960
    v_exp_f32_e64 v249, v249 clamp
    v_mfma_f32_16x16x32_bf16 v[64:67], a[240:243], a[88:91], v[64:67]
    ds_read_b64_tr_b16 a[236:237], v215 offset:29696
    v_exp_f32_e64 v250, v250 clamp
    v_mfma_f32_16x16x32_bf16 v[68:71], a[240:243], a[92:95], v[68:71]
    ds_read_b64_tr_b16 a[238:239], v215 offset:41984
    v_exp_f32_e64 v251, v251 clamp
    v_mfma_f32_16x16x32_bf16 v[76:79], a[244:247], a[92:95], v[76:79]
    s_waitcnt vmcnt(26)
    s_barrier
    v_add_u32 v212, 0xc000, v212
    ds_read_b64_tr_b16 a[240:241], v212 offset:0
    v_add_f32 v168, v168, v248
    v_mfma_f32_16x16x32_bf16 v[72:75], a[244:247], a[88:91], v[72:75]
    ds_read_b64_tr_b16 a[242:243], v212 offset:12288
    v_add_f32 v169, v169, v249
    s_waitcnt lgkmcnt(6)
    v_mfma_f32_16x16x32_bf16 v[80:83], a[216:219], a[88:91], v[80:83]
    ds_read_b64_tr_b16 a[244:245], v212 offset:1024
    v_add_f32 v170, v170, v250
    v_mfma_f32_16x16x32_bf16 v[84:87], a[216:219], a[92:95], v[84:87]
    ds_read_b64_tr_b16 a[246:247], v212 offset:13312
    v_add_f32 v171, v171, v251
    v_mfma_f32_16x16x32_bf16 v[92:95], a[220:223], a[92:95], v[92:95]
    v_add_u32 v213, 0xc000, v213
    ds_read_b64_tr_b16 a[216:217], v213 offset:0
    v_fmaak_f32 v172, v172, v12, 0x358637bd
    v_mfma_f32_16x16x32_bf16 v[88:91], a[220:223], a[88:91], v[88:91]
    ds_read_b64_tr_b16 a[218:219], v213 offset:12288
    v_fmaak_f32 v173, v173, v13, 0x358637bd
    v_mfma_f32_16x16x32_bf16 v[96:99], a[224:227], a[88:91], v[96:99]
    ds_read_b64_tr_b16 a[220:221], v213 offset:1024
    v_mfma_f32_16x16x32_bf16 v[100:103], a[224:227], a[92:95], v[100:103]
    ds_read_b64_tr_b16 a[222:223], v213 offset:13312
    v_fmaak_f32 v174, v174, v14, 0x358637bd
    v_mfma_f32_16x16x32_bf16 v[108:111], a[228:231], a[92:95], v[108:111]
    v_add_u32 v214, 0xc000, v214
    ds_read_b64_tr_b16 a[224:225], v214 offset:0
    v_fmaak_f32 v175, v175, v15, 0x358637bd
    v_mfma_f32_16x16x32_bf16 v[104:107], a[228:231], a[88:91], v[104:107]
    ds_read_b64_tr_b16 a[226:227], v214 offset:12288
    v_mul_f32 v248, 0x3fb8aa3b, v172
    s_waitcnt lgkmcnt(6)
    v_mfma_f32_16x16x32_bf16 v[112:115], a[232:235], a[88:91], v[112:115]
    ds_read_b64_tr_b16 a[228:229], v214 offset:1024
    v_mul_f32 v249, 0x3fb8aa3b, v173
    v_mfma_f32_16x16x32_bf16 v[116:119], a[232:235], a[92:95], v[116:119]
    ds_read_b64_tr_b16 a[230:231], v214 offset:13312
    v_mul_f32 v250, 0x3fb8aa3b, v174
    v_mfma_f32_16x16x32_bf16 v[124:127], a[236:239], a[92:95], v[124:127]
    v_add_u32 v215, 0xc000, v215
    ds_read_b64_tr_b16 a[232:233], v215 offset:0
    v_mul_f32 v251, 0x3fb8aa3b, v175
    v_mfma_f32_16x16x32_bf16 v[120:123], a[236:239], a[88:91], v[120:123]
    ds_read_b64_tr_b16 a[234:235], v215 offset:12288
    v_max_f32 v172, 0x358637bd, v172
    v_mfma_f32_16x16x32_bf16 v[64:67], a[240:243], a[96:99], v[64:67]
    ds_read_b64_tr_b16 a[236:237], v215 offset:1024
    v_max_f32 v173, 0x358637bd, v173
    v_mfma_f32_16x16x32_bf16 v[68:71], a[240:243], a[100:103], v[68:71]
    ds_read_b64_tr_b16 a[238:239], v215 offset:13312
    v_mfma_f32_16x16x32_bf16 v[76:79], a[244:247], a[100:103], v[76:79]
    ds_read_b64_tr_b16 a[240:241], v212 offset:2048
    v_max_f32 v174, 0x358637bd, v174
    v_mfma_f32_16x16x32_bf16 v[72:75], a[244:247], a[96:99], v[72:75]
    ds_read_b64_tr_b16 a[242:243], v212 offset:14336
    v_max_f32 v175, 0x358637bd, v175
    s_waitcnt lgkmcnt(6)
    v_mfma_f32_16x16x32_bf16 v[80:83], a[216:219], a[96:99], v[80:83]
    ds_read_b64_tr_b16 a[244:245], v212 offset:3072
    v_exp_f32_e64 v248, v248 clamp
    v_mfma_f32_16x16x32_bf16 v[84:87], a[216:219], a[100:103], v[84:87]
    ds_read_b64_tr_b16 a[246:247], v212 offset:15360
    v_exp_f32_e64 v249, v249 clamp
    v_mfma_f32_16x16x32_bf16 v[92:95], a[220:223], a[100:103], v[92:95]
    ds_read_b64_tr_b16 a[216:217], v213 offset:2048
    v_exp_f32_e64 v250, v250 clamp
    v_mfma_f32_16x16x32_bf16 v[88:91], a[220:223], a[96:99], v[88:91]
    ds_read_b64_tr_b16 a[218:219], v213 offset:14336
    v_exp_f32_e64 v251, v251 clamp
    v_mfma_f32_16x16x32_bf16 v[96:99], a[224:227], a[96:99], v[96:99]
    ds_read_b64_tr_b16 a[220:221], v213 offset:3072
    v_add_f32 v172, v172, v248
    v_mfma_f32_16x16x32_bf16 v[100:103], a[224:227], a[100:103], v[100:103]
    ds_read_b64_tr_b16 a[222:223], v213 offset:15360
    v_add_f32 v173, v173, v249
    v_mfma_f32_16x16x32_bf16 v[108:111], a[228:231], a[100:103], v[108:111]
    ds_read_b64_tr_b16 a[224:225], v214 offset:2048
    v_add_f32 v174, v174, v250
    v_mfma_f32_16x16x32_bf16 v[104:107], a[228:231], a[96:99], v[104:107]
    ds_read_b64_tr_b16 a[226:227], v214 offset:14336
    s_waitcnt lgkmcnt(6)
    v_mfma_f32_16x16x32_bf16 v[112:115], a[232:235], a[96:99], v[112:115]
    ds_read_b64_tr_b16 a[228:229], v214 offset:3072
    s_add_u32 m0, s39, 49152
    v_mfma_f32_16x16x32_bf16 v[116:119], a[232:235], a[100:103], v[116:119]
    ds_read_b64_tr_b16 a[230:231], v214 offset:15360
    v_add_f32 v175, v175, v251
    v_cvt_pk_bf16_f32 v20, v168, v169
    v_mfma_f32_16x16x32_bf16 v[124:127], a[236:239], a[100:103], v[124:127]
    ds_read_b64_tr_b16 a[232:233], v215 offset:2048
    buffer_load_dwordx4 v224, s[16:19], s54 offen offset:0  lds
    v_mfma_f32_16x16x32_bf16 v[120:123], a[236:239], a[96:99], v[120:123]
    ds_read_b64_tr_b16 a[234:235], v215 offset:14336
    v_cvt_pk_bf16_f32 v21, v170, v171
    v_mfma_f32_16x16x32_bf16 v[64:67], a[240:243], a[104:107], v[64:67]
    ds_read_b64_tr_b16 a[236:237], v215 offset:3072
    v_cvt_pk_bf16_f32 v22, v172, v173
    v_mfma_f32_16x16x32_bf16 v[68:71], a[240:243], a[108:111], v[68:71]
    ds_read_b64_tr_b16 a[238:239], v215 offset:15360
    v_cvt_pk_bf16_f32 v23, v174, v175
    v_cvt_pk_bf16_f32 v236, v192, v193
    v_mfma_f32_16x16x32_bf16 v[76:79], a[244:247], a[108:111], v[76:79]
    ds_read_b64_tr_b16 a[240:241], v212 offset:4096
    buffer_load_dwordx4 v225, s[20:23], s54 offen offset:1024  lds
    v_mfma_f32_16x16x32_bf16 v[72:75], a[244:247], a[104:107], v[72:75]
    ds_read_b64_tr_b16 a[242:243], v212 offset:16384
    v_cvt_pk_bf16_f32 v237, v194, v195
    s_waitcnt lgkmcnt(6)
    v_mfma_f32_16x16x32_bf16 v[80:83], a[216:219], a[104:107], v[80:83]
    ds_read_b64_tr_b16 a[244:245], v212 offset:5120
    v_mov_b32 v238, 0
    v_mov_b32 v239, 0
    v_mfma_f32_16x16x32_bf16 v[84:87], a[216:219], a[108:111], v[84:87]
    ds_read_b64_tr_b16 a[246:247], v212 offset:17408
    buffer_load_dwordx4 v226, s[16:19], s55 offen offset:2048  lds
    v_mfma_f32_16x16x32_bf16 v[92:95], a[220:223], a[108:111], v[92:95]
    ds_read_b64_tr_b16 a[216:217], v213 offset:4096
    v_cvt_pk_bf16_f32 v244, v196, v197
    v_mfma_f32_16x16x32_bf16 v[88:91], a[220:223], a[104:107], v[88:91]
    ds_read_b64_tr_b16 a[218:219], v213 offset:16384
    v_cvt_pk_bf16_f32 v245, v198, v199
    v_mfma_f32_16x16x32_bf16 v[96:99], a[224:227], a[104:107], v[96:99]
    ds_read_b64_tr_b16 a[220:221], v213 offset:5120
    v_mov_b32 v252, 0
    v_mov_b32 v246, 0
    v_mfma_f32_16x16x32_bf16 v[100:103], a[224:227], a[108:111], v[100:103]
    ds_read_b64_tr_b16 a[222:223], v213 offset:17408
    buffer_load_dwordx4 v227, s[20:23], s55 offen offset:3072  lds
    v_mov_b32 v247, 0
    v_mfma_f32_16x16x32_bf16 v[108:111], a[228:231], a[108:111], v[108:111]
    ds_read_b64_tr_b16 a[224:225], v214 offset:4096
    s_xor_b32 s77, s47, 256
    buffer_load_dword v253, v252, s[32:35], s77 offen sc1
    v_mfma_f32_16x16x32_bf16 v[104:107], a[228:231], a[104:107], v[104:107]
    ds_read_b64_tr_b16 a[226:227], v214 offset:16384
    s_add_u32 m0, s39, 53248
    v_mfma_f32_16x16x32_bf16 v[144:147], v[16:19], v[24:27], 0
    s_waitcnt lgkmcnt(6)
    v_mfma_f32_16x16x32_bf16 v[112:115], a[232:235], a[104:107], v[112:115]
    ds_read_b64_tr_b16 a[228:229], v214 offset:5120
    v_mfma_f32_16x16x32_bf16 v[148:151], v[16:19], v[28:31], 0
    v_mfma_f32_16x16x32_bf16 v[116:119], a[232:235], a[108:111], v[116:119]
    ds_read_b64_tr_b16 a[230:231], v214 offset:17408
    buffer_load_dwordx4 v224, s[16:19], s56 offen offset:0  lds
    v_mfma_f32_16x16x32_bf16 v[124:127], a[236:239], a[108:111], v[124:127]
    ds_read_b64_tr_b16 a[232:233], v215 offset:4096
    v_mfma_f32_16x16x32_bf16 v[152:155], v[16:19], v[32:35], 0
    v_mfma_f32_16x16x32_bf16 v[120:123], a[236:239], a[104:107], v[120:123]
    ds_read_b64_tr_b16 a[234:235], v215 offset:16384
    v_mfma_f32_16x16x32_bf16 v[156:159], v[20:23], v[24:27], 0
    v_mfma_f32_16x16x32_bf16 v[64:67], a[240:243], a[112:115], v[64:67]
    ds_read_b64_tr_b16 a[236:237], v215 offset:5120
    v_mfma_f32_16x16x32_bf16 v[160:163], v[20:23], v[28:31], 0
    v_mfma_f32_16x16x32_bf16 v[164:167], v[20:23], v[32:35], 0
    v_mfma_f32_16x16x32_bf16 v[68:71], a[240:243], a[116:119], v[68:71]
    ds_read_b64_tr_b16 a[238:239], v215 offset:17408
    buffer_load_dwordx4 v225, s[20:23], s56 offen offset:1024  lds
    v_mfma_f32_16x16x32_bf16 v[76:79], a[244:247], a[116:119], v[76:79]
    s_waitcnt vmcnt(27)
    s_waitcnt vmcnt(21)
    s_barrier
    ds_read_b64_tr_b16 a[240:241], v212 offset:24576
    s_add_u32 s42, s40, 1
    v_mov_b32 v254, s42
    buffer_store_dword v254, v255, s[32:35], s47 offen sc1
    v_mfma_f32_16x16x32_bf16 v[168:171], v[32:35], v[28:31], 0
    v_mfma_f32_16x16x32_bf16 v[72:75], a[244:247], a[112:115], v[72:75]
    ds_read_b64_tr_b16 a[242:243], v212 offset:36864
    v_mfma_f32_16x16x32_bf16 v[172:175], v[32:35], v[32:35], 0
    s_waitcnt lgkmcnt(6)
    v_mfma_f32_16x16x32_bf16 v[80:83], a[216:219], a[112:115], v[80:83]
    ds_read_b64_tr_b16 a[244:245], v212 offset:25600
    v_mfma_f32_16x16x32_bf16 v[84:87], a[216:219], a[116:119], v[84:87]
    ds_read_b64_tr_b16 a[246:247], v212 offset:37888
    v_mfma_f32_16x16x32_bf16 v[92:95], a[220:223], a[116:119], v[92:95]
    ds_read_b64_tr_b16 a[216:217], v213 offset:24576
    s_add_u32 m0, s39, 73728
    v_mfma_f32_16x16x32_bf16 v[88:91], a[220:223], a[112:115], v[88:91]
    ds_read_b64_tr_b16 a[218:219], v213 offset:36864
    v_mfma_f32_16x16x32_bf16 v[96:99], a[224:227], a[112:115], v[96:99]
    ds_read_b64_tr_b16 a[220:221], v213 offset:25600
    ds_write_b128 v0, v[144:147]
    v_mfma_f32_16x16x32_bf16 v[100:103], a[224:227], a[116:119], v[100:103]
    ds_read_b64_tr_b16 a[222:223], v213 offset:37888
    buffer_load_dwordx4 v224, s[16:19], s57 offen offset:0  lds
    v_mfma_f32_16x16x32_bf16 v[108:111], a[228:231], a[116:119], v[108:111]
    ds_read_b64_tr_b16 a[224:225], v214 offset:24576
    v_mfma_f32_16x16x32_bf16 v[104:107], a[228:231], a[112:115], v[104:107]
    ds_read_b64_tr_b16 a[226:227], v214 offset:36864
    s_waitcnt lgkmcnt(7)
    v_mfma_f32_16x16x32_bf16 v[112:115], a[232:235], a[112:115], v[112:115]
    ds_read_b64_tr_b16 a[228:229], v214 offset:25600
    ds_write_b128 v1, v[148:151]
    v_mfma_f32_16x16x32_bf16 v[116:119], a[232:235], a[116:119], v[116:119]
    ds_read_b64_tr_b16 a[230:231], v214 offset:37888
    v_mfma_f32_16x16x32_bf16 v[124:127], a[236:239], a[116:119], v[124:127]
    ds_read_b64_tr_b16 a[232:233], v215 offset:24576
    v_mfma_f32_16x16x32_bf16 v[120:123], a[236:239], a[112:115], v[120:123]
    ds_read_b64_tr_b16 a[234:235], v215 offset:36864
    v_mfma_f32_16x16x32_bf16 v[64:67], a[240:243], a[120:123], v[64:67]
    ds_read_b64_tr_b16 a[236:237], v215 offset:25600
    ds_write_b128 v2, v[152:155]
    v_mfma_f32_16x16x32_bf16 v[68:71], a[240:243], a[124:127], v[68:71]
    ds_read_b64_tr_b16 a[238:239], v215 offset:37888
    buffer_load_dwordx4 v225, s[20:23], s57 offen offset:1024  lds
    v_mfma_f32_16x16x32_bf16 v[76:79], a[244:247], a[124:127], v[76:79]
    ds_read_b64_tr_b16 a[240:241], v212 offset:26624
    v_mfma_f32_16x16x32_bf16 v[72:75], a[244:247], a[120:123], v[72:75]
    ds_read_b64_tr_b16 a[242:243], v212 offset:38912
    s_waitcnt lgkmcnt(7)
    v_mfma_f32_16x16x32_bf16 v[80:83], a[216:219], a[120:123], v[80:83]
    ds_read_b64_tr_b16 a[244:245], v212 offset:27648
    ds_write_b128 v3, v[156:159]
    v_mfma_f32_16x16x32_bf16 v[84:87], a[216:219], a[124:127], v[84:87]
    ds_read_b64_tr_b16 a[246:247], v212 offset:39936
    v_mfma_f32_16x16x32_bf16 v[92:95], a[220:223], a[124:127], v[92:95]
    ds_read_b64_tr_b16 a[216:217], v213 offset:26624
    v_mfma_f32_16x16x32_bf16 v[88:91], a[220:223], a[120:123], v[88:91]
    ds_read_b64_tr_b16 a[218:219], v213 offset:38912
    v_mfma_f32_16x16x32_bf16 v[96:99], a[224:227], a[120:123], v[96:99]
    ds_read_b64_tr_b16 a[220:221], v213 offset:27648
    v_mfma_f32_16x16x32_bf16 v[100:103], a[224:227], a[124:127], v[100:103]
    ds_read_b64_tr_b16 a[222:223], v213 offset:39936
    buffer_load_dwordx4 v226, s[16:19], s58 offen offset:2048  lds
    v_mfma_f32_16x16x32_bf16 v[108:111], a[228:231], a[124:127], v[108:111]
    ds_read_b64_tr_b16 a[224:225], v214 offset:26624
    ds_write_b128 v4, v[160:163]
    v_mfma_f32_16x16x32_bf16 v[104:107], a[228:231], a[120:123], v[104:107]
    ds_read_b64_tr_b16 a[226:227], v214 offset:38912
    s_waitcnt lgkmcnt(7)
    v_mfma_f32_16x16x32_bf16 v[112:115], a[232:235], a[120:123], v[112:115]
    ds_read_b64_tr_b16 a[228:229], v214 offset:27648
    v_mfma_f32_16x16x32_bf16 v[116:119], a[232:235], a[124:127], v[116:119]
    ds_read_b64_tr_b16 a[230:231], v214 offset:39936
    ds_write_b128 v5, v[164:167]
    v_mfma_f32_16x16x32_bf16 v[124:127], a[236:239], a[124:127], v[124:127]
    ds_read_b64_tr_b16 a[232:233], v215 offset:26624
    v_mfma_f32_16x16x32_bf16 v[120:123], a[236:239], a[120:123], v[120:123]
    ds_read_b64_tr_b16 a[234:235], v215 offset:38912
    v_mfma_f32_16x16x32_bf16 v[64:67], a[240:243], a[128:131], v[64:67]
    ds_read_b64_tr_b16 a[236:237], v215 offset:27648
    v_mfma_f32_16x16x32_bf16 v[68:71], a[240:243], a[132:135], v[68:71]
    ds_read_b64_tr_b16 a[238:239], v215 offset:39936
    buffer_load_dwordx4 v227, s[20:23], s58 offen offset:3072  lds
    v_mfma_f32_16x16x32_bf16 v[76:79], a[244:247], a[132:135], v[76:79]
    ds_read_b64_tr_b16 a[240:241], v212 offset:28672
    ds_write_b128 v6, v[168:171]
    v_mfma_f32_16x16x32_bf16 v[72:75], a[244:247], a[128:131], v[72:75]
    ds_read_b64_tr_b16 a[242:243], v212 offset:40960
    s_waitcnt lgkmcnt(8)
    v_mfma_f32_16x16x32_bf16 v[80:83], a[216:219], a[128:131], v[80:83]
    ds_read_b64_tr_b16 a[244:245], v212 offset:29696
    v_mfma_f32_16x16x32_bf16 v[84:87], a[216:219], a[132:135], v[84:87]
    ds_read_b64_tr_b16 a[246:247], v212 offset:41984
    s_add_u32 m0, s39, 77824
    v_mfma_f32_16x16x32_bf16 v[92:95], a[220:223], a[132:135], v[92:95]
    ds_read_b64_tr_b16 a[216:217], v213 offset:28672
    ds_write_b128 v7, v[172:175]
    v_mfma_f32_16x16x32_bf16 v[88:91], a[220:223], a[128:131], v[88:91]
    ds_read_b64_tr_b16 a[218:219], v213 offset:40960
    v_mfma_f32_16x16x32_bf16 v[96:99], a[224:227], a[128:131], v[96:99]
    ds_read_b64_tr_b16 a[220:221], v213 offset:29696
    buffer_load_dwordx4 v224, s[16:19], s59 offen offset:0  lds
    v_mfma_f32_16x16x32_bf16 v[100:103], a[224:227], a[132:135], v[100:103]
    ds_read_b64_tr_b16 a[222:223], v213 offset:41984
    v_mfma_f32_16x16x32_bf16 v[108:111], a[228:231], a[132:135], v[108:111]
    ds_read_b64_tr_b16 a[224:225], v214 offset:28672
    v_mfma_f32_16x16x32_bf16 v[104:107], a[228:231], a[128:131], v[104:107]
    ds_read_b64_tr_b16 a[226:227], v214 offset:40960
    s_waitcnt lgkmcnt(7)
    v_mfma_f32_16x16x32_bf16 v[112:115], a[232:235], a[128:131], v[112:115]
    ds_read_b64_tr_b16 a[228:229], v214 offset:29696
    v_mfma_f32_16x16x32_bf16 v[116:119], a[232:235], a[132:135], v[116:119]
    ds_read_b64_tr_b16 a[230:231], v214 offset:41984
    v_mfma_f32_16x16x32_bf16 v[124:127], a[236:239], a[132:135], v[124:127]
    ds_read_b64_tr_b16 a[232:233], v215 offset:28672
    v_mfma_f32_16x16x32_bf16 v[120:123], a[236:239], a[128:131], v[120:123]
    ds_read_b64_tr_b16 a[234:235], v215 offset:40960
    v_mfma_f32_16x16x32_bf16 v[64:67], a[240:243], a[136:139], v[64:67]
    ds_read_b64_tr_b16 a[236:237], v215 offset:29696
    buffer_load_dwordx4 v225, s[20:23], s59 offen offset:1024  lds
    v_mfma_f32_16x16x32_bf16 v[68:71], a[240:243], a[140:143], v[68:71]
    ds_read_b64_tr_b16 a[238:239], v215 offset:41984
    v_mfma_f32_16x16x32_bf16 v[76:79], a[244:247], a[140:143], v[76:79]
    s_waitcnt vmcnt(22)
    s_waitcnt lgkmcnt(11)
    s_barrier
    v_add_u32 v212, 0xfffe8000, v212
    ds_read_b64_tr_b16 a[240:241], v212 offset:0
    v_mfma_f32_16x16x32_bf16 v[72:75], a[244:247], a[136:139], v[72:75]
    ds_read_b64_tr_b16 a[242:243], v212 offset:12288
    s_mul_i32 s42, s36, 912
    s_add_u32 s42, s42, 147456
    v_add_u32 v248, s42, v208
    s_waitcnt lgkmcnt(6)
    v_mfma_f32_16x16x32_bf16 v[80:83], a[216:219], a[136:139], v[80:83]
    ds_read_b64_tr_b16 a[244:245], v212 offset:1024
    v_mfma_f32_16x16x32_bf16 v[84:87], a[216:219], a[140:143], v[84:87]
    ds_read_b64_tr_b16 a[246:247], v212 offset:13312
    ds_read_b128 v[160:163], v248 offset:0
    v_mfma_f32_16x16x32_bf16 v[92:95], a[220:223], a[140:143], v[92:95]
    v_add_u32 v213, 0xfffe8000, v213
    ds_read_b64_tr_b16 a[216:217], v213 offset:0
    s_add_u32 m0, s39, 98304
    v_mfma_f32_16x16x32_bf16 v[88:91], a[220:223], a[136:139], v[88:91]
    ds_read_b64_tr_b16 a[218:219], v213 offset:12288
    ds_read_b128 v[164:167], v248 offset:3648
    v_mfma_f32_16x16x32_bf16 v[96:99], a[224:227], a[136:139], v[96:99]
    ds_read_b64_tr_b16 a[220:221], v213 offset:1024
    v_mfma_f32_16x16x32_bf16 v[100:103], a[224:227], a[140:143], v[100:103]
    ds_read_b64_tr_b16 a[222:223], v213 offset:13312
    buffer_load_dwordx4 v224, s[16:19], s60 offen offset:0  lds
    v_mfma_f32_16x16x32_bf16 v[108:111], a[228:231], a[140:143], v[108:111]
    v_add_u32 v214, 0xfffe8000, v214
    ds_read_b64_tr_b16 a[224:225], v214 offset:0
    ds_read_b128 v[168:171], v248 offset:7296
    v_mfma_f32_16x16x32_bf16 v[104:107], a[228:231], a[136:139], v[104:107]
    ds_read_b64_tr_b16 a[226:227], v214 offset:12288
    ds_read_b128 v[172:175], v248 offset:10944
    s_waitcnt lgkmcnt(10)
    v_mfma_f32_16x16x32_bf16 v[112:115], a[232:235], a[136:139], v[112:115]
    ds_read_b64_tr_b16 a[228:229], v214 offset:1024
    v_mfma_f32_16x16x32_bf16 v[116:119], a[232:235], a[140:143], v[116:119]
    ds_read_b64_tr_b16 a[230:231], v214 offset:13312
    s_waitcnt lgkmcnt(8)
    v_add_f32 v160, v160, v164
    v_mfma_f32_16x16x32_bf16 v[124:127], a[236:239], a[140:143], v[124:127]
    v_add_u32 v215, 0xfffe8000, v215
    ds_read_b64_tr_b16 a[232:233], v215 offset:0
    v_mfma_f32_16x16x32_bf16 v[120:123], a[236:239], a[136:139], v[120:123]
    ds_read_b64_tr_b16 a[234:235], v215 offset:12288
    v_add_f32 v161, v161, v165
    v_mfma_f32_16x16x32_bf16 v[0:3], a[240:243], a[0:3], 0
    ds_read_b64_tr_b16 a[236:237], v215 offset:1024
    v_mfma_f32_16x16x32_bf16 v[4:7], a[240:243], a[4:7], 0
    ds_read_b64_tr_b16 a[238:239], v215 offset:13312
    buffer_load_dwordx4 v225, s[20:23], s60 offen offset:1024  lds
    v_mfma_f32_16x16x32_bf16 v[12:15], a[244:247], a[4:7], 0
    ds_read_b64_tr_b16 a[240:241], v212 offset:2048
    v_add_f32 v162, v162, v166
    v_mfma_f32_16x16x32_bf16 v[8:11], a[244:247], a[0:3], 0
    ds_read_b64_tr_b16 a[242:243], v212 offset:14336
    v_add_f32 v163, v163, v167
    s_waitcnt lgkmcnt(6)
    v_mfma_f32_16x16x32_bf16 v[16:19], a[216:219], a[0:3], 0
    ds_read_b64_tr_b16 a[244:245], v212 offset:3072
    v_mfma_f32_16x16x32_bf16 v[20:23], a[216:219], a[4:7], 0
    ds_read_b64_tr_b16 a[246:247], v212 offset:15360
    v_add_f32 v168, v168, v172
    v_mfma_f32_16x16x32_bf16 v[28:31], a[220:223], a[4:7], 0
    ds_read_b64_tr_b16 a[216:217], v213 offset:2048
    v_mfma_f32_16x16x32_bf16 v[24:27], a[220:223], a[0:3], 0
    ds_read_b64_tr_b16 a[218:219], v213 offset:14336
    v_add_f32 v169, v169, v173
    v_mfma_f32_16x16x32_bf16 v[32:35], a[224:227], a[0:3], 0
    ds_read_b64_tr_b16 a[220:221], v213 offset:3072
    v_mfma_f32_16x16x32_bf16 v[36:39], a[224:227], a[4:7], 0
    ds_read_b64_tr_b16 a[222:223], v213 offset:15360
    buffer_load_dwordx4 v226, s[16:19], s61 offen offset:2048  lds
    v_mfma_f32_16x16x32_bf16 v[44:47], a[228:231], a[4:7], 0
    ds_read_b64_tr_b16 a[224:225], v214 offset:2048
    v_add_f32 v170, v170, v174
    v_mfma_f32_16x16x32_bf16 v[40:43], a[228:231], a[0:3], 0
    ds_read_b64_tr_b16 a[226:227], v214 offset:14336
    v_add_f32 v171, v171, v175
    s_waitcnt lgkmcnt(6)
    v_mfma_f32_16x16x32_bf16 v[48:51], a[232:235], a[0:3], 0
    ds_read_b64_tr_b16 a[228:229], v214 offset:3072
    v_mfma_f32_16x16x32_bf16 v[52:55], a[232:235], a[4:7], 0
    ds_read_b64_tr_b16 a[230:231], v214 offset:15360
    v_add_f32 v160, v160, v168
    v_mfma_f32_16x16x32_bf16 v[60:63], a[236:239], a[4:7], 0
    ds_read_b64_tr_b16 a[232:233], v215 offset:2048
    v_mfma_f32_16x16x32_bf16 v[56:59], a[236:239], a[0:3], 0
    ds_read_b64_tr_b16 a[234:235], v215 offset:14336
    v_add_f32 v161, v161, v169
    v_mfma_f32_16x16x32_bf16 v[0:3], a[240:243], a[8:11], v[0:3]
    ds_read_b64_tr_b16 a[236:237], v215 offset:3072
    v_mfma_f32_16x16x32_bf16 v[4:7], a[240:243], a[12:15], v[4:7]
    ds_read_b64_tr_b16 a[238:239], v215 offset:15360
    buffer_load_dwordx4 v227, s[20:23], s61 offen offset:3072  lds
    v_mfma_f32_16x16x32_bf16 v[12:15], a[244:247], a[12:15], v[12:15]
    ds_read_b64_tr_b16 a[240:241], v212 offset:4096
    v_add_f32 v162, v162, v170
    v_mfma_f32_16x16x32_bf16 v[8:11], a[244:247], a[8:11], v[8:11]
    ds_read_b64_tr_b16 a[242:243], v212 offset:16384
    v_add_f32 v163, v163, v171
    s_waitcnt lgkmcnt(6)
    v_mfma_f32_16x16x32_bf16 v[16:19], a[216:219], a[8:11], v[16:19]
    ds_read_b64_tr_b16 a[244:245], v212 offset:5120
    v_mfma_f32_16x16x32_bf16 v[20:23], a[216:219], a[12:15], v[20:23]
    ds_read_b64_tr_b16 a[246:247], v212 offset:17408
    s_add_u32 m0, s39, 102400
    buffer_store_dwordx4 v[160:163], v208, s[32:35], s76 offen sc1
    v_mfma_f32_16x16x32_bf16 v[28:31], a[220:223], a[12:15], v[28:31]
    ds_read_b64_tr_b16 a[216:217], v213 offset:4096
    s_add_u32 s42, s40, 1
    s_waitcnt vmcnt(14)
    v_subrev_u32 v253, s42, v253
    v_cmp_ge_u32 vcc, 14, v253
    s_nop 1
    s_cmp_eq_u64 vcc, exec
    s_cbranch_scc0 L_poll0_slow
L_poll0_ok:
    v_mfma_f32_16x16x32_bf16 v[24:27], a[220:223], a[8:11], v[24:27]
    ds_read_b64_tr_b16 a[218:219], v213 offset:16384
    v_mul_f32 v64, v64, v72
    v_mfma_f32_16x16x32_bf16 v[32:35], a[224:227], a[8:11], v[32:35]
    ds_read_b64_tr_b16 a[220:221], v213 offset:5120
    buffer_load_dwordx4 v224, s[16:19], s62 offen offset:0  lds
    v_mfma_f32_16x16x32_bf16 v[36:39], a[224:227], a[12:15], v[36:39]
    ds_read_b64_tr_b16 a[222:223], v213 offset:17408
    v_mul_f32 v65, v65, v73
    v_mul_f32 v66, v66, v74
    v_mfma_f32_16x16x32_bf16 v[44:47], a[228:231], a[12:15], v[44:47]
    ds_read_b64_tr_b16 a[224:225], v214 offset:4096
    buffer_load_dwordx4 a[144:147], v208, s[32:35], s75 offen offset:0 sc1
    v_mfma_f32_16x16x32_bf16 v[40:43], a[228:231], a[8:11], v[40:43]
    ds_read_b64_tr_b16 a[226:227], v214 offset:16384
    v_mul_f32 v67, v67, v75
    s_waitcnt lgkmcnt(6)
    v_mfma_f32_16x16x32_bf16 v[48:51], a[232:235], a[8:11], v[48:51]
    ds_read_b64_tr_b16 a[228:229], v214 offset:5120
    v_cvt_pk_bf16_f32 v144, v64, v65
    v_mfma_f32_16x16x32_bf16 v[52:55], a[232:235], a[12:15], v[52:55]
    ds_read_b64_tr_b16 a[230:231], v214 offset:17408
    v_cvt_pk_bf16_f32 v145, v66, v67
    v_mfma_f32_16x16x32_bf16 v[60:63], a[236:239], a[12:15], v[60:63]
    ds_read_b64_tr_b16 a[232:233], v215 offset:4096
    v_mul_f32 v68, v68, v76
    v_mfma_f32_16x16x32_bf16 v[56:59], a[236:239], a[8:11], v[56:59]
    ds_read_b64_tr_b16 a[234:235], v215 offset:16384
    buffer_load_dwordx4 a[148:151], v208, s[32:35], s75 offen offset:1024 sc1
    v_mfma_f32_16x16x32_bf16 v[0:3], a[240:243], a[16:19], v[0:3]
    ds_read_b64_tr_b16 a[236:237], v215 offset:5120
    buffer_load_dwordx4 v225, s[20:23], s62 offen offset:1024  lds
    v_mfma_f32_16x16x32_bf16 v[4:7], a[240:243], a[20:23], v[4:7]
    ds_read_b64_tr_b16 a[238:239], v215 offset:17408
    v_mul_f32 v69, v69, v77
    v_mfma_f32_16x16x32_bf16 v[12:15], a[244:247], a[20:23], v[12:15]
    s_waitcnt vmcnt(4)
    s_barrier
    ds_read_b64_tr_b16 a[240:241], v212 offset:24576
    s_add_u32 s42, s40, 2
    v_mov_b32 v254, s42
    buffer_store_dword v254, v255, s[32:35], s47 offen sc1
    v_mul_f32 v70, v70, v78
    v_mul_f32 v71, v71, v79
    v_mfma_f32_16x16x32_bf16 v[8:11], a[244:247], a[16:19], v[8:11]
    ds_read_b64_tr_b16 a[242:243], v212 offset:36864
    buffer_load_dwordx4 a[152:155], v208, s[32:35], s75 offen offset:2048 sc1
    s_waitcnt lgkmcnt(6)
    v_mfma_f32_16x16x32_bf16 v[16:19], a[216:219], a[16:19], v[16:19]
    ds_read_b64_tr_b16 a[244:245], v212 offset:25600
    v_cvt_pk_bf16_f32 v148, v68, v69
    v_mfma_f32_16x16x32_bf16 v[20:23], a[216:219], a[20:23], v[20:23]
    ds_read_b64_tr_b16 a[246:247], v212 offset:37888
    v_cvt_pk_bf16_f32 v149, v70, v71
    v_mfma_f32_16x16x32_bf16 v[28:31], a[220:223], a[20:23], v[28:31]
    ds_read_b64_tr_b16 a[216:217], v213 offset:24576
    s_add_u32 m0, s39, 122880
    v_mfma_f32_16x16x32_bf16 v[24:27], a[220:223], a[16:19], v[24:27]
    ds_read_b64_tr_b16 a[218:219], v213 offset:36864
    v_mul_f32 v80, v80, v88
    v_mov_b32 v200, 0
    v_mfma_f32_16x16x32_bf16 v[32:35], a[224:227], a[16:19], v[32:35]
    ds_read_b64_tr_b16 a[220:221], v213 offset:25600
    buffer_load_dwordx4 a[156:159], v208, s[32:35], s75 offen offset:3072 sc1
    v_mul_f32 v81, v81, v89
    v_mfma_f32_16x16x32_bf16 v[36:39], a[224:227], a[20:23], v[36:39]
    ds_read_b64_tr_b16 a[222:223], v213 offset:37888
    buffer_load_dwordx4 v224, s[16:19], s63 offen offset:0  lds
    v_mfma_f32_16x16x32_bf16 v[44:47], a[228:231], a[20:23], v[44:47]
    ds_read_b64_tr_b16 a[224:225], v214 offset:24576
    v_mul_f32 v82, v82, v90
    v_mov_b32 v201, 0
    v_mfma_f32_16x16x32_bf16 v[40:43], a[228:231], a[16:19], v[40:43]
    ds_read_b64_tr_b16 a[226:227], v214 offset:36864
    v_mul_f32 v83, v83, v91
    s_waitcnt lgkmcnt(6)
    v_mfma_f32_16x16x32_bf16 v[48:51], a[232:235], a[16:19], v[48:51]
    ds_read_b64_tr_b16 a[228:229], v214 offset:25600
    v_cvt_pk_bf16_f32 v146, v80, v81
    v_mfma_f32_16x16x32_bf16 v[52:55], a[232:235], a[20:23], v[52:55]
    ds_read_b64_tr_b16 a[230:231], v214 offset:37888
    v_cvt_pk_bf16_f32 v147, v82, v83
    v_mfma_f32_16x16x32_bf16 v[60:63], a[236:239], a[20:23], v[60:63]
    ds_read_b64_tr_b16 a[232:233], v215 offset:24576
    v_mul_f32 v84, v84, v92
    v_mfma_f32_16x16x32_bf16 v[56:59], a[236:239], a[16:19], v[56:59]
    ds_read_b64_tr_b16 a[234:235], v215 offset:36864
    v_mov_b32 v202, 0
    v_mfma_f32_16x16x32_bf16 v[0:3], a[240:243], a[24:27], v[0:3]
    ds_read_b64_tr_b16 a[236:237], v215 offset:25600
    v_mul_f32 v85, v85, v93
    v_mfma_f32_16x16x32_bf16 v[4:7], a[240:243], a[28:31], v[4:7]
    ds_read_b64_tr_b16 a[238:239], v215 offset:37888
    buffer_load_dwordx4 v225, s[20:23], s63 offen offset:1024  lds
    v_mov_b32 v203, 0
    v_mfma_f32_16x16x32_bf16 v[12:15], a[244:247], a[28:31], v[12:15]
    ds_read_b64_tr_b16 a[240:241], v212 offset:26624
    v_mul_f32 v86, v86, v94
    v_mfma_f32_16x16x32_bf16 v[8:11], a[244:247], a[24:27], v[8:11]
    ds_read_b64_tr_b16 a[242:243], v212 offset:38912
    v_mul_f32 v87, v87, v95
    s_waitcnt lgkmcnt(6)
    v_mfma_f32_16x16x32_bf16 v[16:19], a[216:219], a[24:27], v[16:19]
    ds_read_b64_tr_b16 a[244:245], v212 offset:27648
    v_cvt_pk_bf16_f32 v150, v84, v85
    s_mul_i32 s42, s36, 1296
    s_add_u32 s42, s42, 147456
    v_add_u32 v204, s42, v208
    v_mfma_f32_16x16x32_bf16 v[20:23], a[216:219], a[28:31], v[20:23]
    ds_read_b64_tr_b16 a[246:247], v212 offset:39936
    v_cvt_pk_bf16_f32 v151, v86, v87
    v_mfma_f32_16x16x32_bf16 v[28:31], a[220:223], a[28:31], v[28:31]
    ds_read_b64_tr_b16 a[216:217], v213 offset:26624
    v_mul_f32 v96, v96, v104
    v_mfma_f32_16x16x32_bf16 v[24:27], a[220:223], a[24:27], v[24:27]
    ds_read_b64_tr_b16 a[218:219], v213 offset:38912
    v_min_u32 v205, 16, v209
    v_mfma_f32_16x16x32_bf16 v[32:35], a[224:227], a[24:27], v[32:35]
    ds_read_b64_tr_b16 a[220:221], v213 offset:27648
    v_mul_f32 v97, v97, v105
    v_mfma_f32_16x16x32_bf16 v[36:39], a[224:227], a[28:31], v[36:39]
    ds_read_b64_tr_b16 a[222:223], v213 offset:39936
    buffer_load_dwordx4 v226, s[16:19], s64 offen offset:2048  lds
    v_mfma_f32_16x16x32_bf16 v[44:47], a[228:231], a[28:31], v[44:47]
    ds_read_b64_tr_b16 a[224:225], v214 offset:26624
    v_mul_f32 v98, v98, v106
    s_mul_i32 s42, s36, 1296
    s_add_u32 s42, s42, 148480
    v_lshl_add_u32 v205, v205, 4, s42
    v_mfma_f32_16x16x32_bf16 v[40:43], a[228:231], a[24:27], v[40:43]
    ds_read_b64_tr_b16 a[226:227], v214 offset:38912
    v_mul_f32 v99, v99, v107
    s_waitcnt lgkmcnt(6)
    v_mfma_f32_16x16x32_bf16 v[48:51], a[232:235], a[24:27], v[48:51]
    ds_read_b64_tr_b16 a[228:229], v214 offset:27648
    v_cvt_pk_bf16_f32 v152, v96, v97
    v_mfma_f32_16x16x32_bf16 v[52:55], a[232:235], a[28:31], v[52:55]
    ds_read_b64_tr_b16 a[230:231], v214 offset:39936
    v_cvt_pk_bf16_f32 v153, v98, v99
    v_mfma_f32_16x16x32_bf16 v[60:63], a[236:239], a[28:31], v[60:63]
    ds_read_b64_tr_b16 a[232:233], v215 offset:26624
    v_mul_f32 v100, v100, v108
    v_mfma_f32_16x16x32_bf16 v[56:59], a[236:239], a[24:27], v[56:59]
    ds_read_b64_tr_b16 a[234:235], v215 offset:38912
    ds_write_b128 v204, v[200:203]
    v_mfma_f32_16x16x32_bf16 v[0:3], a[240:243], a[32:35], v[0:3]
    ds_read_b64_tr_b16 a[236:237], v215 offset:27648
    v_mul_f32 v101, v101, v109
    v_mfma_f32_16x16x32_bf16 v[4:7], a[240:243], a[36:39], v[4:7]
    ds_read_b64_tr_b16 a[238:239], v215 offset:39936
    buffer_load_dwordx4 v227, s[20:23], s64 offen offset:3072  lds
    ds_write_b128 v205, v[200:203]
    v_mfma_f32_16x16x32_bf16 v[12:15], a[244:247], a[36:39], v[12:15]
    ds_read_b64_tr_b16 a[240:241], v212 offset:28672
    v_mul_f32 v102, v102, v110
    v_mfma_f32_16x16x32_bf16 v[8:11], a[244:247], a[32:35], v[8:11]
    ds_read_b64_tr_b16 a[242:243], v212 offset:40960
    v_mul_f32 v103, v103, v111
    s_waitcnt lgkmcnt(8)
    v_mfma_f32_16x16x32_bf16 v[16:19], a[216:219], a[32:35], v[16:19]
    ds_read_b64_tr_b16 a[244:245], v212 offset:29696
    v_cvt_pk_bf16_f32 v156, v100, v101
    v_mfma_f32_16x16x32_bf16 v[20:23], a[216:219], a[36:39], v[20:23]
    ds_read_b64_tr_b16 a[246:247], v212 offset:41984
    s_add_u32 m0, s39, 126976
    v_mfma_f32_16x16x32_bf16 v[28:31], a[220:223], a[36:39], v[28:31]
    ds_read_b64_tr_b16 a[216:217], v213 offset:28672
    v_cvt_pk_bf16_f32 v157, v102, v103
    v_mfma_f32_16x16x32_bf16 v[24:27], a[220:223], a[32:35], v[24:27]
    ds_read_b64_tr_b16 a[218:219], v213 offset:40960
    v_mul_f32 v112, v112, v120
    v_mfma_f32_16x16x32_bf16 v[32:35], a[224:227], a[32:35], v[32:35]
    ds_read_b64_tr_b16 a[220:221], v213 offset:29696
    buffer_load_dwordx4 v224, s[16:19], s65 offen offset:0  lds
    v_mfma_f32_16x16x32_bf16 v[36:39], a[224:227], a[36:39], v[36:39]
    ds_read_b64_tr_b16 a[222:223], v213 offset:41984
    v_mul_f32 v113, v113, v121
    v_mfma_f32_16x16x32_bf16 v[44:47], a[228:231], a[36:39], v[44:47]
    ds_read_b64_tr_b16 a[224:225], v214 offset:28672
    v_mul_f32 v114, v114, v122
    v_mfma_f32_16x16x32_bf16 v[40:43], a[228:231], a[32:35], v[40:43]
    ds_read_b64_tr_b16 a[226:227], v214 offset:40960
    v_mul_f32 v115, v115, v123
    s_waitcnt lgkmcnt(6)
    v_mfma_f32_16x16x32_bf16 v[48:51], a[232:235], a[32:35], v[48:51]
    ds_read_b64_tr_b16 a[228:229], v214 offset:29696
    v_cvt_pk_bf16_f32 v154, v112, v113
    v_mfma_f32_16x16x32_bf16 v[52:55], a[232:235], a[36:39], v[52:55]
    ds_read_b64_tr_b16 a[230:231], v214 offset:41984
    v_cvt_pk_bf16_f32 v155, v114, v115
    v_mfma_f32_16x16x32_bf16 v[60:63], a[236:239], a[36:39], v[60:63]
    ds_read_b64_tr_b16 a[232:233], v215 offset:28672
    v_mul_f32 v116, v116, v124
    v_mfma_f32_16x16x32_bf16 v[56:59], a[236:239], a[32:35], v[56:59]
    ds_read_b64_tr_b16 a[234:235], v215 offset:40960
    v_mfma_f32_16x16x32_bf16 v[0:3], a[240:243], a[40:43], v[0:3]
    ds_read_b64_tr_b16 a[236:237], v215 offset:29696
    buffer_load_dwordx4 v225, s[20:23], s65 offen offset:1024  lds
    v_mfma_f32_16x16x32_bf16 v[4:7], a[240:243], a[44:47], v[4:7]
    ds_read_b64_tr_b16 a[238:239], v215 offset:41984
    v_mul_f32 v117, v117, v125
    v_mfma_f32_16x16x32_bf16 v[12:15], a[244:247], a[44:47], v[12:15]
    s_barrier
    v_add_u32 v212, 0xc000, v212
    ds_read_b64_tr_b16 a[240:241], v212 offset:0
    v_mul_f32 v118, v118, v126
    v_mul_f32 v119, v119, v127
    v_mfma_f32_16x16x32_bf16 v[8:11], a[244:247], a[40:43], v[8:11]
    ds_read_b64_tr_b16 a[242:243], v212 offset:12288
    s_add_u32 m0, s39, 0
    s_waitcnt lgkmcnt(6)
    v_mfma_f32_16x16x32_bf16 v[16:19], a[216:219], a[40:43], v[16:19]
    ds_read_b64_tr_b16 a[244:245], v212 offset:1024
    v_add_u32 v224, 128, v224
    v_cvt_pk_bf16_f32 v158, v116, v117
    v_mfma_f32_16x16x32_bf16 v[20:23], a[216:219], a[44:47], v[20:23]
    ds_read_b64_tr_b16 a[246:247], v212 offset:13312
    v_add_u32 v225, 128, v225
    v_add_u32 v226, 128, v226
    v_add_u32 v227, 128, v227
    v_cvt_pk_bf16_f32 v159, v118, v119
    v_mfma_f32_16x16x32_bf16 v[28:31], a[220:223], a[44:47], v[28:31]
    v_add_u32 v213, 0xc000, v213
    ds_read_b64_tr_b16 a[216:217], v213 offset:0
    buffer_load_dwordx4 v224, s[16:19], s48 offen offset:0  lds
    v_mfma_f32_16x16x32_bf16 v[24:27], a[220:223], a[40:43], v[24:27]
    ds_read_b64_tr_b16 a[218:219], v213 offset:12288
    s_add_u32 s74, s46, 4096
    v_mfma_f32_16x16x32_bf16 v[32:35], a[224:227], a[40:43], v[32:35]
    ds_read_b64_tr_b16 a[220:221], v213 offset:1024
    v_mfma_f32_16x16x32_bf16 v[36:39], a[224:227], a[44:47], v[36:39]
    ds_read_b64_tr_b16 a[222:223], v213 offset:13312
    buffer_load_dwordx4 v225, s[20:23], s48 offen offset:1024  lds
    v_mfma_f32_16x16x32_bf16 v[44:47], a[228:231], a[44:47], v[44:47]
    v_add_u32 v214, 0xc000, v214
    ds_read_b64_tr_b16 a[224:225], v214 offset:0
    buffer_store_dwordx4 v[144:147], v208, s[32:35], s74 offen offset:0 sc1
    v_mfma_f32_16x16x32_bf16 v[40:43], a[228:231], a[40:43], v[40:43]
    ds_read_b64_tr_b16 a[226:227], v214 offset:12288
    s_waitcnt lgkmcnt(6)
    v_mfma_f32_16x16x32_bf16 v[48:51], a[232:235], a[40:43], v[48:51]
    ds_read_b64_tr_b16 a[228:229], v214 offset:1024
    buffer_store_dwordx4 v[148:151], v208, s[32:35], s74 offen offset:1024 sc1
    v_fmaak_f32 v176, v176, v210, 0x358637bd
    v_mfma_f32_16x16x32_bf16 v[52:55], a[232:235], a[44:47], v[52:55]
    ds_read_b64_tr_b16 a[230:231], v214 offset:13312
    buffer_load_dwordx4 v226, s[16:19], s49 offen offset:2048  lds
    v_mfma_f32_16x16x32_bf16 v[60:63], a[236:239], a[44:47], v[60:63]
    v_add_u32 v215, 0xc000, v215
    ds_read_b64_tr_b16 a[232:233], v215 offset:0
    buffer_store_dwordx4 v[152:155], v208, s[32:35], s74 offen offset:2048 sc1
    v_mfma_f32_16x16x32_bf16 v[56:59], a[236:239], a[40:43], v[56:59]
    ds_read_b64_tr_b16 a[234:235], v215 offset:12288
    v_fmaak_f32 v177, v177, v210, 0x358637bd
    v_mfma_f32_16x16x32_bf16 v[0:3], a[240:243], a[48:51], v[0:3]
    ds_read_b64_tr_b16 a[236:237], v215 offset:1024
    buffer_store_dwordx4 v[156:159], v208, s[32:35], s74 offen offset:3072 sc1
    v_fmaak_f32 v178, v178, v210, 0x358637bd
    v_mfma_f32_16x16x32_bf16 v[4:7], a[240:243], a[52:55], v[4:7]
    ds_read_b64_tr_b16 a[238:239], v215 offset:13312
    buffer_load_dwordx4 v227, s[20:23], s49 offen offset:3072  lds
    v_mfma_f32_16x16x32_bf16 v[12:15], a[244:247], a[52:55], v[12:15]
    ds_read_b64_tr_b16 a[240:241], v212 offset:2048
    v_fmaak_f32 v179, v179, v210, 0x358637bd
    v_mfma_f32_16x16x32_bf16 v[8:11], a[244:247], a[48:51], v[8:11]
    ds_read_b64_tr_b16 a[242:243], v212 offset:14336
    s_add_u32 m0, s39, 4096
    s_waitcnt lgkmcnt(6)
    v_mfma_f32_16x16x32_bf16 v[16:19], a[216:219], a[48:51], v[16:19]
    ds_read_b64_tr_b16 a[244:245], v212 offset:3072
    buffer_load_dwordx4 v224, s[16:19], s50 offen offset:0  lds
    v_mfma_f32_16x16x32_bf16 v[20:23], a[216:219], a[52:55], v[20:23]
    ds_read_b64_tr_b16 a[246:247], v212 offset:15360
    v_mul_f32 v248, 0x3fb8aa3b, v176
    v_mfma_f32_16x16x32_bf16 v[28:31], a[220:223], a[52:55], v[28:31]
    ds_read_b64_tr_b16 a[216:217], v213 offset:2048
    v_mul_f32 v249, 0x3fb8aa3b, v177
    v_mfma_f32_16x16x32_bf16 v[24:27], a[220:223], a[48:51], v[24:27]
    ds_read_b64_tr_b16 a[218:219], v213 offset:14336
    v_mfma_f32_16x16x32_bf16 v[32:35], a[224:227], a[48:51], v[32:35]
    ds_read_b64_tr_b16 a[220:221], v213 offset:3072
    buffer_load_dwordx4 v225, s[20:23], s50 offen offset:1024  lds
    v_mfma_f32_16x16x32_bf16 v[36:39], a[224:227], a[52:55], v[36:39]
    ds_read_b64_tr_b16 a[222:223], v213 offset:15360
    v_mul_f32 v250, 0x3fb8aa3b, v178
    v_mfma_f32_16x16x32_bf16 v[44:47], a[228:231], a[52:55], v[44:47]
    ds_read_b64_tr_b16 a[224:225], v214 offset:2048
    v_mfma_f32_16x16x32_bf16 v[40:43], a[228:231], a[48:51], v[40:43]
    ds_read_b64_tr_b16 a[226:227], v214 offset:14336
    v_mul_f32 v251, 0x3fb8aa3b, v179
    s_waitcnt lgkmcnt(6)
    v_mfma_f32_16x16x32_bf16 v[48:51], a[232:235], a[48:51], v[48:51]
    ds_read_b64_tr_b16 a[228:229], v214 offset:3072
    v_mfma_f32_16x16x32_bf16 v[52:55], a[232:235], a[52:55], v[52:55]
    ds_read_b64_tr_b16 a[230:231], v214 offset:15360
    v_max_f32 v176, 0x358637bd, v176
    v_mfma_f32_16x16x32_bf16 v[60:63], a[236:239], a[52:55], v[60:63]
    ds_read_b64_tr_b16 a[232:233], v215 offset:2048
    v_mfma_f32_16x16x32_bf16 v[56:59], a[236:239], a[48:51], v[56:59]
    ds_read_b64_tr_b16 a[234:235], v215 offset:14336
    v_max_f32 v177, 0x358637bd, v177
    v_mfma_f32_16x16x32_bf16 v[0:3], a[240:243], a[56:59], v[0:3]
    ds_read_b64_tr_b16 a[236:237], v215 offset:3072
    v_mfma_f32_16x16x32_bf16 v[4:7], a[240:243], a[60:63], v[4:7]
    ds_read_b64_tr_b16 a[238:239], v215 offset:15360
    v_max_f32 v178, 0x358637bd, v178
    v_mfma_f32_16x16x32_bf16 v[12:15], a[244:247], a[60:63], v[12:15]
    ds_read_b64_tr_b16 a[240:241], v212 offset:4096
    v_mfma_f32_16x16x32_bf16 v[8:11], a[244:247], a[56:59], v[8:11]
    ds_read_b64_tr_b16 a[242:243], v212 offset:16384
    v_max_f32 v179, 0x358637bd, v179
    s_waitcnt lgkmcnt(6)
    v_mfma_f32_16x16x32_bf16 v[16:19], a[216:219], a[56:59], v[16:19]
    ds_read_b64_tr_b16 a[244:245], v212 offset:5120
    v_mfma_f32_16x16x32_bf16 v[20:23], a[216:219], a[60:63], v[20:23]
    ds_read_b64_tr_b16 a[246:247], v212 offset:17408
    v_mfma_f32_16x16x32_bf16 v[28:31], a[220:223], a[60:63], v[28:31]
    ds_read_b64_tr_b16 a[216:217], v213 offset:4096
    v_exp_f32_e64 v248, v248 clamp
    v_mfma_f32_16x16x32_bf16 v[24:27], a[220:223], a[56:59], v[24:27]
    ds_read_b64_tr_b16 a[218:219], v213 offset:16384
    v_mfma_f32_16x16x32_bf16 v[32:35], a[224:227], a[56:59], v[32:35]
    ds_read_b64_tr_b16 a[220:221], v213 offset:5120
    v_exp_f32_e64 v249, v249 clamp
    v_mfma_f32_16x16x32_bf16 v[36:39], a[224:227], a[60:63], v[36:39]
    ds_read_b64_tr_b16 a[222:223], v213 offset:17408
    v_mfma_f32_16x16x32_bf16 v[44:47], a[228:231], a[60:63], v[44:47]
    ds_read_b64_tr_b16 a[224:225], v214 offset:4096
    v_exp_f32_e64 v250, v250 clamp
    v_mfma_f32_16x16x32_bf16 v[40:43], a[228:231], a[56:59], v[40:43]
    ds_read_b64_tr_b16 a[226:227], v214 offset:16384
    s_waitcnt lgkmcnt(6)
    v_mfma_f32_16x16x32_bf16 v[48:51], a[232:235], a[56:59], v[48:51]
    ds_read_b64_tr_b16 a[228:229], v214 offset:5120
    v_exp_f32_e64 v251, v251 clamp
    v_mfma_f32_16x16x32_bf16 v[52:55], a[232:235], a[60:63], v[52:55]
    ds_read_b64_tr_b16 a[230:231], v214 offset:17408
    v_mfma_f32_16x16x32_bf16 v[60:63], a[236:239], a[60:63], v[60:63]
    ds_read_b64_tr_b16 a[232:233], v215 offset:4096
    v_add_f32 v176, v176, v248
    v_mfma_f32_16x16x32_bf16 v[56:59], a[236:239], a[56:59], v[56:59]
    ds_read_b64_tr_b16 a[234:235], v215 offset:16384
    v_mfma_f32_16x16x32_bf16 v[0:3], a[240:243], a[64:67], v[0:3]
    ds_read_b64_tr_b16 a[236:237], v215 offset:5120
    v_add_f32 v177, v177, v249
    v_mfma_f32_16x16x32_bf16 v[4:7], a[240:243], a[68:71], v[4:7]
    ds_read_b64_tr_b16 a[238:239], v215 offset:17408
    v_mfma_f32_16x16x32_bf16 v[12:15], a[244:247], a[68:71], v[12:15]
    s_barrier
    ds_read_b64_tr_b16 a[240:241], v212 offset:24576
    v_mfma_f32_16x16x32_bf16 v[8:11], a[244:247], a[64:67], v[8:11]
    ds_read_b64_tr_b16 a[242:243], v212 offset:36864
    v_add_f32 v178, v178, v250
    s_waitcnt lgkmcnt(6)
    v_mfma_f32_16x16x32_bf16 v[16:19], a[216:219], a[64:67], v[16:19]
    ds_read_b64_tr_b16 a[244:245], v212 offset:25600
    v_lshrrev_b32 v252, 2, v209
    v_mfma_f32_16x16x32_bf16 v[20:23], a[216:219], a[68:71], v[20:23]
    ds_read_b64_tr_b16 a[246:247], v212 offset:37888
    v_add_f32 v179, v179, v251
    v_mfma_f32_16x16x32_bf16 v[28:31], a[220:223], a[68:71], v[28:31]
    ds_read_b64_tr_b16 a[216:217], v213 offset:24576
    v_mul_u32_u24 v252, 4096, v252
    v_mfma_f32_16x16x32_bf16 v[24:27], a[220:223], a[64:67], v[24:27]
    ds_read_b64_tr_b16 a[218:219], v213 offset:36864
    v_cvt_pk_bf16_f32 v232, v176, v177
    v_mfma_f32_16x16x32_bf16 v[32:35], a[224:227], a[64:67], v[32:35]
    ds_read_b64_tr_b16 a[220:221], v213 offset:25600
    s_xor_b32 s77, s38, 0
    s_mul_i32 s77, s77, 256
    s_add_u32 s77, s77, 47185920
    v_mfma_f32_16x16x32_bf16 v[36:39], a[224:227], a[68:71], v[36:39]
    ds_read_b64_tr_b16 a[222:223], v213 offset:37888
    v_cvt_pk_bf16_f32 v233, v178, v179
    v_mfma_f32_16x16x32_bf16 v[44:47], a[228:231], a[68:71], v[44:47]
    ds_read_b64_tr_b16 a[224:225], v214 offset:24576
    buffer_load_dword v253, v252, s[32:35], s77 offen sc1
    v_mfma_f32_16x16x32_bf16 v[40:43], a[228:231], a[64:67], v[40:43]
    ds_read_b64_tr_b16 a[226:227], v214 offset:36864
    v_fmaak_f32 v184, v184, v210, 0x358637bd
    s_waitcnt lgkmcnt(6)
    v_mfma_f32_16x16x32_bf16 v[48:51], a[232:235], a[64:67], v[48:51]
    ds_read_b64_tr_b16 a[228:229], v214 offset:25600
    v_mfma_f32_16x16x32_bf16 v[52:55], a[232:235], a[68:71], v[52:55]
    ds_read_b64_tr_b16 a[230:231], v214 offset:37888
    v_fmaak_f32 v185, v185, v210, 0x358637bd
    v_mfma_f32_16x16x32_bf16 v[60:63], a[236:239], a[68:71], v[60:63]
    ds_read_b64_tr_b16 a[232:233], v215 offset:24576
    v_mfma_f32_16x16x32_bf16 v[56:59], a[236:239], a[64:67], v[56:59]
    ds_read_b64_tr_b16 a[234:235], v215 offset:36864
    v_mfma_f32_16x16x32_bf16 v[0:3], a[240:243], a[72:75], v[0:3]
    ds_read_b64_tr_b16 a[236:237], v215 offset:25600
    v_fmaak_f32 v186, v186, v210, 0x358637bd
    v_mfma_f32_16x16x32_bf16 v[4:7], a[240:243], a[76:79], v[4:7]
    ds_read_b64_tr_b16 a[238:239], v215 offset:37888
    v_mfma_f32_16x16x32_bf16 v[12:15], a[244:247], a[76:79], v[12:15]
    ds_read_b64_tr_b16 a[240:241], v212 offset:26624
    v_fmaak_f32 v187, v187, v210, 0x358637bd
    v_mfma_f32_16x16x32_bf16 v[8:11], a[244:247], a[72:75], v[8:11]
    ds_read_b64_tr_b16 a[242:243], v212 offset:38912
    s_waitcnt lgkmcnt(6)
    v_mfma_f32_16x16x32_bf16 v[16:19], a[216:219], a[72:75], v[16:19]
    ds_read_b64_tr_b16 a[244:245], v212 offset:27648
    v_mul_f32 v248, 0x3fb8aa3b, v184
    v_mfma_f32_16x16x32_bf16 v[20:23], a[216:219], a[76:79], v[20:23]
    ds_read_b64_tr_b16 a[246:247], v212 offset:39936
    v_mfma_f32_16x16x32_bf16 v[28:31], a[220:223], a[76:79], v[28:31]
    ds_read_b64_tr_b16 a[216:217], v213 offset:26624
    v_mul_f32 v249, 0x3fb8aa3b, v185
    v_mfma_f32_16x16x32_bf16 v[24:27], a[220:223], a[72:75], v[24:27]
    ds_read_b64_tr_b16 a[218:219], v213 offset:38912
    v_mfma_f32_16x16x32_bf16 v[32:35], a[224:227], a[72:75], v[32:35]
    ds_read_b64_tr_b16 a[220:221], v213 offset:27648
    v_mul_f32 v250, 0x3fb8aa3b, v186
    v_mfma_f32_16x16x32_bf16 v[36:39], a[224:227], a[76:79], v[36:39]
    ds_read_b64_tr_b16 a[222:223], v213 offset:39936
    v_mfma_f32_16x16x32_bf16 v[44:47], a[228:231], a[76:79], v[44:47]
    ds_read_b64_tr_b16 a[224:225], v214 offset:26624
    v_mul_f32 v251, 0x3fb8aa3b, v187
    v_mfma_f32_16x16x32_bf16 v[40:43], a[228:231], a[72:75], v[40:43]
    ds_read_b64_tr_b16 a[226:227], v214 offset:38912
    s_waitcnt lgkmcnt(6)
    v_mfma_f32_16x16x32_bf16 v[48:51], a[232:235], a[72:75], v[48:51]
    ds_read_b64_tr_b16 a[228:229], v214 offset:27648
    s_add_u32 m0, s39, 24576
    v_mfma_f32_16x16x32_bf16 v[52:55], a[232:235], a[76:79], v[52:55]
    ds_read_b64_tr_b16 a[230:231], v214 offset:39936
    v_max_f32 v184, 0x358637bd, v184
    v_mfma_f32_16x16x32_bf16 v[60:63], a[236:239], a[76:79], v[60:63]
    ds_read_b64_tr_b16 a[232:233], v215 offset:26624
    buffer_load_dwordx4 v224, s[16:19], s51 offen offset:0  lds
    v_mfma_f32_16x16x32_bf16 v[56:59], a[236:239], a[72:75], v[56:59]
    ds_read_b64_tr_b16 a[234:235], v215 offset:38912
    v_max_f32 v185, 0x358637bd, v185
    v_mfma_f32_16x16x32_bf16 v[0:3], a[240:243], a[80:83], v[0:3]
    ds_read_b64_tr_b16 a[236:237], v215 offset:27648
    v_mfma_f32_16x16x32_bf16 v[4:7], a[240:243], a[84:87], v[4:7]
    ds_read_b64_tr_b16 a[238:239], v215 offset:39936
    v_max_f32 v186, 0x358637bd, v186
    v_mfma_f32_16x16x32_bf16 v[12:15], a[244:247], a[84:87], v[12:15]
    ds_read_b64_tr_b16 a[240:241], v212 offset:28672
    buffer_load_dwordx4 v225, s[20:23], s51 offen offset:1024  lds
    v_mfma_f32_16x16x32_bf16 v[8:11], a[244:247], a[80:83], v[8:11]
    ds_read_b64_tr_b16 a[242:243], v212 offset:40960
    v_max_f32 v187, 0x358637bd, v187
    s_waitcnt lgkmcnt(6)
    v_mfma_f32_16x16x32_bf16 v[16:19], a[216:219], a[80:83], v[16:19]
    ds_read_b64_tr_b16 a[244:245], v212 offset:29696
    v_mfma_f32_16x16x32_bf16 v[20:23], a[216:219], a[84:87], v[20:23]
    ds_read_b64_tr_b16 a[246:247], v212 offset:41984
    buffer_load_dwordx4 v226, s[16:19], s52 offen offset:2048  lds
    v_mfma_f32_16x16x32_bf16 v[28:31], a[220:223], a[84:87], v[28:31]
    ds_read_b64_tr_b16 a[216:217], v213 offset:28672
    v_exp_f32_e64 v248, v248 clamp
    v_mfma_f32_16x16x32_bf16 v[24:27], a[220:223], a[80:83], v[24:27]
    ds_read_b64_tr_b16 a[218:219], v213 offset:40960
    v_exp_f32_e64 v249, v249 clamp
    v_mfma_f32_16x16x32_bf16 v[32:35], a[224:227], a[80:83], v[32:35]
    ds_read_b64_tr_b16 a[220:221], v213 offset:29696
    v_mfma_f32_16x16x32_bf16 v[36:39], a[224:227], a[84:87], v[36:39]
    ds_read_b64_tr_b16 a[222:223], v213 offset:41984
    buffer_load_dwordx4 v227, s[20:23], s52 offen offset:3072  lds
    v_mfma_f32_16x16x32_bf16 v[44:47], a[228:231], a[84:87], v[44:47]
    ds_read_b64_tr_b16 a[224:225], v214 offset:28672
    v_exp_f32_e64 v250, v250 clamp
    v_mfma_f32_16x16x32_bf16 v[40:43], a[228:231], a[80:83], v[40:43]
    ds_read_b64_tr_b16 a[226:227], v214 offset:40960
    s_add_u32 m0, s39, 28672
    s_waitcnt lgkmcnt(6)
    v_mfma_f32_16x16x32_bf16 v[48:51], a[232:235], a[80:83], v[48:51]
    ds_read_b64_tr_b16 a[228:229], v214 offset:29696
    v_exp_f32_e64 v251, v251 clamp
    v_mfma_f32_16x16x32_bf16 v[52:55], a[232:235], a[84:87], v[52:55]
    ds_read_b64_tr_b16 a[230:231], v214 offset:41984
    buffer_load_dwordx4 v224, s[16:19], s53 offen offset:0  lds
    v_mfma_f32_16x16x32_bf16 v[60:63], a[236:239], a[84:87], v[60:63]
    ds_read_b64_tr_b16 a[232:233], v215 offset:28672
    v_add_f32 v184, v184, v248
    v_mfma_f32_16x16x32_bf16 v[56:59], a[236:239], a[80:83], v[56:59]
    ds_read_b64_tr_b16 a[234:235], v215 offset:40960
    v_mfma_f32_16x16x32_bf16 v[0:3], a[240:243], a[88:91], v[0:3]
    ds_read_b64_tr_b16 a[236:237], v215 offset:29696
    v_add_f32 v185, v185, v249
    v_mfma_f32_16x16x32_bf16 v[4:7], a[240:243], a[92:95], v[4:7]
    ds_read_b64_tr_b16 a[238:239], v215 offset:41984
    buffer_load_dwordx4 v225, s[20:23], s53 offen offset:1024  lds
    v_mfma_f32_16x16x32_bf16 v[12:15], a[244:247], a[92:95], v[12:15]
    s_waitcnt vmcnt(26)
    s_barrier
    v_add_u32 v212, 0xc000, v212
    ds_read_b64_tr_b16 a[240:241], v212 offset:0
    v_add_f32 v186, v186, v250
    v_mfma_f32_16x16x32_bf16 v[8:11], a[244:247], a[88:91], v[8:11]
    ds_read_b64_tr_b16 a[242:243], v212 offset:12288
    s_waitcnt lgkmcnt(6)
    v_mfma_f32_16x16x32_bf16 v[16:19], a[216:219], a[88:91], v[16:19]
    ds_read_b64_tr_b16 a[244:245], v212 offset:1024
    s_add_u32 m0, s39, 49152
    v_mfma_f32_16x16x32_bf16 v[20:23], a[216:219], a[92:95], v[20:23]
    ds_read_b64_tr_b16 a[246:247], v212 offset:13312
    v_add_f32 v187, v187, v251
    v_mfma_f32_16x16x32_bf16 v[28:31], a[220:223], a[92:95], v[28:31]
    v_add_u32 v213, 0xc000, v213
    ds_read_b64_tr_b16 a[216:217], v213 offset:0
    buffer_load_dwordx4 v224, s[16:19], s54 offen offset:0  lds
    v_mfma_f32_16x16x32_bf16 v[24:27], a[220:223], a[88:91], v[24:27]
    ds_read_b64_tr_b16 a[218:219], v213 offset:12288
    v_cvt_pk_bf16_f32 v234, v184, v185
    v_mfma_f32_16x16x32_bf16 v[32:35], a[224:227], a[88:91], v[32:35]
    ds_read_b64_tr_b16 a[220:221], v213 offset:1024
    v_mfma_f32_16x16x32_bf16 v[36:39], a[224:227], a[92:95], v[36:39]
    ds_read_b64_tr_b16 a[222:223], v213 offset:13312
    buffer_load_dwordx4 v225, s[20:23], s54 offen offset:1024  lds
    v_mfma_f32_16x16x32_bf16 v[44:47], a[228:231], a[92:95], v[44:47]
    v_add_u32 v214, 0xc000, v214
    ds_read_b64_tr_b16 a[224:225], v214 offset:0
    v_cvt_pk_bf16_f32 v235, v186, v187
    v_mfma_f32_16x16x32_bf16 v[40:43], a[228:231], a[88:91], v[40:43]
    ds_read_b64_tr_b16 a[226:227], v214 offset:12288
    v_mul_f32 v210, v210, v210
    s_waitcnt lgkmcnt(6)
    v_mfma_f32_16x16x32_bf16 v[48:51], a[232:235], a[88:91], v[48:51]
    ds_read_b64_tr_b16 a[228:229], v214 offset:1024
    v_mfma_f32_16x16x32_bf16 v[52:55], a[232:235], a[92:95], v[52:55]
    ds_read_b64_tr_b16 a[230:231], v214 offset:13312
    buffer_load_dwordx4 v226, s[16:19], s55 offen offset:2048  lds
    v_mfma_f32_16x16x32_bf16 v[60:63], a[236:239], a[92:95], v[60:63]
    v_add_u32 v215, 0xc000, v215
    ds_read_b64_tr_b16 a[232:233], v215 offset:0
    v_fmaak_f32 v180, v180, v211, 0x358637bd
    v_mfma_f32_16x16x32_bf16 v[56:59], a[236:239], a[88:91], v[56:59]
    ds_read_b64_tr_b16 a[234:235], v215 offset:12288
    v_fmaak_f32 v181, v181, v211, 0x358637bd
    v_mfma_f32_16x16x32_bf16 v[0:3], a[240:243], a[96:99], v[0:3]
    ds_read_b64_tr_b16 a[236:237], v215 offset:1024
    v_mfma_f32_16x16x32_bf16 v[4:7], a[240:243], a[100:103], v[4:7]
    ds_read_b64_tr_b16 a[238:239], v215 offset:13312
    buffer_load_dwordx4 v227, s[20:23], s55 offen offset:3072  lds
    v_mfma_f32_16x16x32_bf16 v[12:15], a[244:247], a[100:103], v[12:15]
    ds_read_b64_tr_b16 a[240:241], v212 offset:2048
    v_fmaak_f32 v182, v182, v211, 0x358637bd
    v_mfma_f32_16x16x32_bf16 v[8:11], a[244:247], a[96:99], v[8:11]
    ds_read_b64_tr_b16 a[242:243], v212 offset:14336
    s_add_u32 m0, s39, 53248
    s_waitcnt lgkmcnt(6)
    v_mfma_f32_16x16x32_bf16 v[16:19], a[216:219], a[96:99], v[16:19]
    ds_read_b64_tr_b16 a[244:245], v212 offset:3072
    buffer_load_dwordx4 v224, s[16:19], s56 offen offset:0  lds
    v_mfma_f32_16x16x32_bf16 v[20:23], a[216:219], a[100:103], v[20:23]
    ds_read_b64_tr_b16 a[246:247], v212 offset:15360
    v_fmaak_f32 v183, v183, v211, 0x358637bd
    v_mfma_f32_16x16x32_bf16 v[28:31], a[220:223], a[100:103], v[28:31]
    ds_read_b64_tr_b16 a[216:217], v213 offset:2048
    v_mul_f32 v248, 0x3fb8aa3b, v180
    v_mfma_f32_16x16x32_bf16 v[24:27], a[220:223], a[96:99], v[24:27]
    ds_read_b64_tr_b16 a[218:219], v213 offset:14336
    v_mfma_f32_16x16x32_bf16 v[32:35], a[224:227], a[96:99], v[32:35]
    ds_read_b64_tr_b16 a[220:221], v213 offset:3072
    buffer_load_dwordx4 v225, s[20:23], s56 offen offset:1024  lds
    v_mfma_f32_16x16x32_bf16 v[36:39], a[224:227], a[100:103], v[36:39]
    ds_read_b64_tr_b16 a[222:223], v213 offset:15360
    v_mul_f32 v249, 0x3fb8aa3b, v181
    v_mfma_f32_16x16x32_bf16 v[44:47], a[228:231], a[100:103], v[44:47]
    ds_read_b64_tr_b16 a[224:225], v214 offset:2048
    s_lshr_b32 s100, s38, 1
    s_mul_i32 s100, s100, 663552
    s_lshl_b32 s42, s41, 9
    s_add_u32 s100, s100, s42
    s_add_u32 s100, s100, 3072
    v_mfma_f32_16x16x32_bf16 v[40:43], a[228:231], a[96:99], v[40:43]
    ds_read_b64_tr_b16 a[226:227], v214 offset:14336
    v_accvgpr_read_b32 v254, a171
    v_mul_f32 v250, 0x3fb8aa3b, v182
    s_waitcnt lgkmcnt(6)
    v_mfma_f32_16x16x32_bf16 v[48:51], a[232:235], a[96:99], v[48:51]
    ds_read_b64_tr_b16 a[228:229], v214 offset:3072
    buffer_load_dword a215, v254, s[24:27], s100 offen offset:0
    v_mul_f32 v251, 0x3fb8aa3b, v183
    v_mfma_f32_16x16x32_bf16 v[52:55], a[232:235], a[100:103], v[52:55]
    ds_read_b64_tr_b16 a[230:231], v214 offset:15360
    buffer_load_dword a215, v254, s[24:27], s100 offen offset:128
    v_mfma_f32_16x16x32_bf16 v[60:63], a[236:239], a[100:103], v[60:63]
    ds_read_b64_tr_b16 a[232:233], v215 offset:2048
    buffer_load_dword a215, v254, s[24:27], s100 offen offset:256
    v_max_f32 v180, 0x358637bd, v180
    v_mfma_f32_16x16x32_bf16 v[56:59], a[236:239], a[96:99], v[56:59]
    ds_read_b64_tr_b16 a[234:235], v215 offset:14336
    buffer_load_dword a215, v254, s[24:27], s100 offen offset:384
    v_mfma_f32_16x16x32_bf16 v[0:3], a[240:243], a[104:107], v[0:3]
    ds_read_b64_tr_b16 a[236:237], v215 offset:3072
    buffer_load_dword a215, v254, s[24:27], s100 offen offset:512
    v_mfma_f32_16x16x32_bf16 v[4:7], a[240:243], a[108:111], v[4:7]
    ds_read_b64_tr_b16 a[238:239], v215 offset:15360
    v_max_f32 v181, 0x358637bd, v181
    v_mfma_f32_16x16x32_bf16 v[12:15], a[244:247], a[108:111], v[12:15]
    ds_read_b64_tr_b16 a[240:241], v212 offset:4096
    v_mfma_f32_16x16x32_bf16 v[8:11], a[244:247], a[104:107], v[8:11]
    ds_read_b64_tr_b16 a[242:243], v212 offset:16384
    v_max_f32 v182, 0x358637bd, v182
    s_waitcnt lgkmcnt(6)
    v_mfma_f32_16x16x32_bf16 v[16:19], a[216:219], a[104:107], v[16:19]
    ds_read_b64_tr_b16 a[244:245], v212 offset:5120
    s_add_u32 s42, s40, 2
    s_waitcnt vmcnt(17)
    v_subrev_u32 v253, s42, v253
    v_cmp_ge_u32 vcc, 13, v253
    s_nop 1
    s_cmp_eq_u64 vcc, exec
    s_cbranch_scc0 L_poll1_slow
L_poll1_ok:
    v_mfma_f32_16x16x32_bf16 v[20:23], a[216:219], a[108:111], v[20:23]
    ds_read_b64_tr_b16 a[246:247], v212 offset:17408
    v_max_f32 v183, 0x358637bd, v183
    v_mfma_f32_16x16x32_bf16 v[28:31], a[220:223], a[108:111], v[28:31]
    ds_read_b64_tr_b16 a[216:217], v213 offset:4096
    v_mfma_f32_16x16x32_bf16 v[24:27], a[220:223], a[104:107], v[24:27]
    ds_read_b64_tr_b16 a[218:219], v213 offset:16384
    v_exp_f32_e64 v248, v248 clamp
    v_mfma_f32_16x16x32_bf16 v[32:35], a[224:227], a[104:107], v[32:35]
    ds_read_b64_tr_b16 a[220:221], v213 offset:5120
    v_mfma_f32_16x16x32_bf16 v[36:39], a[224:227], a[108:111], v[36:39]
    ds_read_b64_tr_b16 a[222:223], v213 offset:17408
    v_exp_f32_e64 v249, v249 clamp
    v_mfma_f32_16x16x32_bf16 v[44:47], a[228:231], a[108:111], v[44:47]
    ds_read_b64_tr_b16 a[224:225], v214 offset:4096
    v_mfma_f32_16x16x32_bf16 v[40:43], a[228:231], a[104:107], v[40:43]
    ds_read_b64_tr_b16 a[226:227], v214 offset:16384
    v_exp_f32_e64 v250, v250 clamp
    s_waitcnt lgkmcnt(6)
    v_mfma_f32_16x16x32_bf16 v[48:51], a[232:235], a[104:107], v[48:51]
    ds_read_b64_tr_b16 a[228:229], v214 offset:5120
    v_mfma_f32_16x16x32_bf16 v[52:55], a[232:235], a[108:111], v[52:55]
    ds_read_b64_tr_b16 a[230:231], v214 offset:17408
    v_mfma_f32_16x16x32_bf16 v[60:63], a[236:239], a[108:111], v[60:63]
    ds_read_b64_tr_b16 a[232:233], v215 offset:4096
    v_exp_f32_e64 v251, v251 clamp
    v_mfma_f32_16x16x32_bf16 v[56:59], a[236:239], a[104:107], v[56:59]
    ds_read_b64_tr_b16 a[234:235], v215 offset:16384
    v_mfma_f32_16x16x32_bf16 v[0:3], a[240:243], a[112:115], v[0:3]
    ds_read_b64_tr_b16 a[236:237], v215 offset:5120
    v_add_f32 v180, v180, v248
    v_mfma_f32_16x16x32_bf16 v[4:7], a[240:243], a[116:119], v[4:7]
    ds_read_b64_tr_b16 a[238:239], v215 offset:17408
    v_mfma_f32_16x16x32_bf16 v[12:15], a[244:247], a[116:119], v[12:15]
    s_barrier
    ds_read_b64_tr_b16 a[240:241], v212 offset:24576
    s_add_u32 s42, s40, 3
    v_mov_b32 v254, s42
    buffer_store_dword v254, v255, s[32:35], s47 offen sc1
    v_add_f32 v181, v181, v249
    v_mfma_f32_16x16x32_bf16 v[8:11], a[244:247], a[112:115], v[8:11]
    ds_read_b64_tr_b16 a[242:243], v212 offset:36864
    s_waitcnt lgkmcnt(6)
    v_mfma_f32_16x16x32_bf16 v[16:19], a[216:219], a[112:115], v[16:19]
    ds_read_b64_tr_b16 a[244:245], v212 offset:25600
    v_add_f32 v182, v182, v250
    v_mfma_f32_16x16x32_bf16 v[20:23], a[216:219], a[116:119], v[20:23]
    ds_read_b64_tr_b16 a[246:247], v212 offset:37888
    v_mfma_f32_16x16x32_bf16 v[28:31], a[220:223], a[116:119], v[28:31]
    ds_read_b64_tr_b16 a[216:217], v213 offset:24576
    v_add_f32 v183, v183, v251
    v_mfma_f32_16x16x32_bf16 v[24:27], a[220:223], a[112:115], v[24:27]
    ds_read_b64_tr_b16 a[218:219], v213 offset:36864
    v_mfma_f32_16x16x32_bf16 v[32:35], a[224:227], a[112:115], v[32:35]
    ds_read_b64_tr_b16 a[220:221], v213 offset:25600
    v_cvt_pk_bf16_f32 v240, v180, v181
    v_mfma_f32_16x16x32_bf16 v[36:39], a[224:227], a[116:119], v[36:39]
    ds_read_b64_tr_b16 a[222:223], v213 offset:37888
    v_mfma_f32_16x16x32_bf16 v[44:47], a[228:231], a[116:119], v[44:47]
    ds_read_b64_tr_b16 a[224:225], v214 offset:24576
    v_mfma_f32_16x16x32_bf16 v[40:43], a[228:231], a[112:115], v[40:43]
    ds_read_b64_tr_b16 a[226:227], v214 offset:36864
    v_cvt_pk_bf16_f32 v241, v182, v183
    s_waitcnt lgkmcnt(6)
    v_mfma_f32_16x16x32_bf16 v[48:51], a[232:235], a[112:115], v[48:51]
    ds_read_b64_tr_b16 a[228:229], v214 offset:25600
    v_mfma_f32_16x16x32_bf16 v[52:55], a[232:235], a[116:119], v[52:55]
    ds_read_b64_tr_b16 a[230:231], v214 offset:37888
    v_fmaak_f32 v188, v188, v211, 0x358637bd
    v_mfma_f32_16x16x32_bf16 v[60:63], a[236:239], a[116:119], v[60:63]
    ds_read_b64_tr_b16 a[232:233], v215 offset:24576
    v_mfma_f32_16x16x32_bf16 v[56:59], a[236:239], a[112:115], v[56:59]
    ds_read_b64_tr_b16 a[234:235], v215 offset:36864
    v_fmaak_f32 v189, v189, v211, 0x358637bd
    v_mfma_f32_16x16x32_bf16 v[0:3], a[240:243], a[120:123], v[0:3]
    ds_read_b64_tr_b16 a[236:237], v215 offset:25600
    v_mfma_f32_16x16x32_bf16 v[4:7], a[240:243], a[124:127], v[4:7]
    ds_read_b64_tr_b16 a[238:239], v215 offset:37888
    s_add_u32 s92, s92, 16384
    s_addc_u32 s93, s93, 0
    v_mov_b32 v254, s91
    global_load_dword a215, v254, s[92:93]
    v_mfma_f32_16x16x32_bf16 v[12:15], a[244:247], a[124:127], v[12:15]
    ds_read_b64_tr_b16 a[240:241], v212 offset:26624
    v_fmaak_f32 v190, v190, v211, 0x358637bd
    v_mfma_f32_16x16x32_bf16 v[8:11], a[244:247], a[120:123], v[8:11]
    ds_read_b64_tr_b16 a[242:243], v212 offset:38912
    v_fmaak_f32 v191, v191, v211, 0x358637bd
    s_waitcnt lgkmcnt(6)
    v_mfma_f32_16x16x32_bf16 v[16:19], a[216:219], a[120:123], v[16:19]
    ds_read_b64_tr_b16 a[244:245], v212 offset:27648
    v_mfma_f32_16x16x32_bf16 v[20:23], a[216:219], a[124:127], v[20:23]
    ds_read_b64_tr_b16 a[246:247], v212 offset:39936
    v_mul_f32 v248, 0x3fb8aa3b, v188
    v_mfma_f32_16x16x32_bf16 v[28:31], a[220:223], a[124:127], v[28:31]
    ds_read_b64_tr_b16 a[216:217], v213 offset:26624
    v_mfma_f32_16x16x32_bf16 v[24:27], a[220:223], a[120:123], v[24:27]
    ds_read_b64_tr_b16 a[218:219], v213 offset:38912
    v_mfma_f32_16x16x32_bf16 v[32:35], a[224:227], a[120:123], v[32:35]
    ds_read_b64_tr_b16 a[220:221], v213 offset:27648
    v_mul_f32 v249, 0x3fb8aa3b, v189
    v_mfma_f32_16x16x32_bf16 v[36:39], a[224:227], a[124:127], v[36:39]
    ds_read_b64_tr_b16 a[222:223], v213 offset:39936
    v_mfma_f32_16x16x32_bf16 v[44:47], a[228:231], a[124:127], v[44:47]
    ds_read_b64_tr_b16 a[224:225], v214 offset:26624
    v_mul_f32 v250, 0x3fb8aa3b, v190
    v_mfma_f32_16x16x32_bf16 v[40:43], a[228:231], a[120:123], v[40:43]
    ds_read_b64_tr_b16 a[226:227], v214 offset:38912
    s_waitcnt lgkmcnt(6)
    v_mfma_f32_16x16x32_bf16 v[48:51], a[232:235], a[120:123], v[48:51]
    ds_read_b64_tr_b16 a[228:229], v214 offset:27648
    v_mul_f32 v251, 0x3fb8aa3b, v191
    v_mfma_f32_16x16x32_bf16 v[52:55], a[232:235], a[124:127], v[52:55]
    ds_read_b64_tr_b16 a[230:231], v214 offset:39936
    v_mfma_f32_16x16x32_bf16 v[60:63], a[236:239], a[124:127], v[60:63]
    ds_read_b64_tr_b16 a[232:233], v215 offset:26624
    v_max_f32 v188, 0x358637bd, v188
    v_mfma_f32_16x16x32_bf16 v[56:59], a[236:239], a[120:123], v[56:59]
    ds_read_b64_tr_b16 a[234:235], v215 offset:38912
    v_mfma_f32_16x16x32_bf16 v[0:3], a[240:243], a[128:131], v[0:3]
    ds_read_b64_tr_b16 a[236:237], v215 offset:27648
    v_max_f32 v189, 0x358637bd, v189
    v_mfma_f32_16x16x32_bf16 v[4:7], a[240:243], a[132:135], v[4:7]
    ds_read_b64_tr_b16 a[238:239], v215 offset:39936
    v_mfma_f32_16x16x32_bf16 v[12:15], a[244:247], a[132:135], v[12:15]
    ds_read_b64_tr_b16 a[240:241], v212 offset:28672
    v_max_f32 v190, 0x358637bd, v190
    v_mfma_f32_16x16x32_bf16 v[8:11], a[244:247], a[128:131], v[8:11]
    ds_read_b64_tr_b16 a[242:243], v212 offset:40960
    s_waitcnt lgkmcnt(6)
    v_mfma_f32_16x16x32_bf16 v[16:19], a[216:219], a[128:131], v[16:19]
    ds_read_b64_tr_b16 a[244:245], v212 offset:29696
    v_mfma_f32_16x16x32_bf16 v[20:23], a[216:219], a[132:135], v[20:23]
    ds_read_b64_tr_b16 a[246:247], v212 offset:41984
    v_max_f32 v191, 0x358637bd, v191
    v_mfma_f32_16x16x32_bf16 v[28:31], a[220:223], a[132:135], v[28:31]
    ds_read_b64_tr_b16 a[216:217], v213 offset:28672
    v_mfma_f32_16x16x32_bf16 v[24:27], a[220:223], a[128:131], v[24:27]
    ds_read_b64_tr_b16 a[218:219], v213 offset:40960
    v_exp_f32_e64 v248, v248 clamp
    v_mfma_f32_16x16x32_bf16 v[32:35], a[224:227], a[128:131], v[32:35]
    ds_read_b64_tr_b16 a[220:221], v213 offset:29696
    v_mfma_f32_16x16x32_bf16 v[36:39], a[224:227], a[132:135], v[36:39]
    ds_read_b64_tr_b16 a[222:223], v213 offset:41984
    v_exp_f32_e64 v249, v249 clamp
    v_mfma_f32_16x16x32_bf16 v[44:47], a[228:231], a[132:135], v[44:47]
    ds_read_b64_tr_b16 a[224:225], v214 offset:28672
    v_mfma_f32_16x16x32_bf16 v[40:43], a[228:231], a[128:131], v[40:43]
    ds_read_b64_tr_b16 a[226:227], v214 offset:40960
    v_exp_f32_e64 v250, v250 clamp
    s_waitcnt lgkmcnt(6)
    v_mfma_f32_16x16x32_bf16 v[48:51], a[232:235], a[128:131], v[48:51]
    ds_read_b64_tr_b16 a[228:229], v214 offset:29696
    v_mfma_f32_16x16x32_bf16 v[52:55], a[232:235], a[132:135], v[52:55]
    ds_read_b64_tr_b16 a[230:231], v214 offset:41984
    v_exp_f32_e64 v251, v251 clamp
    v_mfma_f32_16x16x32_bf16 v[60:63], a[236:239], a[132:135], v[60:63]
    ds_read_b64_tr_b16 a[232:233], v215 offset:28672
    v_mov_b32 v252, 0
    s_xor_b32 s77, s47, 256
    v_mfma_f32_16x16x32_bf16 v[56:59], a[236:239], a[128:131], v[56:59]
    ds_read_b64_tr_b16 a[234:235], v215 offset:40960
    v_add_f32 v188, v188, v248
    buffer_load_dword v253, v252, s[32:35], s77 offen sc1
    v_mfma_f32_16x16x32_bf16 v[0:3], a[240:243], a[136:139], v[0:3]
    ds_read_b64_tr_b16 a[236:237], v215 offset:29696
    v_mfma_f32_16x16x32_bf16 v[4:7], a[240:243], a[140:143], v[4:7]
    ds_read_b64_tr_b16 a[238:239], v215 offset:41984
    v_mfma_f32_16x16x32_bf16 v[12:15], a[244:247], a[140:143], v[12:15]
    s_barrier
    v_add_u32 v212, 0xfffe8000, v212
    ds_read_b64_tr_b16 a[240:241], v212 offset:0
    v_add_f32 v189, v189, v249
    v_mfma_f32_16x16x32_bf16 v[8:11], a[244:247], a[136:139], v[8:11]
    ds_read_b64_tr_b16 a[242:243], v212 offset:12288
    s_waitcnt lgkmcnt(6)
    v_mfma_f32_16x16x32_bf16 v[16:19], a[216:219], a[136:139], v[16:19]
    ds_read_b64_tr_b16 a[244:245], v212 offset:1024
    s_add_u32 m0, s39, 73728
    v_mfma_f32_16x16x32_bf16 v[20:23], a[216:219], a[140:143], v[20:23]
    ds_read_b64_tr_b16 a[246:247], v212 offset:13312
    v_add_f32 v190, v190, v250
    v_mfma_f32_16x16x32_bf16 v[28:31], a[220:223], a[140:143], v[28:31]
    v_add_u32 v213, 0xfffe8000, v213
    ds_read_b64_tr_b16 a[216:217], v213 offset:0
    buffer_load_dwordx4 v224, s[16:19], s57 offen offset:0  lds
    v_mfma_f32_16x16x32_bf16 v[24:27], a[220:223], a[136:139], v[24:27]
    ds_read_b64_tr_b16 a[218:219], v213 offset:12288
    v_add_f32 v191, v191, v251
    v_mfma_f32_16x16x32_bf16 v[32:35], a[224:227], a[136:139], v[32:35]
    ds_read_b64_tr_b16 a[220:221], v213 offset:1024
    v_cvt_pk_bf16_f32 v242, v188, v189
    v_mfma_f32_16x16x32_bf16 v[36:39], a[224:227], a[140:143], v[36:39]
    ds_read_b64_tr_b16 a[222:223], v213 offset:13312
    v_mfma_f32_16x16x32_bf16 v[44:47], a[228:231], a[140:143], v[44:47]
    v_add_u32 v214, 0xfffe8000, v214
    ds_read_b64_tr_b16 a[224:225], v214 offset:0
    buffer_load_dwordx4 v225, s[20:23], s57 offen offset:1024  lds
    v_mfma_f32_16x16x32_bf16 v[40:43], a[228:231], a[136:139], v[40:43]
    ds_read_b64_tr_b16 a[226:227], v214 offset:12288
    v_cvt_pk_bf16_f32 v243, v190, v191
    s_waitcnt lgkmcnt(6)
    v_mfma_f32_16x16x32_bf16 v[48:51], a[232:235], a[136:139], v[48:51]
    ds_read_b64_tr_b16 a[228:229], v214 offset:1024
    v_mul_f32 v211, v211, v211
    v_mfma_f32_16x16x32_bf16 v[52:55], a[232:235], a[140:143], v[52:55]
    ds_read_b64_tr_b16 a[230:231], v214 offset:13312
    v_mfma_f32_16x16x32_bf16 v[60:63], a[236:239], a[140:143], v[60:63]
    v_add_u32 v215, 0xfffe8000, v215
    ds_read_b64_tr_b16 a[232:233], v215 offset:0
    buffer_load_dwordx4 v226, s[16:19], s58 offen offset:2048  lds
    v_mfma_f32_16x16x32_bf16 v[56:59], a[236:239], a[136:139], v[56:59]
    ds_read_b64_tr_b16 a[234:235], v215 offset:12288
    v_mfma_f32_16x16x32_bf16 v[64:67], a[240:243], a[0:3], 0
    ds_read_b64_tr_b16 a[236:237], v215 offset:1024
    v_mfma_f32_16x16x32_bf16 v[68:71], a[240:243], a[4:7], 0
    ds_read_b64_tr_b16 a[238:239], v215 offset:13312
    s_xor_b32 s42, s76, 0
    buffer_load_dwordx4 v[176:179], v208, s[32:35], s42 offen sc1
    v_mfma_f32_16x16x32_bf16 v[76:79], a[244:247], a[4:7], 0
    ds_read_b64_tr_b16 a[240:241], v212 offset:2048
    buffer_load_dwordx4 v227, s[20:23], s58 offen offset:3072  lds
    v_mfma_f32_16x16x32_bf16 v[72:75], a[244:247], a[0:3], 0
    ds_read_b64_tr_b16 a[242:243], v212 offset:14336
    s_waitcnt lgkmcnt(6)
    v_mfma_f32_16x16x32_bf16 v[80:83], a[216:219], a[0:3], 0
    ds_read_b64_tr_b16 a[244:245], v212 offset:3072
    s_add_u32 m0, s39, 77824
    v_mfma_f32_16x16x32_bf16 v[84:87], a[216:219], a[4:7], 0
    ds_read_b64_tr_b16 a[246:247], v212 offset:15360
    buffer_load_dwordx4 v224, s[16:19], s59 offen offset:0  lds
    s_xor_b32 s42, s76, 4096
    buffer_load_dwordx4 v[180:183], v208, s[32:35], s42 offen sc1
    v_mfma_f32_16x16x32_bf16 v[92:95], a[220:223], a[4:7], 0
    ds_read_b64_tr_b16 a[216:217], v213 offset:2048
    v_mul_f32 v0, v0, v8
    v_mfma_f32_16x16x32_bf16 v[88:91], a[220:223], a[0:3], 0
    ds_read_b64_tr_b16 a[218:219], v213 offset:14336
    v_mfma_f32_16x16x32_bf16 v[96:99], a[224:227], a[0:3], 0
    ds_read_b64_tr_b16 a[220:221], v213 offset:3072
    v_mul_f32 v1, v1, v9
    v_mfma_f32_16x16x32_bf16 v[100:103], a[224:227], a[4:7], 0
    ds_read_b64_tr_b16 a[222:223], v213 offset:15360
    buffer_load_dwordx4 v225, s[20:23], s59 offen offset:1024  lds
    s_xor_b32 s42, s76, 8192
    buffer_load_dwordx4 v[184:187], v208, s[32:35], s42 offen sc1
    v_mfma_f32_16x16x32_bf16 v[108:111], a[228:231], a[4:7], 0
    ds_read_b64_tr_b16 a[224:225], v214 offset:2048
    v_mul_f32 v2, v2, v10
    v_mfma_f32_16x16x32_bf16 v[104:107], a[228:231], a[0:3], 0
    ds_read_b64_tr_b16 a[226:227], v214 offset:14336
    s_add_u32 m0, s39, 98304
    s_waitcnt lgkmcnt(6)
    v_mfma_f32_16x16x32_bf16 v[112:115], a[232:235], a[0:3], 0
    ds_read_b64_tr_b16 a[228:229], v214 offset:3072
    v_mul_f32 v3, v3, v11
    v_cvt_pk_bf16_f32 v160, v0, v1
    v_mfma_f32_16x16x32_bf16 v[116:119], a[232:235], a[4:7], 0
    ds_read_b64_tr_b16 a[230:231], v214 offset:15360
    buffer_load_dwordx4 v224, s[16:19], s60 offen offset:0  lds
    s_xor_b32 s42, s76, 12288
    buffer_load_dwordx4 v[188:191], v208, s[32:35], s42 offen sc1
    v_mfma_f32_16x16x32_bf16 v[124:127], a[236:239], a[4:7], 0
    ds_read_b64_tr_b16 a[232:233], v215 offset:2048
    v_cvt_pk_bf16_f32 v161, v2, v3
    v_mfma_f32_16x16x32_bf16 v[120:123], a[236:239], a[0:3], 0
    ds_read_b64_tr_b16 a[234:235], v215 offset:14336
    v_mul_f32 v4, v4, v12
    v_mfma_f32_16x16x32_bf16 v[64:67], a[240:243], a[8:11], v[64:67]
    ds_read_b64_tr_b16 a[236:237], v215 offset:3072
    v_mfma_f32_16x16x32_bf16 v[68:71], a[240:243], a[12:15], v[68:71]
    ds_read_b64_tr_b16 a[238:239], v215 offset:15360
    buffer_load_dwordx4 v225, s[20:23], s60 offen offset:1024  lds
    s_xor_b32 s42, s76, 16384
    buffer_load_dwordx4 v[192:195], v208, s[32:35], s42 offen sc1
    v_mfma_f32_16x16x32_bf16 v[76:79], a[244:247], a[12:15], v[76:79]
    ds_read_b64_tr_b16 a[240:241], v212 offset:4096
    v_mul_f32 v5, v5, v13
    v_mfma_f32_16x16x32_bf16 v[72:75], a[244:247], a[8:11], v[72:75]
    ds_read_b64_tr_b16 a[242:243], v212 offset:16384
    v_mul_f32 v6, v6, v14
    s_waitcnt lgkmcnt(6)
    v_mfma_f32_16x16x32_bf16 v[80:83], a[216:219], a[8:11], v[80:83]
    ds_read_b64_tr_b16 a[244:245], v212 offset:5120
    v_mul_f32 v7, v7, v15
    v_mfma_f32_16x16x32_bf16 v[84:87], a[216:219], a[12:15], v[84:87]
    ds_read_b64_tr_b16 a[246:247], v212 offset:17408
    buffer_load_dwordx4 v226, s[16:19], s61 offen offset:2048  lds
    s_xor_b32 s42, s76, 20480
    buffer_load_dwordx4 v[196:199], v208, s[32:35], s42 offen sc1
    v_mfma_f32_16x16x32_bf16 v[92:95], a[220:223], a[12:15], v[92:95]
    ds_read_b64_tr_b16 a[216:217], v213 offset:4096
    v_cvt_pk_bf16_f32 v164, v4, v5
    v_mfma_f32_16x16x32_bf16 v[88:91], a[220:223], a[8:11], v[88:91]
    ds_read_b64_tr_b16 a[218:219], v213 offset:16384
    v_cvt_pk_bf16_f32 v165, v6, v7
    v_mfma_f32_16x16x32_bf16 v[96:99], a[224:227], a[8:11], v[96:99]
    ds_read_b64_tr_b16 a[220:221], v213 offset:5120
    v_mul_f32 v16, v16, v24
    v_mfma_f32_16x16x32_bf16 v[100:103], a[224:227], a[12:15], v[100:103]
    ds_read_b64_tr_b16 a[222:223], v213 offset:17408
    buffer_load_dwordx4 v227, s[20:23], s61 offen offset:3072  lds
    v_mfma_f32_16x16x32_bf16 v[108:111], a[228:231], a[12:15], v[108:111]
    ds_read_b64_tr_b16 a[224:225], v214 offset:4096
    v_mul_f32 v17, v17, v25
    v_mfma_f32_16x16x32_bf16 v[104:107], a[228:231], a[8:11], v[104:107]
    ds_read_b64_tr_b16 a[226:227], v214 offset:16384
    s_add_u32 m0, s39, 102400
    s_waitcnt lgkmcnt(6)
    v_mfma_f32_16x16x32_bf16 v[112:115], a[232:235], a[8:11], v[112:115]
    ds_read_b64_tr_b16 a[228:229], v214 offset:5120
    v_mul_f32 v18, v18, v26
    v_mul_f32 v19, v19, v27
    v_mfma_f32_16x16x32_bf16 v[116:119], a[232:235], a[12:15], v[116:119]
    ds_read_b64_tr_b16 a[230:231], v214 offset:17408
    buffer_load_dwordx4 v224, s[16:19], s62 offen offset:0  lds
    v_mfma_f32_16x16x32_bf16 v[124:127], a[236:239], a[12:15], v[124:127]
    ds_read_b64_tr_b16 a[232:233], v215 offset:4096
    v_cvt_pk_bf16_f32 v162, v16, v17
    v_mfma_f32_16x16x32_bf16 v[120:123], a[236:239], a[8:11], v[120:123]
    ds_read_b64_tr_b16 a[234:235], v215 offset:16384
    v_cvt_pk_bf16_f32 v163, v18, v19
    v_mfma_f32_16x16x32_bf16 v[64:67], a[240:243], a[16:19], v[64:67]
    ds_read_b64_tr_b16 a[236:237], v215 offset:5120
    s_waitcnt vmcnt(13)
    v_add_f32 v200, v200, v176
    v_add_f32 v201, v201, v177
    v_mfma_f32_16x16x32_bf16 v[68:71], a[240:243], a[20:23], v[68:71]
    ds_read_b64_tr_b16 a[238:239], v215 offset:17408
    buffer_load_dwordx4 v225, s[20:23], s62 offen offset:1024  lds
    v_mfma_f32_16x16x32_bf16 v[76:79], a[244:247], a[20:23], v[76:79]
    s_barrier
    ds_read_b64_tr_b16 a[240:241], v212 offset:24576
    v_mul_f32 v20, v20, v28
    v_add_f32 v202, v202, v178
    v_mfma_f32_16x16x32_bf16 v[72:75], a[244:247], a[16:19], v[72:75]
    ds_read_b64_tr_b16 a[242:243], v212 offset:36864
    v_mul_f32 v21, v21, v29
    v_add_f32 v203, v203, v179
    s_waitcnt lgkmcnt(6)
    v_mfma_f32_16x16x32_bf16 v[80:83], a[216:219], a[16:19], v[80:83]
    ds_read_b64_tr_b16 a[244:245], v212 offset:25600
    v_mul_f32 v22, v22, v30
    s_xor_b32 s42, s76, 24576
    buffer_load_dwordx4 v[176:179], v208, s[32:35], s42 offen sc1
    v_mfma_f32_16x16x32_bf16 v[84:87], a[216:219], a[20:23], v[84:87]
    ds_read_b64_tr_b16 a[246:247], v212 offset:37888
    v_mul_f32 v23, v23, v31
    s_waitcnt vmcnt(12)
    v_add_f32 v200, v200, v180
    v_mfma_f32_16x16x32_bf16 v[92:95], a[220:223], a[20:23], v[92:95]
    ds_read_b64_tr_b16 a[216:217], v213 offset:24576
    s_add_u32 m0, s39, 122880
    v_add_f32 v201, v201, v181
    v_mfma_f32_16x16x32_bf16 v[88:91], a[220:223], a[16:19], v[88:91]
    ds_read_b64_tr_b16 a[218:219], v213 offset:36864
    v_cvt_pk_bf16_f32 v166, v20, v21
    v_mfma_f32_16x16x32_bf16 v[96:99], a[224:227], a[16:19], v[96:99]
    ds_read_b64_tr_b16 a[220:221], v213 offset:25600
    v_cvt_pk_bf16_f32 v167, v22, v23
    v_add_f32 v202, v202, v182
    v_mfma_f32_16x16x32_bf16 v[100:103], a[224:227], a[20:23], v[100:103]
    ds_read_b64_tr_b16 a[222:223], v213 offset:37888
    buffer_load_dwordx4 v224, s[16:19], s63 offen offset:0  lds
    v_add_f32 v203, v203, v183
    v_mfma_f32_16x16x32_bf16 v[108:111], a[228:231], a[20:23], v[108:111]
    ds_read_b64_tr_b16 a[224:225], v214 offset:24576
    v_mul_f32 v32, v32, v40
    s_xor_b32 s42, s76, 28672
    buffer_load_dwordx4 v[180:183], v208, s[32:35], s42 offen sc1
    v_mfma_f32_16x16x32_bf16 v[104:107], a[228:231], a[16:19], v[104:107]
    ds_read_b64_tr_b16 a[226:227], v214 offset:36864
    v_mul_f32 v33, v33, v41
    s_waitcnt lgkmcnt(6)
    v_mfma_f32_16x16x32_bf16 v[112:115], a[232:235], a[16:19], v[112:115]
    ds_read_b64_tr_b16 a[228:229], v214 offset:25600
    s_waitcnt vmcnt(12)
    v_add_f32 v200, v200, v184
    v_add_f32 v201, v201, v185
    v_mfma_f32_16x16x32_bf16 v[116:119], a[232:235], a[20:23], v[116:119]
    ds_read_b64_tr_b16 a[230:231], v214 offset:37888
    v_mul_f32 v34, v34, v42
    v_mfma_f32_16x16x32_bf16 v[124:127], a[236:239], a[20:23], v[124:127]
    ds_read_b64_tr_b16 a[232:233], v215 offset:24576
    v_mul_f32 v35, v35, v43
    v_mfma_f32_16x16x32_bf16 v[120:123], a[236:239], a[16:19], v[120:123]
    ds_read_b64_tr_b16 a[234:235], v215 offset:36864
    v_add_f32 v202, v202, v186
    v_add_f32 v203, v203, v187
    v_mfma_f32_16x16x32_bf16 v[64:67], a[240:243], a[24:27], v[64:67]
    ds_read_b64_tr_b16 a[236:237], v215 offset:25600
    v_cvt_pk_bf16_f32 v168, v32, v33
    s_xor_b32 s42, s76, 32768
    buffer_load_dwordx4 v[184:187], v208, s[32:35], s42 offen sc1
    v_mfma_f32_16x16x32_bf16 v[68:71], a[240:243], a[28:31], v[68:71]
    ds_read_b64_tr_b16 a[238:239], v215 offset:37888
    buffer_load_dwordx4 v225, s[20:23], s63 offen offset:1024  lds
    s_waitcnt vmcnt(12)
    v_add_f32 v200, v200, v188
    v_mfma_f32_16x16x32_bf16 v[76:79], a[244:247], a[28:31], v[76:79]
    ds_read_b64_tr_b16 a[240:241], v212 offset:26624
    v_cvt_pk_bf16_f32 v169, v34, v35
    v_add_f32 v201, v201, v189
    v_mfma_f32_16x16x32_bf16 v[72:75], a[244:247], a[24:27], v[72:75]
    ds_read_b64_tr_b16 a[242:243], v212 offset:38912
    v_mul_f32 v36, v36, v44
    s_waitcnt lgkmcnt(6)
    v_mfma_f32_16x16x32_bf16 v[80:83], a[216:219], a[24:27], v[80:83]
    ds_read_b64_tr_b16 a[244:245], v212 offset:27648
    v_mul_f32 v37, v37, v45
    v_mfma_f32_16x16x32_bf16 v[84:87], a[216:219], a[28:31], v[84:87]
    ds_read_b64_tr_b16 a[246:247], v212 offset:39936
    v_add_f32 v202, v202, v190
    v_add_f32 v203, v203, v191
    v_mfma_f32_16x16x32_bf16 v[92:95], a[220:223], a[28:31], v[92:95]
    ds_read_b64_tr_b16 a[216:217], v213 offset:26624
    v_mul_f32 v38, v38, v46
    s_xor_b32 s42, s76, 36864
    buffer_load_dwordx4 v[188:191], v208, s[32:35], s42 offen sc1
    v_mfma_f32_16x16x32_bf16 v[88:91], a[220:223], a[24:27], v[88:91]
    ds_read_b64_tr_b16 a[218:219], v213 offset:38912
    v_mul_f32 v39, v39, v47
    v_mfma_f32_16x16x32_bf16 v[96:99], a[224:227], a[24:27], v[96:99]
    ds_read_b64_tr_b16 a[220:221], v213 offset:27648
    s_waitcnt vmcnt(11)
    v_add_f32 v200, v200, v192
    v_add_f32 v201, v201, v193
    v_mfma_f32_16x16x32_bf16 v[100:103], a[224:227], a[28:31], v[100:103]
    ds_read_b64_tr_b16 a[222:223], v213 offset:39936
    buffer_load_dwordx4 v226, s[16:19], s64 offen offset:2048  lds
    v_mfma_f32_16x16x32_bf16 v[108:111], a[228:231], a[28:31], v[108:111]
    ds_read_b64_tr_b16 a[224:225], v214 offset:26624
    v_cvt_pk_bf16_f32 v172, v36, v37
    v_add_f32 v202, v202, v194
    v_mfma_f32_16x16x32_bf16 v[104:107], a[228:231], a[24:27], v[104:107]
    ds_read_b64_tr_b16 a[226:227], v214 offset:38912
    v_cvt_pk_bf16_f32 v173, v38, v39
    v_add_f32 v203, v203, v195
    s_waitcnt lgkmcnt(6)
    v_mfma_f32_16x16x32_bf16 v[112:115], a[232:235], a[24:27], v[112:115]
    ds_read_b64_tr_b16 a[228:229], v214 offset:27648
    v_mul_f32 v48, v48, v56
    s_xor_b32 s42, s76, 40960
    buffer_load_dwordx4 v[192:195], v208, s[32:35], s42 offen sc1
    v_mfma_f32_16x16x32_bf16 v[116:119], a[232:235], a[28:31], v[116:119]
    ds_read_b64_tr_b16 a[230:231], v214 offset:39936
    v_mul_f32 v49, v49, v57
    s_waitcnt vmcnt(11)
    v_add_f32 v200, v200, v196
    v_mfma_f32_16x16x32_bf16 v[124:127], a[236:239], a[28:31], v[124:127]
    ds_read_b64_tr_b16 a[232:233], v215 offset:26624
    v_mul_f32 v50, v50, v58
    v_mfma_f32_16x16x32_bf16 v[120:123], a[236:239], a[24:27], v[120:123]
    ds_read_b64_tr_b16 a[234:235], v215 offset:38912
    v_add_f32 v201, v201, v197
    v_mfma_f32_16x16x32_bf16 v[64:67], a[240:243], a[32:35], v[64:67]
    ds_read_b64_tr_b16 a[236:237], v215 offset:27648
    v_mul_f32 v51, v51, v59
    v_add_f32 v202, v202, v198
    v_mfma_f32_16x16x32_bf16 v[68:71], a[240:243], a[36:39], v[68:71]
    ds_read_b64_tr_b16 a[238:239], v215 offset:39936
    buffer_load_dwordx4 v227, s[20:23], s64 offen offset:3072  lds
    v_add_f32 v203, v203, v199
    v_mfma_f32_16x16x32_bf16 v[76:79], a[244:247], a[36:39], v[76:79]
    ds_read_b64_tr_b16 a[240:241], v212 offset:28672
    v_cvt_pk_bf16_f32 v170, v48, v49
    s_xor_b32 s42, s76, 45056
    buffer_load_dwordx4 v[196:199], v208, s[32:35], s42 offen sc1
    v_mfma_f32_16x16x32_bf16 v[72:75], a[244:247], a[32:35], v[72:75]
    ds_read_b64_tr_b16 a[242:243], v212 offset:40960
    v_cvt_pk_bf16_f32 v171, v50, v51
    s_waitcnt vmcnt(9)
    v_add_f32 v200, v200, v176
    s_waitcnt lgkmcnt(6)
    v_mfma_f32_16x16x32_bf16 v[80:83], a[216:219], a[32:35], v[80:83]
    ds_read_b64_tr_b16 a[244:245], v212 offset:29696
    v_mul_f32 v52, v52, v60
    v_add_f32 v201, v201, v177
    v_mfma_f32_16x16x32_bf16 v[84:87], a[216:219], a[36:39], v[84:87]
    ds_read_b64_tr_b16 a[246:247], v212 offset:41984
    s_add_u32 m0, s39, 126976
    v_mfma_f32_16x16x32_bf16 v[92:95], a[220:223], a[36:39], v[92:95]
    ds_read_b64_tr_b16 a[216:217], v213 offset:28672
    v_mul_f32 v53, v53, v61
    v_add_f32 v202, v202, v178
    v_mfma_f32_16x16x32_bf16 v[88:91], a[220:223], a[32:35], v[88:91]
    ds_read_b64_tr_b16 a[218:219], v213 offset:40960
    v_mul_f32 v54, v54, v62
    v_add_f32 v203, v203, v179
    v_mfma_f32_16x16x32_bf16 v[96:99], a[224:227], a[32:35], v[96:99]
    ds_read_b64_tr_b16 a[220:221], v213 offset:29696
    buffer_load_dwordx4 v224, s[16:19], s65 offen offset:0  lds
    s_xor_b32 s42, s76, 49152
    buffer_load_dwordx4 v[176:179], v208, s[32:35], s42 offen sc1
    v_mfma_f32_16x16x32_bf16 v[100:103], a[224:227], a[36:39], v[100:103]
    ds_read_b64_tr_b16 a[222:223], v213 offset:41984
    v_mul_f32 v55, v55, v63
    s_waitcnt vmcnt(9)
    v_add_f32 v200, v200, v180
    v_mfma_f32_16x16x32_bf16 v[108:111], a[228:231], a[36:39], v[108:111]
    ds_read_b64_tr_b16 a[224:225], v214 offset:28672
    v_cvt_pk_bf16_f32 v174, v52, v53
    v_mfma_f32_16x16x32_bf16 v[104:107], a[228:231], a[32:35], v[104:107]
    ds_read_b64_tr_b16 a[226:227], v214 offset:40960
    v_add_f32 v201, v201, v181
    s_waitcnt lgkmcnt(6)
    v_mfma_f32_16x16x32_bf16 v[112:115], a[232:235], a[32:35], v[112:115]
    ds_read_b64_tr_b16 a[228:229], v214 offset:29696
    v_cvt_pk_bf16_f32 v175, v54, v55
    v_mfma_f32_16x16x32_bf16 v[116:119], a[232:235], a[36:39], v[116:119]
    ds_read_b64_tr_b16 a[230:231], v214 offset:41984
    v_add_f32 v202, v202, v182
    v_mfma_f32_16x16x32_bf16 v[124:127], a[236:239], a[36:39], v[124:127]
    ds_read_b64_tr_b16 a[232:233], v215 offset:28672
    v_add_f32 v203, v203, v183
    v_mfma_f32_16x16x32_bf16 v[120:123], a[236:239], a[32:35], v[120:123]
    ds_read_b64_tr_b16 a[234:235], v215 offset:40960
    s_xor_b32 s42, s76, 53248
    buffer_load_dwordx4 v[180:183], v208, s[32:35], s42 offen sc1
    v_mfma_f32_16x16x32_bf16 v[64:67], a[240:243], a[40:43], v[64:67]
    ds_read_b64_tr_b16 a[236:237], v215 offset:29696
    buffer_load_dwordx4 v225, s[20:23], s65 offen offset:1024  lds
    s_waitcnt vmcnt(10)
    v_add_f32 v200, v200, v184
    v_mfma_f32_16x16x32_bf16 v[68:71], a[240:243], a[44:47], v[68:71]
    ds_read_b64_tr_b16 a[238:239], v215 offset:41984
    v_add_f32 v201, v201, v185
    v_mfma_f32_16x16x32_bf16 v[76:79], a[244:247], a[44:47], v[76:79]
    s_barrier
    v_add_u32 v212, 0xc000, v212
    ds_read_b64_tr_b16 a[240:241], v212 offset:0
    v_add_f32 v202, v202, v186
    v_mfma_f32_16x16x32_bf16 v[72:75], a[244:247], a[40:43], v[72:75]
    ds_read_b64_tr_b16 a[242:243], v212 offset:12288
    s_add_u32 m0, s39, 0
    v_add_f32 v203, v203, v187
    s_waitcnt lgkmcnt(6)
    v_mfma_f32_16x16x32_bf16 v[80:83], a[216:219], a[40:43], v[80:83]
    ds_read_b64_tr_b16 a[244:245], v212 offset:1024
    v_accvgpr_read_b32 v228, a248
    v_mfma_f32_16x16x32_bf16 v[84:87], a[216:219], a[44:47], v[84:87]
    ds_read_b64_tr_b16 a[246:247], v212 offset:13312
    s_xor_b32 s42, s76, 57344
    buffer_load_dwordx4 v[184:187], v208, s[32:35], s42 offen sc1
    v_mfma_f32_16x16x32_bf16 v[92:95], a[220:223], a[44:47], v[92:95]
    v_add_u32 v213, 0xc000, v213
    ds_read_b64_tr_b16 a[216:217], v213 offset:0
    v_subrev_u32 v229, 1024, v228
    s_waitcnt vmcnt(9)
    v_add_f32 v200, v200, v188
    v_mfma_f32_16x16x32_bf16 v[88:91], a[220:223], a[40:43], v[88:91]
    ds_read_b64_tr_b16 a[218:219], v213 offset:12288
    v_subrev_u32 v230, 2048, v228
    v_add_f32 v201, v201, v189
    v_mfma_f32_16x16x32_bf16 v[96:99], a[224:227], a[40:43], v[96:99]
    ds_read_b64_tr_b16 a[220:221], v213 offset:1024
    v_subrev_u32 v231, 3072, v228
    v_add_f32 v202, v202, v190
    v_mfma_f32_16x16x32_bf16 v[100:103], a[224:227], a[44:47], v[100:103]
    ds_read_b64_tr_b16 a[222:223], v213 offset:13312
    buffer_load_dwordx4 v228, s[16:19], s48 offen offset:0  lds
    v_mfma_f32_16x16x32_bf16 v[108:111], a[228:231], a[44:47], v[108:111]
    v_add_u32 v214, 0xc000, v214
    ds_read_b64_tr_b16 a[224:225], v214 offset:0
    v_add_f32 v203, v203, v191
    s_xor_b32 s42, s76, 61440
    buffer_load_dwordx4 v[188:191], v208, s[32:35], s42 offen sc1
    v_mfma_f32_16x16x32_bf16 v[104:107], a[228:231], a[40:43], v[104:107]
    ds_read_b64_tr_b16 a[226:227], v214 offset:12288
    s_waitcnt lgkmcnt(6)
    v_mfma_f32_16x16x32_bf16 v[112:115], a[232:235], a[40:43], v[112:115]
    ds_read_b64_tr_b16 a[228:229], v214 offset:1024
    s_add_u32 s74, s46, 8192
    v_mfma_f32_16x16x32_bf16 v[116:119], a[232:235], a[44:47], v[116:119]
    ds_read_b64_tr_b16 a[230:231], v214 offset:13312
    v_mfma_f32_16x16x32_bf16 v[124:127], a[236:239], a[44:47], v[124:127]
    v_add_u32 v215, 0xc000, v215
    ds_read_b64_tr_b16 a[232:233], v215 offset:0
    buffer_store_dwordx4 v[160:163], v208, s[32:35], s74 offen offset:0 sc1
    v_mfma_f32_16x16x32_bf16 v[120:123], a[236:239], a[40:43], v[120:123]
    ds_read_b64_tr_b16 a[234:235], v215 offset:12288
    v_mfma_f32_16x16x32_bf16 v[64:67], a[240:243], a[48:51], v[64:67]
    ds_read_b64_tr_b16 a[236:237], v215 offset:1024
    v_mfma_f32_16x16x32_bf16 v[68:71], a[240:243], a[52:55], v[68:71]
    ds_read_b64_tr_b16 a[238:239], v215 offset:13312
    buffer_load_dwordx4 v229, s[20:23], s48 offen offset:1024  lds
    v_mfma_f32_16x16x32_bf16 v[76:79], a[244:247], a[52:55], v[76:79]
    ds_read_b64_tr_b16 a[240:241], v212 offset:2048
    buffer_store_dwordx4 v[164:167], v208, s[32:35], s74 offen offset:1024 sc1
    v_mfma_f32_16x16x32_bf16 v[72:75], a[244:247], a[48:51], v[72:75]
    ds_read_b64_tr_b16 a[242:243], v212 offset:14336
    buffer_store_dwordx4 v[168:171], v208, s[32:35], s74 offen offset:2048 sc1
    s_waitcnt lgkmcnt(6)
    v_mfma_f32_16x16x32_bf16 v[80:83], a[216:219], a[48:51], v[80:83]
    ds_read_b64_tr_b16 a[244:245], v212 offset:3072
    v_mfma_f32_16x16x32_bf16 v[84:87], a[216:219], a[52:55], v[84:87]
    ds_read_b64_tr_b16 a[246:247], v212 offset:15360
    buffer_store_dwordx4 v[172:175], v208, s[32:35], s74 offen offset:3072 sc1
    v_mfma_f32_16x16x32_bf16 v[92:95], a[220:223], a[52:55], v[92:95]
    ds_read_b64_tr_b16 a[216:217], v213 offset:2048
    v_mfma_f32_16x16x32_bf16 v[88:91], a[220:223], a[48:51], v[88:91]
    ds_read_b64_tr_b16 a[218:219], v213 offset:14336
    v_accvgpr_read_b32 v248, a176
    v_mfma_f32_16x16x32_bf16 v[96:99], a[224:227], a[48:51], v[96:99]
    ds_read_b64_tr_b16 a[220:221], v213 offset:3072
    v_accvgpr_read_b32 v249, a177
    v_accvgpr_read_b32 v250, a178
    v_mfma_f32_16x16x32_bf16 v[100:103], a[224:227], a[52:55], v[100:103]
    ds_read_b64_tr_b16 a[222:223], v213 offset:15360
    buffer_load_dwordx4 v230, s[16:19], s50 offen offset:2048  lds
    v_mfma_f32_16x16x32_bf16 v[108:111], a[228:231], a[52:55], v[108:111]
    ds_read_b64_tr_b16 a[224:225], v214 offset:2048
    s_waitcnt vmcnt(15)
    v_add_f32 v200, v200, v192
    v_mfma_f32_16x16x32_bf16 v[104:107], a[228:231], a[48:51], v[104:107]
    ds_read_b64_tr_b16 a[226:227], v214 offset:14336
    v_add_f32 v201, v201, v193
    s_waitcnt lgkmcnt(6)
    v_mfma_f32_16x16x32_bf16 v[112:115], a[232:235], a[48:51], v[112:115]
    ds_read_b64_tr_b16 a[228:229], v214 offset:3072
    v_add_f32 v202, v202, v194
    v_mfma_f32_16x16x32_bf16 v[116:119], a[232:235], a[52:55], v[116:119]
    ds_read_b64_tr_b16 a[230:231], v214 offset:15360
    v_add_f32 v203, v203, v195
    v_mfma_f32_16x16x32_bf16 v[124:127], a[236:239], a[52:55], v[124:127]
    ds_read_b64_tr_b16 a[232:233], v215 offset:2048
    s_waitcnt vmcnt(13)
    v_add_f32 v200, v200, v196
    v_mfma_f32_16x16x32_bf16 v[120:123], a[236:239], a[48:51], v[120:123]
    ds_read_b64_tr_b16 a[234:235], v215 offset:14336
    v_add_f32 v201, v201, v197
    v_mfma_f32_16x16x32_bf16 v[64:67], a[240:243], a[56:59], v[64:67]
    ds_read_b64_tr_b16 a[236:237], v215 offset:3072
    v_add_f32 v202, v202, v198
    v_add_f32 v203, v203, v199
    v_mfma_f32_16x16x32_bf16 v[68:71], a[240:243], a[60:63], v[68:71]
    ds_read_b64_tr_b16 a[238:239], v215 offset:15360
    buffer_load_dwordx4 v231, s[20:23], s50 offen offset:3072  lds
    s_waitcnt vmcnt(12)
    v_add_f32 v200, v200, v176
    v_mfma_f32_16x16x32_bf16 v[76:79], a[244:247], a[60:63], v[76:79]
    ds_read_b64_tr_b16 a[240:241], v212 offset:4096
    v_add_f32 v201, v201, v177
    v_mfma_f32_16x16x32_bf16 v[72:75], a[244:247], a[56:59], v[72:75]
    ds_read_b64_tr_b16 a[242:243], v212 offset:16384
    v_add_f32 v202, v202, v178
    s_waitcnt lgkmcnt(6)
    v_mfma_f32_16x16x32_bf16 v[80:83], a[216:219], a[56:59], v[80:83]
    ds_read_b64_tr_b16 a[244:245], v212 offset:5120
    v_add_f32 v203, v203, v179
    s_waitcnt vmcnt(11)
    v_add_f32 v200, v200, v180
    v_mfma_f32_16x16x32_bf16 v[84:87], a[216:219], a[60:63], v[84:87]
    ds_read_b64_tr_b16 a[246:247], v212 offset:17408
    s_add_u32 m0, s39, 4096
    v_add_f32 v201, v201, v181
    v_mfma_f32_16x16x32_bf16 v[92:95], a[220:223], a[60:63], v[92:95]
    ds_read_b64_tr_b16 a[216:217], v213 offset:4096
    v_add_f32 v202, v202, v182
    v_mfma_f32_16x16x32_bf16 v[88:91], a[220:223], a[56:59], v[88:91]
    ds_read_b64_tr_b16 a[218:219], v213 offset:16384
    v_add_f32 v203, v203, v183
    s_waitcnt vmcnt(9)
    v_add_f32 v200, v200, v184
    v_mfma_f32_16x16x32_bf16 v[96:99], a[224:227], a[56:59], v[96:99]
    ds_read_b64_tr_b16 a[220:221], v213 offset:5120
    buffer_load_dwordx4 v228, s[16:19], s52 offen offset:0  lds
    v_add_f32 v201, v201, v185
    v_mfma_f32_16x16x32_bf16 v[100:103], a[224:227], a[60:63], v[100:103]
    ds_read_b64_tr_b16 a[222:223], v213 offset:17408
    v_add_f32 v202, v202, v186
    v_mfma_f32_16x16x32_bf16 v[108:111], a[228:231], a[60:63], v[108:111]
    ds_read_b64_tr_b16 a[224:225], v214 offset:4096
    v_add_f32 v203, v203, v187
    v_mfma_f32_16x16x32_bf16 v[104:107], a[228:231], a[56:59], v[104:107]
    ds_read_b64_tr_b16 a[226:227], v214 offset:16384
    s_waitcnt vmcnt(8)
    v_add_f32 v200, v200, v188
    s_waitcnt lgkmcnt(6)
    v_mfma_f32_16x16x32_bf16 v[112:115], a[232:235], a[56:59], v[112:115]
    ds_read_b64_tr_b16 a[228:229], v214 offset:5120
    v_add_f32 v201, v201, v189
    v_mfma_f32_16x16x32_bf16 v[116:119], a[232:235], a[60:63], v[116:119]
    ds_read_b64_tr_b16 a[230:231], v214 offset:17408
    v_add_f32 v202, v202, v190
    v_add_f32 v203, v203, v191
    v_cvt_pk_bf16_f32 v200, v200, v201
    v_cvt_pk_bf16_f32 v201, v202, v203
    v_and_b32 v200, v200, v249
    v_and_b32 v201, v201, v250
    ds_write_b64 v248, v[200:201]
    v_mfma_f32_16x16x32_bf16 v[124:127], a[236:239], a[60:63], v[124:127]
    ds_read_b64_tr_b16 a[232:233], v215 offset:4096
    v_mfma_f32_16x16x32_bf16 v[120:123], a[236:239], a[56:59], v[120:123]
    ds_read_b64_tr_b16 a[234:235], v215 offset:16384
    v_mfma_f32_16x16x32_bf16 v[64:67], a[240:243], a[64:67], v[64:67]
    ds_read_b64_tr_b16 a[236:237], v215 offset:5120
    buffer_load_dwordx4 v229, s[20:23], s52 offen offset:1024  lds
    v_mfma_f32_16x16x32_bf16 v[68:71], a[240:243], a[68:71], v[68:71]
    ds_read_b64_tr_b16 a[238:239], v215 offset:17408
    v_mfma_f32_16x16x32_bf16 v[76:79], a[244:247], a[68:71], v[76:79]
    s_waitcnt lgkmcnt(4)
    s_barrier
    ds_read_b64_tr_b16 a[240:241], v212 offset:24576
    v_mfma_f32_16x16x32_bf16 v[72:75], a[244:247], a[64:67], v[72:75]
    ds_read_b64_tr_b16 a[242:243], v212 offset:36864
    v_accvgpr_read_b32 v248, a179
    v_mfma_f32_16x16x32_bf16 v[80:83], a[216:219], a[64:67], v[80:83]
    ds_read_b64_tr_b16 a[244:245], v212 offset:25600
    v_accvgpr_read_b32 v250, a180
    v_mfma_f32_16x16x32_bf16 v[84:87], a[216:219], a[68:71], v[84:87]
    ds_read_b64_tr_b16 a[246:247], v212 offset:37888
    v_mfma_f32_16x16x32_bf16 v[92:95], a[220:223], a[68:71], v[92:95]
    ds_read_b64_tr_b16 a[216:217], v213 offset:24576
    s_add_u32 m0, s39, 24576
    v_mfma_f32_16x16x32_bf16 v[88:91], a[220:223], a[64:67], v[88:91]
    ds_read_b64_tr_b16 a[218:219], v213 offset:36864
    v_accvgpr_read_b32 v251, a181
    v_mfma_f32_16x16x32_bf16 v[96:99], a[224:227], a[64:67], v[96:99]
    ds_read_b64_tr_b16 a[220:221], v213 offset:25600
    ds_read_b64 v[0:1], v248 offset:0
    ds_read_b64 v[2:3], v248 offset:32
    v_mfma_f32_16x16x32_bf16 v[100:103], a[224:227], a[68:71], v[100:103]
    ds_read_b64_tr_b16 a[222:223], v213 offset:37888
    buffer_load_dwordx4 v228, s[16:19], s54 offen offset:0  lds
    v_mfma_f32_16x16x32_bf16 v[108:111], a[228:231], a[68:71], v[108:111]
    ds_read_b64_tr_b16 a[224:225], v214 offset:24576
    ds_read_b64 v[4:5], v248 offset:2176
    v_mfma_f32_16x16x32_bf16 v[104:107], a[228:231], a[64:67], v[104:107]
    ds_read_b64_tr_b16 a[226:227], v214 offset:36864
    ds_read_b64 v[6:7], v248 offset:2208
    s_waitcnt lgkmcnt(10)
    v_mfma_f32_16x16x32_bf16 v[112:115], a[232:235], a[64:67], v[112:115]
    ds_read_b64_tr_b16 a[228:229], v214 offset:25600
    ds_read_b64 v[8:9], v248 offset:2240
    v_mfma_f32_16x16x32_bf16 v[116:119], a[232:235], a[68:71], v[116:119]
    ds_read_b64_tr_b16 a[230:231], v214 offset:37888
    ds_read_b64 v[10:11], v248 offset:2272
    v_mfma_f32_16x16x32_bf16 v[124:127], a[236:239], a[68:71], v[124:127]
    ds_read_b64_tr_b16 a[232:233], v215 offset:24576
    ds_read_b64 v[12:13], v250 offset:0
    v_mfma_f32_16x16x32_bf16 v[120:123], a[236:239], a[64:67], v[120:123]
    ds_read_b64_tr_b16 a[234:235], v215 offset:36864
    ds_read_b64 v[14:15], v250 offset:32
    v_mfma_f32_16x16x32_bf16 v[64:67], a[240:243], a[72:75], v[64:67]
    ds_read_b64_tr_b16 a[236:237], v215 offset:25600
    ds_read_b64 v[16:17], v250 offset:64
    v_mfma_f32_16x16x32_bf16 v[68:71], a[240:243], a[76:79], v[68:71]
    ds_read_b64_tr_b16 a[238:239], v215 offset:37888
    buffer_load_dwordx4 v229, s[20:23], s54 offen offset:1024  lds
    v_mfma_f32_16x16x32_bf16 v[76:79], a[244:247], a[76:79], v[76:79]
    ds_read_b64_tr_b16 a[240:241], v212 offset:26624
    ds_read_b64 v[18:19], v250 offset:96
    v_mfma_f32_16x16x32_bf16 v[72:75], a[244:247], a[72:75], v[72:75]
    ds_read_b64_tr_b16 a[242:243], v212 offset:38912
    ds_read_b64 v[20:21], v251 offset:0
    s_waitcnt lgkmcnt(12)
    v_mfma_f32_16x16x32_bf16 v[80:83], a[216:219], a[72:75], v[80:83]
    ds_read_b64_tr_b16 a[244:245], v212 offset:27648
    ds_read_b64 v[22:23], v251 offset:32
    v_mfma_f32_16x16x32_bf16 v[84:87], a[216:219], a[76:79], v[84:87]
    ds_read_b64_tr_b16 a[246:247], v212 offset:39936
    ds_read_b64 v[24:25], v251 offset:64
    v_mfma_f32_16x16x32_bf16 v[92:95], a[220:223], a[76:79], v[92:95]
    ds_read_b64_tr_b16 a[216:217], v213 offset:26624
    ds_read_b64 v[26:27], v251 offset:96
    v_mfma_f32_16x16x32_bf16 v[88:91], a[220:223], a[72:75], v[88:91]
    ds_read_b64_tr_b16 a[218:219], v213 offset:38912
    v_mfma_f32_16x16x32_bf16 v[96:99], a[224:227], a[72:75], v[96:99]
    ds_read_b64_tr_b16 a[220:221], v213 offset:27648
    s_waitcnt lgkmcnt(6)
    v_mfma_f32_16x16x32_bf16 v[56:59], v[20:23], v[232:235], 0
    v_mfma_f32_16x16x32_bf16 v[100:103], a[224:227], a[76:79], v[100:103]
    ds_read_b64_tr_b16 a[222:223], v213 offset:39936
    buffer_load_dwordx4 v230, s[16:19], s56 offen offset:2048  lds
    v_mfma_f32_16x16x32_bf16 v[108:111], a[228:231], a[76:79], v[108:111]
    ds_read_b64_tr_b16 a[224:225], v214 offset:26624
    v_mfma_f32_16x16x32_bf16 v[32:35], v[0:3], v[232:235], 0
    v_mfma_f32_16x16x32_bf16 v[104:107], a[228:231], a[72:75], v[104:107]
    ds_read_b64_tr_b16 a[226:227], v214 offset:38912
    v_mfma_f32_16x16x32_bf16 v[40:43], v[4:7], v[232:235], 0
    v_mfma_f32_16x16x32_bf16 v[48:51], v[12:15], v[232:235], 0
    s_waitcnt lgkmcnt(8)
    v_mfma_f32_16x16x32_bf16 v[112:115], a[232:235], a[72:75], v[112:115]
    ds_read_b64_tr_b16 a[228:229], v214 offset:27648
    s_add_u32 s42, s40, 3
    v_subrev_u32 v253, s42, v253
    v_cmp_ge_u32 vcc, 12, v253
    s_nop 1
    s_cmp_eq_u64 vcc, exec
    s_cbranch_scc0 L_poll2_slow
L_poll2_ok:
    v_mfma_f32_16x16x32_bf16 v[116:119], a[232:235], a[76:79], v[116:119]
    ds_read_b64_tr_b16 a[230:231], v214 offset:39936
    s_waitcnt lgkmcnt(7)
    v_mfma_f32_16x16x32_bf16 v[56:59], v[24:27], v[236:239], v[56:59]
    v_mfma_f32_16x16x32_bf16 v[124:127], a[236:239], a[76:79], v[124:127]
    ds_read_b64_tr_b16 a[232:233], v215 offset:26624
    v_mfma_f32_16x16x32_bf16 v[40:43], v[8:11], v[236:239], v[40:43]
    v_mfma_f32_16x16x32_bf16 v[120:123], a[236:239], a[72:75], v[120:123]
    ds_read_b64_tr_b16 a[234:235], v215 offset:38912
    v_mfma_f32_16x16x32_bf16 v[48:51], v[16:19], v[236:239], v[48:51]
    v_mfma_f32_16x16x32_bf16 v[64:67], a[240:243], a[80:83], v[64:67]
    ds_read_b64_tr_b16 a[236:237], v215 offset:27648
    s_add_u32 s75, s75, 4096
    v_mfma_f32_16x16x32_bf16 v[60:63], v[20:23], v[240:243], 0
    v_mfma_f32_16x16x32_bf16 v[68:71], a[240:243], a[84:87], v[68:71]
    ds_read_b64_tr_b16 a[238:239], v215 offset:39936
    buffer_load_dwordx4 v231, s[20:23], s56 offen offset:3072  lds
    v_mfma_f32_16x16x32_bf16 v[76:79], a[244:247], a[84:87], v[76:79]
    ds_read_b64_tr_b16 a[240:241], v212 offset:28672
    v_mfma_f32_16x16x32_bf16 v[36:39], v[0:3], v[240:243], 0
    v_mfma_f32_16x16x32_bf16 v[72:75], a[244:247], a[80:83], v[72:75]
    ds_read_b64_tr_b16 a[242:243], v212 offset:40960
    v_mfma_f32_16x16x32_bf16 v[44:47], v[4:7], v[240:243], 0
    s_waitcnt lgkmcnt(6)
    v_mfma_f32_16x16x32_bf16 v[80:83], a[216:219], a[80:83], v[80:83]
    ds_read_b64_tr_b16 a[244:245], v212 offset:29696
    buffer_load_dwordx4 a[160:163], v208, s[32:35], s75 offen offset:0 sc1
    v_mfma_f32_16x16x32_bf16 v[52:55], v[12:15], v[240:243], 0
    v_mfma_f32_16x16x32_bf16 v[84:87], a[216:219], a[84:87], v[84:87]
    ds_read_b64_tr_b16 a[246:247], v212 offset:41984
    s_add_u32 m0, s39, 28672
    v_mfma_f32_16x16x32_bf16 v[92:95], a[220:223], a[84:87], v[92:95]
    ds_read_b64_tr_b16 a[216:217], v213 offset:28672
    v_mfma_f32_16x16x32_bf16 v[60:63], v[24:27], v[244:247], v[60:63]
    v_mfma_f32_16x16x32_bf16 v[88:91], a[220:223], a[80:83], v[88:91]
    ds_read_b64_tr_b16 a[218:219], v213 offset:40960
    v_mfma_f32_16x16x32_bf16 v[44:47], v[8:11], v[244:247], v[44:47]
    v_mfma_f32_16x16x32_bf16 v[52:55], v[16:19], v[244:247], v[52:55]
    v_mfma_f32_16x16x32_bf16 v[96:99], a[224:227], a[80:83], v[96:99]
    ds_read_b64_tr_b16 a[220:221], v213 offset:29696
    buffer_load_dwordx4 v228, s[16:19], s58 offen offset:0  lds
    v_mfma_f32_16x16x32_bf16 v[100:103], a[224:227], a[84:87], v[100:103]
    ds_read_b64_tr_b16 a[222:223], v213 offset:41984
    buffer_load_dwordx4 a[164:167], v208, s[32:35], s75 offen offset:1024 sc1
    v_mfma_f32_16x16x32_bf16 v[108:111], a[228:231], a[84:87], v[108:111]
    ds_read_b64_tr_b16 a[224:225], v214 offset:28672
    v_cmp_gt_u32 s[0:1], 16, v209
    v_mfma_f32_16x16x32_bf16 v[104:107], a[228:231], a[80:83], v[104:107]
    ds_read_b64_tr_b16 a[226:227], v214 offset:40960
    v_accvgpr_read_b32 v200, a182
    v_permlane16_swap_b32 v210, v211
    s_waitcnt lgkmcnt(6)
    v_mfma_f32_16x16x32_bf16 v[112:115], a[232:235], a[80:83], v[112:115]
    ds_read_b64_tr_b16 a[228:229], v214 offset:29696
    buffer_load_dwordx4 a[168:171], v208, s[32:35], s75 offen offset:2048 sc1
    v_mfma_f32_16x16x32_bf16 v[116:119], a[232:235], a[84:87], v[116:119]
    ds_read_b64_tr_b16 a[230:231], v214 offset:41984
    v_min_u32 v201, 31, v209
    v_mfma_f32_16x16x32_bf16 v[124:127], a[236:239], a[84:87], v[124:127]
    ds_read_b64_tr_b16 a[232:233], v215 offset:28672
    v_lshlrev_b32 v201, 2, v201
    v_mfma_f32_16x16x32_bf16 v[120:123], a[236:239], a[80:83], v[120:123]
    ds_read_b64_tr_b16 a[234:235], v215 offset:40960
    s_add_u32 s66, s81, 36864
    s_cmp_eq_u32 s38, 0
    s_cselect_b32 s66, s66, 1073741824
    v_mfma_f32_16x16x32_bf16 v[64:67], a[240:243], a[88:91], v[64:67]
    ds_read_b64_tr_b16 a[236:237], v215 offset:29696
    buffer_load_dwordx4 v229, s[20:23], s58 offen offset:1024  lds
    s_xor_b32 s42, s38, 0
    s_lshl_b32 s42, s42, 11
    s_add_u32 s81, s81, s42
    v_mfma_f32_16x16x32_bf16 v[68:71], a[240:243], a[92:95], v[68:71]
    ds_read_b64_tr_b16 a[238:239], v215 offset:41984
    buffer_load_dwordx4 a[172:175], v208, s[32:35], s75 offen offset:3072 sc1
    v_mfma_f32_16x16x32_bf16 v[76:79], a[244:247], a[92:95], v[76:79]
    s_waitcnt vmcnt(14)
    s_barrier
    v_add_u32 v212, 0xc000, v212
    ds_read_b64_tr_b16 a[240:241], v212 offset:0
    s_add_u32 s42, s40, 4
    v_mov_b32 v254, s42
    buffer_store_dword v254, v255, s[32:35], s47 offen sc1
    v_add_f32 v56, 0x358637bd, v56
    v_mfma_f32_16x16x32_bf16 v[72:75], a[244:247], a[88:91], v[72:75]
    ds_read_b64_tr_b16 a[242:243], v212 offset:12288
    v_add_f32 v58, 0x358637bd, v58
    s_waitcnt lgkmcnt(6)
    v_mfma_f32_16x16x32_bf16 v[80:83], a[216:219], a[88:91], v[80:83]
    ds_read_b64_tr_b16 a[244:245], v212 offset:1024
    v_rcp_f32 v56, v56
    v_mfma_f32_16x16x32_bf16 v[84:87], a[216:219], a[92:95], v[84:87]
    ds_read_b64_tr_b16 a[246:247], v212 offset:13312
    v_rcp_f32 v58, v58
    v_mfma_f32_16x16x32_bf16 v[92:95], a[220:223], a[92:95], v[92:95]
    v_add_u32 v213, 0xc000, v213
    ds_read_b64_tr_b16 a[216:217], v213 offset:0
    s_add_u32 m0, s39, 49152
    v_mfma_f32_16x16x32_bf16 v[88:91], a[220:223], a[88:91], v[88:91]
    ds_read_b64_tr_b16 a[218:219], v213 offset:12288
    v_cndmask_b32 v57, v58, v56, s[0:1]
    v_mfma_f32_16x16x32_bf16 v[96:99], a[224:227], a[88:91], v[96:99]
    ds_read_b64_tr_b16 a[220:221], v213 offset:1024
    v_mul_f32 v32, v32, v56
    v_mul_f32 v33, v33, v56
    v_mfma_f32_16x16x32_bf16 v[100:103], a[224:227], a[92:95], v[100:103]
    ds_read_b64_tr_b16 a[222:223], v213 offset:13312
    buffer_load_dwordx4 v228, s[16:19], s60 offen offset:0  lds
    v_mfma_f32_16x16x32_bf16 v[108:111], a[228:231], a[92:95], v[108:111]
    v_add_u32 v214, 0xc000, v214
    ds_read_b64_tr_b16 a[224:225], v214 offset:0
    v_mul_f32 v34, v34, v56
    v_mfma_f32_16x16x32_bf16 v[104:107], a[228:231], a[88:91], v[104:107]
    ds_read_b64_tr_b16 a[226:227], v214 offset:12288
    v_mul_f32 v35, v35, v56
    s_waitcnt lgkmcnt(6)
    v_mfma_f32_16x16x32_bf16 v[112:115], a[232:235], a[88:91], v[112:115]
    ds_read_b64_tr_b16 a[228:229], v214 offset:1024
    v_cvt_pk_bf16_f32 v32, v32, v33
    v_mfma_f32_16x16x32_bf16 v[116:119], a[232:235], a[92:95], v[116:119]
    ds_read_b64_tr_b16 a[230:231], v214 offset:13312
    v_cvt_pk_bf16_f32 v33, v34, v35
    v_mfma_f32_16x16x32_bf16 v[124:127], a[236:239], a[92:95], v[124:127]
    v_add_u32 v215, 0xc000, v215
    ds_read_b64_tr_b16 a[232:233], v215 offset:0
    v_mul_f32 v40, v40, v57
    v_mfma_f32_16x16x32_bf16 v[120:123], a[236:239], a[88:91], v[120:123]
    ds_read_b64_tr_b16 a[234:235], v215 offset:12288
    v_mfma_f32_16x16x32_bf16 v[64:67], a[240:243], a[96:99], v[64:67]
    ds_read_b64_tr_b16 a[236:237], v215 offset:1024
    v_mul_f32 v41, v41, v57
    v_mfma_f32_16x16x32_bf16 v[68:71], a[240:243], a[100:103], v[68:71]
    ds_read_b64_tr_b16 a[238:239], v215 offset:13312
    buffer_load_dwordx4 v229, s[20:23], s60 offen offset:1024  lds
    v_mfma_f32_16x16x32_bf16 v[76:79], a[244:247], a[100:103], v[76:79]
    ds_read_b64_tr_b16 a[240:241], v212 offset:2048
    v_mul_f32 v42, v42, v58
    v_mfma_f32_16x16x32_bf16 v[72:75], a[244:247], a[96:99], v[72:75]
    ds_read_b64_tr_b16 a[242:243], v212 offset:14336
    v_mul_f32 v43, v43, v58
    s_waitcnt lgkmcnt(6)
    v_mfma_f32_16x16x32_bf16 v[80:83], a[216:219], a[96:99], v[80:83]
    ds_read_b64_tr_b16 a[244:245], v212 offset:3072
    v_cvt_pk_bf16_f32 v34, v40, v41
    v_mfma_f32_16x16x32_bf16 v[84:87], a[216:219], a[100:103], v[84:87]
    ds_read_b64_tr_b16 a[246:247], v212 offset:15360
    v_cvt_pk_bf16_f32 v35, v42, v43
    v_mfma_f32_16x16x32_bf16 v[92:95], a[220:223], a[100:103], v[92:95]
    ds_read_b64_tr_b16 a[216:217], v213 offset:2048
    v_mul_f32 v48, v48, v58
    v_mfma_f32_16x16x32_bf16 v[88:91], a[220:223], a[96:99], v[88:91]
    ds_read_b64_tr_b16 a[218:219], v213 offset:14336
    v_mul_f32 v49, v49, v58
    v_mfma_f32_16x16x32_bf16 v[96:99], a[224:227], a[96:99], v[96:99]
    ds_read_b64_tr_b16 a[220:221], v213 offset:3072
    v_mul_f32 v50, v50, v58
    v_mfma_f32_16x16x32_bf16 v[100:103], a[224:227], a[100:103], v[100:103]
    ds_read_b64_tr_b16 a[222:223], v213 offset:15360
    buffer_load_dwordx4 v230, s[16:19], s62 offen offset:2048  lds
    v_mfma_f32_16x16x32_bf16 v[108:111], a[228:231], a[100:103], v[108:111]
    ds_read_b64_tr_b16 a[224:225], v214 offset:2048
    v_mul_f32 v51, v51, v58
    v_mfma_f32_16x16x32_bf16 v[104:107], a[228:231], a[96:99], v[104:107]
    ds_read_b64_tr_b16 a[226:227], v214 offset:14336
    v_cvt_pk_bf16_f32 v48, v48, v49
    s_waitcnt lgkmcnt(6)
    v_mfma_f32_16x16x32_bf16 v[112:115], a[232:235], a[96:99], v[112:115]
    ds_read_b64_tr_b16 a[228:229], v214 offset:3072
    v_cvt_pk_bf16_f32 v49, v50, v51
    v_mfma_f32_16x16x32_bf16 v[116:119], a[232:235], a[100:103], v[116:119]
    ds_read_b64_tr_b16 a[230:231], v214 offset:15360
    v_add_f32 v60, 0x358637bd, v60
    v_mfma_f32_16x16x32_bf16 v[124:127], a[236:239], a[100:103], v[124:127]
    ds_read_b64_tr_b16 a[232:233], v215 offset:2048
    v_add_f32 v62, 0x358637bd, v62
    v_mfma_f32_16x16x32_bf16 v[120:123], a[236:239], a[96:99], v[120:123]
    ds_read_b64_tr_b16 a[234:235], v215 offset:14336
    v_rcp_f32 v60, v60
    v_mfma_f32_16x16x32_bf16 v[64:67], a[240:243], a[104:107], v[64:67]
    ds_read_b64_tr_b16 a[236:237], v215 offset:3072
    v_mfma_f32_16x16x32_bf16 v[68:71], a[240:243], a[108:111], v[68:71]
    ds_read_b64_tr_b16 a[238:239], v215 offset:15360
    buffer_load_dwordx4 v231, s[20:23], s62 offen offset:3072  lds
    v_mfma_f32_16x16x32_bf16 v[76:79], a[244:247], a[108:111], v[76:79]
    ds_read_b64_tr_b16 a[240:241], v212 offset:4096
    v_rcp_f32 v62, v62
    v_mfma_f32_16x16x32_bf16 v[72:75], a[244:247], a[104:107], v[72:75]
    ds_read_b64_tr_b16 a[242:243], v212 offset:16384
    v_cndmask_b32 v61, v62, v60, s[0:1]
    s_waitcnt lgkmcnt(6)
    v_mfma_f32_16x16x32_bf16 v[80:83], a[216:219], a[104:107], v[80:83]
    ds_read_b64_tr_b16 a[244:245], v212 offset:5120
    v_mul_f32 v36, v36, v60
    v_mul_f32 v37, v37, v60
    v_mfma_f32_16x16x32_bf16 v[84:87], a[216:219], a[108:111], v[84:87]
    ds_read_b64_tr_b16 a[246:247], v212 offset:17408
    s_add_u32 m0, s39, 53248
    v_mfma_f32_16x16x32_bf16 v[92:95], a[220:223], a[108:111], v[92:95]
    ds_read_b64_tr_b16 a[216:217], v213 offset:4096
    v_mul_f32 v38, v38, v60
    v_mfma_f32_16x16x32_bf16 v[88:91], a[220:223], a[104:107], v[88:91]
    ds_read_b64_tr_b16 a[218:219], v213 offset:16384
    v_mul_f32 v39, v39, v60
    v_mfma_f32_16x16x32_bf16 v[96:99], a[224:227], a[104:107], v[96:99]
    ds_read_b64_tr_b16 a[220:221], v213 offset:5120
    buffer_load_dwordx4 v228, s[16:19], s64 offen offset:0  lds
    v_mfma_f32_16x16x32_bf16 v[100:103], a[224:227], a[108:111], v[100:103]
    ds_read_b64_tr_b16 a[222:223], v213 offset:17408
    v_cvt_pk_bf16_f32 v36, v36, v37
    v_mfma_f32_16x16x32_bf16 v[108:111], a[228:231], a[108:111], v[108:111]
    ds_read_b64_tr_b16 a[224:225], v214 offset:4096
    v_cvt_pk_bf16_f32 v37, v38, v39
    v_mfma_f32_16x16x32_bf16 v[104:107], a[228:231], a[104:107], v[104:107]
    ds_read_b64_tr_b16 a[226:227], v214 offset:16384
    v_mul_f32 v44, v44, v61
    s_waitcnt lgkmcnt(6)
    v_mfma_f32_16x16x32_bf16 v[112:115], a[232:235], a[104:107], v[112:115]
    ds_read_b64_tr_b16 a[228:229], v214 offset:5120
    v_mul_f32 v45, v45, v61
    v_mfma_f32_16x16x32_bf16 v[116:119], a[232:235], a[108:111], v[116:119]
    ds_read_b64_tr_b16 a[230:231], v214 offset:17408
    v_mul_f32 v46, v46, v62
    v_mfma_f32_16x16x32_bf16 v[124:127], a[236:239], a[108:111], v[124:127]
    ds_read_b64_tr_b16 a[232:233], v215 offset:4096
    v_mul_f32 v47, v47, v62
    v_mfma_f32_16x16x32_bf16 v[120:123], a[236:239], a[104:107], v[120:123]
    ds_read_b64_tr_b16 a[234:235], v215 offset:16384
    v_cvt_pk_bf16_f32 v38, v44, v45
    v_mfma_f32_16x16x32_bf16 v[64:67], a[240:243], a[112:115], v[64:67]
    ds_read_b64_tr_b16 a[236:237], v215 offset:5120
    buffer_load_dwordx4 v229, s[20:23], s64 offen offset:1024  lds
    v_mfma_f32_16x16x32_bf16 v[68:71], a[240:243], a[116:119], v[68:71]
    ds_read_b64_tr_b16 a[238:239], v215 offset:17408
    v_cvt_pk_bf16_f32 v39, v46, v47
    v_mfma_f32_16x16x32_bf16 v[76:79], a[244:247], a[116:119], v[76:79]
    s_barrier
    ds_read_b64_tr_b16 a[240:241], v212 offset:24576
    v_mul_f32 v52, v52, v62
    v_mfma_f32_16x16x32_bf16 v[72:75], a[244:247], a[112:115], v[72:75]
    ds_read_b64_tr_b16 a[242:243], v212 offset:36864
    s_add_u32 m0, s39, 73728
    v_mul_f32 v53, v53, v62
    s_waitcnt lgkmcnt(6)
    v_mfma_f32_16x16x32_bf16 v[80:83], a[216:219], a[112:115], v[80:83]
    ds_read_b64_tr_b16 a[244:245], v212 offset:25600
    s_lshr_b32 s48, s38, 1
    s_mul_i32 s48, s48, 663552
    s_mul_i32 s70, s41, 294912
    s_add_u32 s48, s48, s70
    v_mul_f32 v54, v54, v62
    v_mfma_f32_16x16x32_bf16 v[84:87], a[216:219], a[116:119], v[84:87]
    ds_read_b64_tr_b16 a[246:247], v212 offset:37888
    s_add_u32 s70, s71, 0
    s_and_b32 s70, s70, 3
    s_lshl_b32 s70, s70, 7
    s_add_u32 s70, s70, s72
    v_mfma_f32_16x16x32_bf16 v[92:95], a[220:223], a[116:119], v[92:95]
    ds_read_b64_tr_b16 a[216:217], v213 offset:24576
    v_accvgpr_read_b32 v224, a249
    v_mul_f32 v55, v55, v62
    v_mfma_f32_16x16x32_bf16 v[88:91], a[220:223], a[112:115], v[88:91]
    ds_read_b64_tr_b16 a[218:219], v213 offset:36864
    v_add_u32 v224, s70, v224
    v_cvt_pk_bf16_f32 v52, v52, v53
    v_cvt_pk_bf16_f32 v53, v54, v55
    v_mfma_f32_16x16x32_bf16 v[96:99], a[224:227], a[112:115], v[96:99]
    ds_read_b64_tr_b16 a[220:221], v213 offset:25600
    v_subrev_u32 v225, 1024, v224
    v_subrev_u32 v226, 2048, v224
    v_subrev_u32 v227, 3072, v224
    v_mfma_f32_16x16x32_bf16 v[100:103], a[224:227], a[116:119], v[100:103]
    ds_read_b64_tr_b16 a[222:223], v213 offset:37888
    buffer_load_dwordx4 v224, s[24:27], s48 offen offset:0  lds
    v_mfma_f32_16x16x32_bf16 v[108:111], a[228:231], a[116:119], v[108:111]
    ds_read_b64_tr_b16 a[224:225], v214 offset:24576
    v_permlane16_swap_b32 v48, v52
    v_permlane16_swap_b32 v49, v53
    v_mfma_f32_16x16x32_bf16 v[104:107], a[228:231], a[112:115], v[104:107]
    ds_read_b64_tr_b16 a[226:227], v214 offset:36864
    s_waitcnt lgkmcnt(6)
    v_mfma_f32_16x16x32_bf16 v[112:115], a[232:235], a[112:115], v[112:115]
    ds_read_b64_tr_b16 a[228:229], v214 offset:25600
    v_mfma_f32_16x16x32_bf16 v[116:119], a[232:235], a[116:119], v[116:119]
    ds_read_b64_tr_b16 a[230:231], v214 offset:37888
    s_add_u32 s49, s48, 36864
    v_mfma_f32_16x16x32_bf16 v[124:127], a[236:239], a[116:119], v[124:127]
    ds_read_b64_tr_b16 a[232:233], v215 offset:24576
    buffer_store_dwordx4 v[32:35], v208, s[32:35], s81 offen offset:0 sc1
    v_mfma_f32_16x16x32_bf16 v[120:123], a[236:239], a[112:115], v[120:123]
    ds_read_b64_tr_b16 a[234:235], v215 offset:36864
    v_mfma_f32_16x16x32_bf16 v[64:67], a[240:243], a[120:123], v[64:67]
    ds_read_b64_tr_b16 a[236:237], v215 offset:25600
    v_mfma_f32_16x16x32_bf16 v[68:71], a[240:243], a[124:127], v[68:71]
    ds_read_b64_tr_b16 a[238:239], v215 offset:37888
    buffer_load_dwordx4 v225, s[24:27], s49 offen offset:1024  lds
    v_mfma_f32_16x16x32_bf16 v[76:79], a[244:247], a[124:127], v[76:79]
    ds_read_b64_tr_b16 a[240:241], v212 offset:26624
    buffer_store_dwordx4 v[36:39], v208, s[32:35], s81 offen offset:1024 sc1
    v_mfma_f32_16x16x32_bf16 v[72:75], a[244:247], a[120:123], v[72:75]
    ds_read_b64_tr_b16 a[242:243], v212 offset:38912
    v_mov_b32 v252, 0
    s_waitcnt lgkmcnt(6)
    v_mfma_f32_16x16x32_bf16 v[80:83], a[216:219], a[120:123], v[80:83]
    ds_read_b64_tr_b16 a[244:245], v212 offset:27648
    s_xor_b32 s77, s47, 256
    buffer_load_dword v253, v252, s[32:35], s77 offen sc1
    v_mfma_f32_16x16x32_bf16 v[84:87], a[216:219], a[124:127], v[84:87]
    ds_read_b64_tr_b16 a[246:247], v212 offset:39936
    s_add_u32 s50, s49, 36864
    v_mfma_f32_16x16x32_bf16 v[92:95], a[220:223], a[124:127], v[92:95]
    ds_read_b64_tr_b16 a[216:217], v213 offset:26624
    s_mov_b32 exec_hi, 0
    buffer_store_dword v210, v201, s[32:35], s66 offen sc1
    s_mov_b32 exec_hi, -1
    v_mfma_f32_16x16x32_bf16 v[88:91], a[220:223], a[120:123], v[88:91]
    ds_read_b64_tr_b16 a[218:219], v213 offset:38912
    v_mfma_f32_16x16x32_bf16 v[96:99], a[224:227], a[120:123], v[96:99]
    ds_read_b64_tr_b16 a[220:221], v213 offset:27648
    v_mfma_f32_16x16x32_bf16 v[100:103], a[224:227], a[124:127], v[100:103]
    ds_read_b64_tr_b16 a[222:223], v213 offset:39936
    buffer_load_dwordx4 v226, s[24:27], s50 offen offset:2048  lds
    v_mfma_f32_16x16x32_bf16 v[108:111], a[228:231], a[124:127], v[108:111]
    ds_read_b64_tr_b16 a[224:225], v214 offset:26624
    buffer_store_dwordx2 v[48:49], v200, s[32:35], s82 offen sc1
    v_mfma_f32_16x16x32_bf16 v[104:107], a[228:231], a[120:123], v[104:107]
    ds_read_b64_tr_b16 a[226:227], v214 offset:38912
    s_waitcnt lgkmcnt(6)
    v_mfma_f32_16x16x32_bf16 v[112:115], a[232:235], a[120:123], v[112:115]
    ds_read_b64_tr_b16 a[228:229], v214 offset:27648
    v_mfma_f32_16x16x32_bf16 v[116:119], a[232:235], a[124:127], v[116:119]
    ds_read_b64_tr_b16 a[230:231], v214 offset:39936
    s_add_u32 s51, s50, 36864
    v_mfma_f32_16x16x32_bf16 v[124:127], a[236:239], a[124:127], v[124:127]
    ds_read_b64_tr_b16 a[232:233], v215 offset:26624
    v_mfma_f32_16x16x32_bf16 v[120:123], a[236:239], a[120:123], v[120:123]
    ds_read_b64_tr_b16 a[234:235], v215 offset:38912
    v_mfma_f32_16x16x32_bf16 v[64:67], a[240:243], a[128:131], v[64:67]
    ds_read_b64_tr_b16 a[236:237], v215 offset:27648
    v_mfma_f32_16x16x32_bf16 v[68:71], a[240:243], a[132:135], v[68:71]
    ds_read_b64_tr_b16 a[238:239], v215 offset:39936
    buffer_load_dwordx4 v227, s[24:27], s51 offen offset:3072  lds
    v_mfma_f32_16x16x32_bf16 v[76:79], a[244:247], a[132:135], v[76:79]
    ds_read_b64_tr_b16 a[240:241], v212 offset:28672
    v_accvgpr_read_b32 v216, a252
    v_mfma_f32_16x16x32_bf16 v[72:75], a[244:247], a[128:131], v[72:75]
    ds_read_b64_tr_b16 a[242:243], v212 offset:40960
    s_add_u32 m0, s39, 77824
    s_waitcnt lgkmcnt(6)
    v_mfma_f32_16x16x32_bf16 v[80:83], a[216:219], a[128:131], v[80:83]
    ds_read_b64_tr_b16 a[244:245], v212 offset:29696
    v_xor_b32 v217, 32, v216
    v_mfma_f32_16x16x32_bf16 v[84:87], a[216:219], a[132:135], v[84:87]
    ds_read_b64_tr_b16 a[246:247], v212 offset:41984
    v_accvgpr_read_b32 v218, a253
    v_mfma_f32_16x16x32_bf16 v[92:95], a[220:223], a[132:135], v[92:95]
    ds_read_b64_tr_b16 a[216:217], v213 offset:28672
    s_add_u32 s52, s51, 36864
    v_mfma_f32_16x16x32_bf16 v[88:91], a[220:223], a[128:131], v[88:91]
    ds_read_b64_tr_b16 a[218:219], v213 offset:40960
    v_mfma_f32_16x16x32_bf16 v[96:99], a[224:227], a[128:131], v[96:99]
    ds_read_b64_tr_b16 a[220:221], v213 offset:29696
    buffer_load_dwordx4 v224, s[24:27], s52 offen offset:0  lds
    v_mfma_f32_16x16x32_bf16 v[100:103], a[224:227], a[132:135], v[100:103]
    ds_read_b64_tr_b16 a[222:223], v213 offset:41984
    v_mfma_f32_16x16x32_bf16 v[108:111], a[228:231], a[132:135], v[108:111]
    ds_read_b64_tr_b16 a[224:225], v214 offset:28672
    v_mfma_f32_16x16x32_bf16 v[104:107], a[228:231], a[128:131], v[104:107]
    ds_read_b64_tr_b16 a[226:227], v214 offset:40960
    s_waitcnt lgkmcnt(6)
    v_mfma_f32_16x16x32_bf16 v[112:115], a[232:235], a[128:131], v[112:115]
    ds_read_b64_tr_b16 a[228:229], v214 offset:29696
    s_add_u32 s53, s52, 36864
    v_mfma_f32_16x16x32_bf16 v[116:119], a[232:235], a[132:135], v[116:119]
    ds_read_b64_tr_b16 a[230:231], v214 offset:41984
    v_mfma_f32_16x16x32_bf16 v[124:127], a[236:239], a[132:135], v[124:127]
    ds_read_b64_tr_b16 a[232:233], v215 offset:28672
    v_mfma_f32_16x16x32_bf16 v[120:123], a[236:239], a[128:131], v[120:123]
    ds_read_b64_tr_b16 a[234:235], v215 offset:40960
    v_mfma_f32_16x16x32_bf16 v[64:67], a[240:243], a[136:139], v[64:67]
    ds_read_b64_tr_b16 a[236:237], v215 offset:29696
    buffer_load_dwordx4 v225, s[24:27], s53 offen offset:1024  lds
    v_mfma_f32_16x16x32_bf16 v[68:71], a[240:243], a[140:143], v[68:71]
    ds_read_b64_tr_b16 a[238:239], v215 offset:41984
    v_mfma_f32_16x16x32_bf16 v[76:79], a[244:247], a[140:143], v[76:79]
    s_waitcnt vmcnt(28)
    s_barrier
    ds_read_b64_tr_b16 a[240:241], v216 offset:0
    v_mfma_f32_16x16x32_bf16 v[72:75], a[244:247], a[136:139], v[72:75]
    ds_read_b64_tr_b16 a[242:243], v216 offset:6144
    s_waitcnt lgkmcnt(6)
    v_mfma_f32_16x16x32_bf16 v[80:83], a[216:219], a[136:139], v[80:83]
    ds_read_b64_tr_b16 a[244:245], v216 offset:1024
    s_add_u32 m0, s39, 98304
    v_mfma_f32_16x16x32_bf16 v[84:87], a[216:219], a[140:143], v[84:87]
    ds_read_b64_tr_b16 a[246:247], v216 offset:7168
    v_mfma_f32_16x16x32_bf16 v[92:95], a[220:223], a[140:143], v[92:95]
    ds_read_b64_tr_b16 a[216:217], v217 offset:0
    s_mul_i32 s100, s91, 41
    s_add_u32 s100, s100, 3072
    v_mfma_f32_16x16x32_bf16 v[88:91], a[220:223], a[136:139], v[88:91]
    ds_read_b64_tr_b16 a[218:219], v217 offset:6144
    s_add_u32 s54, s53, 36864
    v_mfma_f32_16x16x32_bf16 v[96:99], a[224:227], a[136:139], v[96:99]
    ds_read_b64_tr_b16 a[220:221], v217 offset:1024
    v_mfma_f32_16x16x32_bf16 v[100:103], a[224:227], a[140:143], v[100:103]
    ds_read_b64_tr_b16 a[222:223], v217 offset:7168
    buffer_load_dwordx4 v224, s[24:27], s54 offen offset:0  lds
    v_mfma_f32_16x16x32_bf16 v[108:111], a[228:231], a[140:143], v[108:111]
    ds_read_b64_tr_b16 a[224:225], v216 offset:12288
    v_min_u32 v207, 10, v209
    v_mfma_f32_16x16x32_bf16 v[104:107], a[228:231], a[136:139], v[104:107]
    ds_read_b64_tr_b16 a[226:227], v216 offset:18432
    s_waitcnt lgkmcnt(6)
    v_mfma_f32_16x16x32_bf16 v[112:115], a[232:235], a[136:139], v[112:115]
    ds_read_b64_tr_b16 a[228:229], v216 offset:13312
    v_mfma_f32_16x16x32_bf16 v[116:119], a[232:235], a[140:143], v[116:119]
    ds_read_b64_tr_b16 a[230:231], v216 offset:19456
    s_add_u32 s55, s54, 36864
    v_mfma_f32_16x16x32_bf16 v[124:127], a[236:239], a[140:143], v[124:127]
    ds_read_b64_tr_b16 a[232:233], v217 offset:12288
    v_lshlrev_b32 v207, 7, v207
    v_mfma_f32_16x16x32_bf16 v[120:123], a[236:239], a[136:139], v[120:123]
    ds_read_b64_tr_b16 a[234:235], v217 offset:18432
    v_mfma_f32_16x16x32_bf16 v[0:3], a[240:243], a[0:3], 0
    ds_read_b64_tr_b16 a[236:237], v217 offset:13312
    v_mfma_f32_16x16x32_bf16 v[4:7], a[240:243], a[4:7], 0
    ds_read_b64_tr_b16 a[238:239], v217 offset:19456
    buffer_load_dwordx4 v225, s[24:27], s55 offen offset:1024  lds
    v_mfma_f32_16x16x32_bf16 v[12:15], a[244:247], a[4:7], 0
    ds_read_b64_tr_b16 a[240:241], v216 offset:2048
    v_mfma_f32_16x16x32_bf16 v[8:11], a[244:247], a[0:3], 0
    ds_read_b64_tr_b16 a[242:243], v216 offset:8192
    s_waitcnt lgkmcnt(6)
    v_mfma_f32_16x16x32_bf16 v[16:19], a[216:219], a[0:3], 0
    ds_read_b64_tr_b16 a[244:245], v216 offset:3072
    v_mfma_f32_16x16x32_bf16 v[20:23], a[216:219], a[4:7], 0
    ds_read_b64_tr_b16 a[246:247], v216 offset:9216
    s_mul_i32 s70, s41, 258048
    s_sub_u32 s70, 589824, s70
    s_add_u32 s64, s48, s70
    v_mfma_f32_16x16x32_bf16 v[28:31], a[220:223], a[4:7], 0
    ds_read_b64_tr_b16 a[216:217], v217 offset:2048
    v_mul_f32 v64, v64, v72
    v_mfma_f32_16x16x32_bf16 v[24:27], a[220:223], a[0:3], 0
    ds_read_b64_tr_b16 a[218:219], v217 offset:8192
    v_mul_f32 v65, v65, v73
    v_mfma_f32_16x16x32_bf16 v[0:3], a[224:227], a[8:11], v[0:3]
    ds_read_b64_tr_b16 a[220:221], v217 offset:3072
    v_mul_f32 v66, v66, v74
    v_mfma_f32_16x16x32_bf16 v[4:7], a[224:227], a[12:15], v[4:7]
    ds_read_b64_tr_b16 a[222:223], v217 offset:9216
    buffer_load_dwordx4 v226, s[24:27], s64 offen offset:2048  lds
    v_mfma_f32_16x16x32_bf16 v[12:15], a[228:231], a[12:15], v[12:15]
    ds_read_b64_tr_b16 a[224:225], v216 offset:14336
    v_mul_f32 v67, v67, v75
    v_mfma_f32_16x16x32_bf16 v[8:11], a[228:231], a[8:11], v[8:11]
    ds_read_b64_tr_b16 a[226:227], v216 offset:20480
    buffer_load_dword a215, v207, s[12:15], s100 offen offset:0
    s_add_u32 s42, s40, 4
    s_waitcnt vmcnt(10)
    v_subrev_u32 v253, s42, v253
    v_cmp_ge_u32 vcc, 11, v253
    s_nop 1
    s_cmp_eq_u64 vcc, exec
    s_cbranch_scc0 L_poll3_slow
L_poll3_ok:
    s_waitcnt lgkmcnt(6)
    v_mfma_f32_16x16x32_bf16 v[16:19], a[232:235], a[8:11], v[16:19]
    ds_read_b64_tr_b16 a[228:229], v216 offset:15360
    v_cvt_pk_bf16_f32 v176, v64, v65
    v_cvt_pk_bf16_f32 v177, v66, v67
    v_mfma_f32_16x16x32_bf16 v[20:23], a[232:235], a[12:15], v[20:23]
    ds_read_b64_tr_b16 a[230:231], v216 offset:21504
    s_mul_i32 s70, s41, 589824
    s_sub_u32 s70, 294912, s70
    s_add_u32 s56, s48, s70
    v_mfma_f32_16x16x32_bf16 v[28:31], a[236:239], a[12:15], v[28:31]
    ds_read_b64_tr_b16 a[232:233], v217 offset:14336
    buffer_load_dword a215, v207, s[12:15], s100 offen offset:1280
    v_mul_f32 v68, v68, v76
    v_mfma_f32_16x16x32_bf16 v[24:27], a[236:239], a[8:11], v[24:27]
    ds_read_b64_tr_b16 a[234:235], v217 offset:20480
    buffer_load_dword a215, v207, s[12:15], s100 offen offset:2560
    v_mul_f32 v69, v69, v77
    v_mfma_f32_16x16x32_bf16 v[0:3], a[240:243], a[16:19], v[0:3]
    ds_read_b64_tr_b16 a[236:237], v217 offset:15360
    v_mul_f32 v70, v70, v78
    v_mfma_f32_16x16x32_bf16 v[4:7], a[240:243], a[20:23], v[4:7]
    ds_read_b64_tr_b16 a[238:239], v217 offset:21504
    buffer_load_dwordx4 v227, s[24:27], s56 offen offset:3072  lds
    v_mul_f32 v71, v71, v79
    v_mfma_f32_16x16x32_bf16 v[12:15], a[244:247], a[20:23], v[12:15]
    ds_read_b64_tr_b16 a[240:241], v216 offset:4096
    buffer_load_dword a215, v207, s[12:15], s100 offen offset:3840
    v_cvt_pk_bf16_f32 v180, v68, v69
    v_mfma_f32_16x16x32_bf16 v[8:11], a[244:247], a[16:19], v[8:11]
    ds_read_b64_tr_b16 a[242:243], v216 offset:10240
    s_add_u32 m0, s39, 102400
    s_waitcnt lgkmcnt(6)
    v_mfma_f32_16x16x32_bf16 v[16:19], a[216:219], a[16:19], v[16:19]
    ds_read_b64_tr_b16 a[244:245], v216 offset:5120
    v_cvt_pk_bf16_f32 v181, v70, v71
    v_mfma_f32_16x16x32_bf16 v[20:23], a[216:219], a[20:23], v[20:23]
    ds_read_b64_tr_b16 a[246:247], v216 offset:11264
    v_mul_f32 v80, v80, v88
    v_mul_f32 v81, v81, v89
    v_mfma_f32_16x16x32_bf16 v[28:31], a[220:223], a[20:23], v[28:31]
    ds_read_b64_tr_b16 a[216:217], v217 offset:4096
    s_add_u32 s57, s56, 36864
    v_mfma_f32_16x16x32_bf16 v[24:27], a[220:223], a[16:19], v[24:27]
    ds_read_b64_tr_b16 a[218:219], v217 offset:10240
    v_mul_f32 v82, v82, v90
    v_mfma_f32_16x16x32_bf16 v[0:3], a[224:227], a[24:27], v[0:3]
    ds_read_b64_tr_b16 a[220:221], v217 offset:5120
    buffer_load_dwordx4 v224, s[24:27], s57 offen offset:0  lds
    v_mfma_f32_16x16x32_bf16 v[4:7], a[224:227], a[28:31], v[4:7]
    ds_read_b64_tr_b16 a[222:223], v217 offset:11264
    v_mul_f32 v83, v83, v91
    v_mfma_f32_16x16x32_bf16 v[12:15], a[228:231], a[28:31], v[12:15]
    ds_read_b64_tr_b16 a[224:225], v216 offset:16384
    v_cvt_pk_bf16_f32 v178, v80, v81
    v_mfma_f32_16x16x32_bf16 v[8:11], a[228:231], a[24:27], v[8:11]
    ds_read_b64_tr_b16 a[226:227], v216 offset:22528
    v_cvt_pk_bf16_f32 v179, v82, v83
    v_mul_f32 v84, v84, v92
    s_waitcnt lgkmcnt(6)
    v_mfma_f32_16x16x32_bf16 v[16:19], a[232:235], a[24:27], v[16:19]
    ds_read_b64_tr_b16 a[228:229], v216 offset:17408
    s_add_u32 s58, s57, 36864
    v_mfma_f32_16x16x32_bf16 v[20:23], a[232:235], a[28:31], v[20:23]
    ds_read_b64_tr_b16 a[230:231], v216 offset:23552
    v_mul_f32 v85, v85, v93
    v_mfma_f32_16x16x32_bf16 v[28:31], a[236:239], a[28:31], v[28:31]
    ds_read_b64_tr_b16 a[232:233], v217 offset:16384
    v_mul_f32 v86, v86, v94
    v_mfma_f32_16x16x32_bf16 v[24:27], a[236:239], a[24:27], v[24:27]
    ds_read_b64_tr_b16 a[234:235], v217 offset:22528
    v_mul_f32 v87, v87, v95
    v_mfma_f32_16x16x32_bf16 v[0:3], a[240:243], a[32:35], v[0:3]
    ds_read_b64_tr_b16 a[236:237], v217 offset:17408
    buffer_load_dwordx4 v225, s[24:27], s58 offen offset:1024  lds
    v_mfma_f32_16x16x32_bf16 v[4:7], a[240:243], a[36:39], v[4:7]
    ds_read_b64_tr_b16 a[238:239], v217 offset:23552
    v_cvt_pk_bf16_f32 v182, v84, v85
    v_mfma_f32_16x16x32_bf16 v[12:15], a[244:247], a[36:39], v[12:15]
    s_waitcnt vmcnt(13)
    s_barrier
    ds_read_b64_tr_b16 a[240:241], v216 offset:24576
    s_add_u32 s42, s40, 5
    v_mov_b32 v254, s42
    buffer_store_dword v254, v255, s[32:35], s47 offen sc1
    v_cvt_pk_bf16_f32 v183, v86, v87
    v_mfma_f32_16x16x32_bf16 v[8:11], a[244:247], a[32:35], v[8:11]
    ds_read_b64_tr_b16 a[242:243], v216 offset:30720
    v_mul_f32 v96, v96, v104
    v_mul_f32 v97, v97, v105
    s_waitcnt lgkmcnt(6)
    v_mfma_f32_16x16x32_bf16 v[16:19], a[216:219], a[32:35], v[16:19]
    ds_read_b64_tr_b16 a[244:245], v216 offset:25600
    s_add_u32 m0, s39, 122880
    v_mfma_f32_16x16x32_bf16 v[20:23], a[216:219], a[36:39], v[20:23]
    ds_read_b64_tr_b16 a[246:247], v216 offset:31744
    v_mul_f32 v98, v98, v106
    v_mfma_f32_16x16x32_bf16 v[28:31], a[220:223], a[36:39], v[28:31]
    ds_read_b64_tr_b16 a[216:217], v217 offset:24576
    v_mul_f32 v99, v99, v107
    v_mfma_f32_16x16x32_bf16 v[24:27], a[220:223], a[32:35], v[24:27]
    ds_read_b64_tr_b16 a[218:219], v217 offset:30720
    s_add_u32 s59, s58, 36864
    v_mfma_f32_16x16x32_bf16 v[0:3], a[224:227], a[40:43], v[0:3]
    ds_read_b64_tr_b16 a[220:221], v217 offset:25600
    v_cvt_pk_bf16_f32 v184, v96, v97
    v_cvt_pk_bf16_f32 v185, v98, v99
    v_mfma_f32_16x16x32_bf16 v[4:7], a[224:227], a[44:47], v[4:7]
    ds_read_b64_tr_b16 a[222:223], v217 offset:31744
    buffer_load_dwordx4 v224, s[24:27], s59 offen offset:0  lds
    v_mfma_f32_16x16x32_bf16 v[12:15], a[228:231], a[44:47], v[12:15]
    ds_read_b64_tr_b16 a[224:225], v216 offset:36864
    v_mul_f32 v100, v100, v108
    v_mfma_f32_16x16x32_bf16 v[8:11], a[228:231], a[40:43], v[8:11]
    ds_read_b64_tr_b16 a[226:227], v216 offset:43008
    v_mul_f32 v101, v101, v109
    s_waitcnt lgkmcnt(6)
    v_mfma_f32_16x16x32_bf16 v[16:19], a[232:235], a[40:43], v[16:19]
    ds_read_b64_tr_b16 a[228:229], v216 offset:37888
    v_mul_f32 v102, v102, v110
    v_mfma_f32_16x16x32_bf16 v[20:23], a[232:235], a[44:47], v[20:23]
    ds_read_b64_tr_b16 a[230:231], v216 offset:44032
    s_add_u32 s60, s59, 36864
    v_mfma_f32_16x16x32_bf16 v[28:31], a[236:239], a[44:47], v[28:31]
    ds_read_b64_tr_b16 a[232:233], v217 offset:36864
    v_mul_f32 v103, v103, v111
    v_mfma_f32_16x16x32_bf16 v[24:27], a[236:239], a[40:43], v[24:27]
    ds_read_b64_tr_b16 a[234:235], v217 offset:43008
    v_cvt_pk_bf16_f32 v188, v100, v101
    v_mfma_f32_16x16x32_bf16 v[0:3], a[240:243], a[48:51], v[0:3]
    ds_read_b64_tr_b16 a[236:237], v217 offset:37888
    v_cvt_pk_bf16_f32 v189, v102, v103
    v_mul_f32 v112, v112, v120
    v_mfma_f32_16x16x32_bf16 v[4:7], a[240:243], a[52:55], v[4:7]
    ds_read_b64_tr_b16 a[238:239], v217 offset:44032
    buffer_load_dwordx4 v225, s[24:27], s60 offen offset:1024  lds
    v_mfma_f32_16x16x32_bf16 v[12:15], a[244:247], a[52:55], v[12:15]
    ds_read_b64_tr_b16 a[240:241], v216 offset:26624
    v_mul_f32 v113, v113, v121
    v_mfma_f32_16x16x32_bf16 v[8:11], a[244:247], a[48:51], v[8:11]
    ds_read_b64_tr_b16 a[242:243], v216 offset:32768
    v_mul_f32 v114, v114, v122
    s_waitcnt lgkmcnt(6)
    v_mfma_f32_16x16x32_bf16 v[16:19], a[216:219], a[48:51], v[16:19]
    ds_read_b64_tr_b16 a[244:245], v216 offset:27648
    v_mul_f32 v115, v115, v123
    v_mfma_f32_16x16x32_bf16 v[20:23], a[216:219], a[52:55], v[20:23]
    ds_read_b64_tr_b16 a[246:247], v216 offset:33792
    s_add_u32 s61, s60, 36864
    v_mfma_f32_16x16x32_bf16 v[28:31], a[220:223], a[52:55], v[28:31]
    ds_read_b64_tr_b16 a[216:217], v217 offset:26624
    v_cvt_pk_bf16_f32 v186, v112, v113
    v_mfma_f32_16x16x32_bf16 v[24:27], a[220:223], a[48:51], v[24:27]
    ds_read_b64_tr_b16 a[218:219], v217 offset:32768
    v_cvt_pk_bf16_f32 v187, v114, v115
    v_mfma_f32_16x16x32_bf16 v[0:3], a[224:227], a[56:59], v[0:3]
    ds_read_b64_tr_b16 a[220:221], v217 offset:27648
    v_mul_f32 v116, v116, v124
    v_mul_f32 v117, v117, v125
    s_add_u32 s74, s46, 12288
    v_mfma_f32_16x16x32_bf16 v[4:7], a[224:227], a[60:63], v[4:7]
    ds_read_b64_tr_b16 a[222:223], v217 offset:33792
    buffer_load_dwordx4 v226, s[24:27], s61 offen offset:2048  lds
    v_mul_f32 v118, v118, v126
    v_mfma_f32_16x16x32_bf16 v[12:15], a[228:231], a[60:63], v[12:15]
    ds_read_b64_tr_b16 a[224:225], v216 offset:38912
    s_add_u32 s70, s71, 1
    s_and_b32 s70, s70, 3
    s_lshl_b32 s70, s70, 7
    s_add_u32 s70, s70, s72
    v_mfma_f32_16x16x32_bf16 v[8:11], a[228:231], a[56:59], v[8:11]
    ds_read_b64_tr_b16 a[226:227], v216 offset:45056
    v_accvgpr_read_b32 v228, a249
    v_mul_f32 v119, v119, v127
    s_waitcnt lgkmcnt(6)
    v_mfma_f32_16x16x32_bf16 v[16:19], a[232:235], a[56:59], v[16:19]
    ds_read_b64_tr_b16 a[228:229], v216 offset:39936
    v_add_u32 v228, s70, v228
    buffer_store_dwordx4 v[176:179], v208, s[32:35], s74 offen offset:0 sc1
    v_mfma_f32_16x16x32_bf16 v[20:23], a[232:235], a[60:63], v[20:23]
    ds_read_b64_tr_b16 a[230:231], v216 offset:46080
    v_cvt_pk_bf16_f32 v190, v116, v117
    v_cvt_pk_bf16_f32 v191, v118, v119
    v_mfma_f32_16x16x32_bf16 v[28:31], a[236:239], a[60:63], v[28:31]
    ds_read_b64_tr_b16 a[232:233], v217 offset:38912
    v_subrev_u32 v229, 1024, v228
    v_mfma_f32_16x16x32_bf16 v[24:27], a[236:239], a[56:59], v[24:27]
    ds_read_b64_tr_b16 a[234:235], v217 offset:45056
    v_subrev_u32 v230, 2048, v228
    v_mfma_f32_16x16x32_bf16 v[0:3], a[240:243], a[64:67], v[0:3]
    ds_read_b64_tr_b16 a[236:237], v217 offset:39936
    v_subrev_u32 v231, 3072, v228
    buffer_store_dwordx4 v[180:183], v208, s[32:35], s74 offen offset:1024 sc1
    v_mfma_f32_16x16x32_bf16 v[4:7], a[240:243], a[68:71], v[4:7]
    ds_read_b64_tr_b16 a[238:239], v217 offset:46080
    buffer_load_dwordx4 v231, s[24:27], s48 offen offset:3072  lds
    v_mfma_f32_16x16x32_bf16 v[12:15], a[244:247], a[68:71], v[12:15]
    ds_read_b64_tr_b16 a[240:241], v216 offset:28672
    s_add_u32 m0, s39, 126976
    v_mfma_f32_16x16x32_bf16 v[8:11], a[244:247], a[64:67], v[8:11]
    ds_read_b64_tr_b16 a[242:243], v216 offset:34816
    s_add_u32 s62, s61, 36864
    s_waitcnt lgkmcnt(6)
    v_mfma_f32_16x16x32_bf16 v[16:19], a[216:219], a[64:67], v[16:19]
    ds_read_b64_tr_b16 a[244:245], v216 offset:29696
    buffer_store_dwordx4 v[184:187], v208, s[32:35], s74 offen offset:2048 sc1
    v_mfma_f32_16x16x32_bf16 v[20:23], a[216:219], a[68:71], v[20:23]
    ds_read_b64_tr_b16 a[246:247], v216 offset:35840
    s_add_u32 s63, s62, 36864
    v_mfma_f32_16x16x32_bf16 v[28:31], a[220:223], a[68:71], v[28:31]
    ds_read_b64_tr_b16 a[216:217], v217 offset:28672
    s_mul_i32 s70, s41, 331776
    s_sub_u32 s70, 626688, s70
    s_add_u32 s65, s48, s70
    v_mfma_f32_16x16x32_bf16 v[24:27], a[220:223], a[64:67], v[24:27]
    ds_read_b64_tr_b16 a[218:219], v217 offset:34816
    s_sub_u32 s73, s65, 36864
    s_cmp_lt_u32 s36, 2
    s_cselect_b32 s73, s64, s73
    v_mfma_f32_16x16x32_bf16 v[0:3], a[224:227], a[72:75], v[0:3]
    ds_read_b64_tr_b16 a[220:221], v217 offset:29696
    buffer_load_dwordx4 v228, s[24:27], s49 offen offset:0  lds
    v_mfma_f32_16x16x32_bf16 v[4:7], a[224:227], a[76:79], v[4:7]
    ds_read_b64_tr_b16 a[222:223], v217 offset:35840
    buffer_store_dwordx4 v[188:191], v208, s[32:35], s74 offen offset:3072 sc1
    v_mfma_f32_16x16x32_bf16 v[12:15], a[228:231], a[76:79], v[12:15]
    ds_read_b64_tr_b16 a[224:225], v216 offset:40960
    v_mfma_f32_16x16x32_bf16 v[8:11], a[228:231], a[72:75], v[8:11]
    ds_read_b64_tr_b16 a[226:227], v216 offset:47104
    s_waitcnt lgkmcnt(6)
    v_mfma_f32_16x16x32_bf16 v[16:19], a[232:235], a[72:75], v[16:19]
    ds_read_b64_tr_b16 a[228:229], v216 offset:41984
    s_add_u32 s75, s75, 4096
    v_mfma_f32_16x16x32_bf16 v[20:23], a[232:235], a[76:79], v[20:23]
    ds_read_b64_tr_b16 a[230:231], v216 offset:48128
    v_mfma_f32_16x16x32_bf16 v[28:31], a[236:239], a[76:79], v[28:31]
    ds_read_b64_tr_b16 a[232:233], v217 offset:40960
    v_mfma_f32_16x16x32_bf16 v[24:27], a[236:239], a[72:75], v[24:27]
    ds_read_b64_tr_b16 a[234:235], v217 offset:47104
    v_mfma_f32_16x16x32_bf16 v[0:3], a[240:243], a[80:83], v[0:3]
    ds_read_b64_tr_b16 a[236:237], v217 offset:41984
    buffer_load_dwordx4 v229, s[24:27], s50 offen offset:1024  lds
    v_mfma_f32_16x16x32_bf16 v[4:7], a[240:243], a[84:87], v[4:7]
    ds_read_b64_tr_b16 a[238:239], v217 offset:48128
    buffer_load_dwordx4 a[176:179], v208, s[32:35], s75 offen offset:0 sc1
    v_mfma_f32_16x16x32_bf16 v[12:15], a[244:247], a[84:87], v[12:15]
    s_barrier
    v_add_u32 v216, 0xc000, v216
    ds_read_b64_tr_b16 a[240:241], v216 offset:0
    v_mfma_f32_16x16x32_bf16 v[8:11], a[244:247], a[80:83], v[8:11]
    ds_read_b64_tr_b16 a[242:243], v216 offset:6144
    s_waitcnt lgkmcnt(6)
    v_mfma_f32_16x16x32_bf16 v[16:19], a[216:219], a[80:83], v[16:19]
    ds_read_b64_tr_b16 a[244:245], v216 offset:1024
    buffer_load_dwordx4 a[180:183], v208, s[32:35], s75 offen offset:1024 sc1
    v_mfma_f32_16x16x32_bf16 v[20:23], a[216:219], a[84:87], v[20:23]
    ds_read_b64_tr_b16 a[246:247], v216 offset:7168
    v_mfma_f32_16x16x32_bf16 v[28:31], a[220:223], a[84:87], v[28:31]
    v_add_u32 v217, 0xc000, v217
    ds_read_b64_tr_b16 a[216:217], v217 offset:0
    s_add_u32 m0, s39, 0
    v_mfma_f32_16x16x32_bf16 v[24:27], a[220:223], a[80:83], v[24:27]
    ds_read_b64_tr_b16 a[218:219], v217 offset:6144
    v_mfma_f32_16x16x32_bf16 v[0:3], a[224:227], a[88:91], v[0:3]
    ds_read_b64_tr_b16 a[220:221], v217 offset:1024
    buffer_load_dwordx4 a[184:187], v208, s[32:35], s75 offen offset:2048 sc1
    v_mfma_f32_16x16x32_bf16 v[4:7], a[224:227], a[92:95], v[4:7]
    ds_read_b64_tr_b16 a[222:223], v217 offset:7168
    buffer_load_dwordx4 v228, s[24:27], s51 offen offset:0  lds
    v_mfma_f32_16x16x32_bf16 v[12:15], a[228:231], a[92:95], v[12:15]
    ds_read_b64_tr_b16 a[224:225], v216 offset:12288
    v_mfma_f32_16x16x32_bf16 v[8:11], a[228:231], a[88:91], v[8:11]
    ds_read_b64_tr_b16 a[226:227], v216 offset:18432
    s_waitcnt lgkmcnt(6)
    v_mfma_f32_16x16x32_bf16 v[16:19], a[232:235], a[88:91], v[16:19]
    ds_read_b64_tr_b16 a[228:229], v216 offset:13312
    buffer_load_dwordx4 a[188:191], v208, s[32:35], s75 offen offset:3072 sc1
    v_mfma_f32_16x16x32_bf16 v[20:23], a[232:235], a[92:95], v[20:23]
    ds_read_b64_tr_b16 a[230:231], v216 offset:19456
    v_mfma_f32_16x16x32_bf16 v[28:31], a[236:239], a[92:95], v[28:31]
    ds_read_b64_tr_b16 a[232:233], v217 offset:12288
    v_mfma_f32_16x16x32_bf16 v[24:27], a[236:239], a[88:91], v[24:27]
    ds_read_b64_tr_b16 a[234:235], v217 offset:18432
    v_lshrrev_b32 v252, 2, v209
    v_mfma_f32_16x16x32_bf16 v[0:3], a[240:243], a[96:99], v[0:3]
    ds_read_b64_tr_b16 a[236:237], v217 offset:13312
    v_mfma_f32_16x16x32_bf16 v[4:7], a[240:243], a[100:103], v[4:7]
    ds_read_b64_tr_b16 a[238:239], v217 offset:19456
    buffer_load_dwordx4 v229, s[24:27], s52 offen offset:1024  lds
    v_mfma_f32_16x16x32_bf16 v[12:15], a[244:247], a[100:103], v[12:15]
    ds_read_b64_tr_b16 a[240:241], v216 offset:2048
    v_mul_u32_u24 v252, 256, v252
    v_mfma_f32_16x16x32_bf16 v[8:11], a[244:247], a[96:99], v[8:11]
    ds_read_b64_tr_b16 a[242:243], v216 offset:8192
    v_lshlrev_b32 v207, 3, v209
    s_waitcnt lgkmcnt(6)
    v_mfma_f32_16x16x32_bf16 v[16:19], a[216:219], a[96:99], v[16:19]
    ds_read_b64_tr_b16 a[244:245], v216 offset:3072
    v_mfma_f32_16x16x32_bf16 v[20:23], a[216:219], a[100:103], v[20:23]
    ds_read_b64_tr_b16 a[246:247], v216 offset:9216
    buffer_load_dword v253, v252, s[32:35], s95 offen sc1
    v_mfma_f32_16x16x32_bf16 v[28:31], a[220:223], a[100:103], v[28:31]
    ds_read_b64_tr_b16 a[216:217], v217 offset:2048
    v_mfma_f32_16x16x32_bf16 v[24:27], a[220:223], a[96:99], v[24:27]
    ds_read_b64_tr_b16 a[218:219], v217 offset:8192
    v_mfma_f32_16x16x32_bf16 v[0:3], a[224:227], a[104:107], v[0:3]
    ds_read_b64_tr_b16 a[220:221], v217 offset:3072
    v_mfma_f32_16x16x32_bf16 v[4:7], a[224:227], a[108:111], v[4:7]
    ds_read_b64_tr_b16 a[222:223], v217 offset:9216
    buffer_load_dwordx4 v230, s[24:27], s53 offen offset:2048  lds
    v_mfma_f32_16x16x32_bf16 v[12:15], a[228:231], a[108:111], v[12:15]
    ds_read_b64_tr_b16 a[224:225], v216 offset:14336
    v_mfma_f32_16x16x32_bf16 v[8:11], a[228:231], a[104:107], v[8:11]
    ds_read_b64_tr_b16 a[226:227], v216 offset:20480
    s_waitcnt lgkmcnt(6)
    v_mfma_f32_16x16x32_bf16 v[16:19], a[232:235], a[104:107], v[16:19]
    ds_read_b64_tr_b16 a[228:229], v216 offset:15360
    v_mfma_f32_16x16x32_bf16 v[20:23], a[232:235], a[108:111], v[20:23]
    ds_read_b64_tr_b16 a[230:231], v216 offset:21504
    v_mfma_f32_16x16x32_bf16 v[28:31], a[236:239], a[108:111], v[28:31]
    ds_read_b64_tr_b16 a[232:233], v217 offset:14336
    v_mfma_f32_16x16x32_bf16 v[24:27], a[236:239], a[104:107], v[24:27]
    ds_read_b64_tr_b16 a[234:235], v217 offset:20480
    v_mfma_f32_16x16x32_bf16 v[0:3], a[240:243], a[112:115], v[0:3]
    ds_read_b64_tr_b16 a[236:237], v217 offset:15360
    v_mfma_f32_16x16x32_bf16 v[4:7], a[240:243], a[116:119], v[4:7]
    ds_read_b64_tr_b16 a[238:239], v217 offset:21504
    buffer_load_dwordx4 v231, s[24:27], s54 offen offset:3072  lds
    v_mfma_f32_16x16x32_bf16 v[12:15], a[244:247], a[116:119], v[12:15]
    ds_read_b64_tr_b16 a[240:241], v216 offset:4096
    v_mfma_f32_16x16x32_bf16 v[8:11], a[244:247], a[112:115], v[8:11]
    ds_read_b64_tr_b16 a[242:243], v216 offset:10240
    s_waitcnt lgkmcnt(6)
    v_mfma_f32_16x16x32_bf16 v[16:19], a[216:219], a[112:115], v[16:19]
    ds_read_b64_tr_b16 a[244:245], v216 offset:5120
    v_mfma_f32_16x16x32_bf16 v[20:23], a[216:219], a[116:119], v[20:23]
    ds_read_b64_tr_b16 a[246:247], v216 offset:11264
    s_add_u32 m0, s39, 4096
    v_mfma_f32_16x16x32_bf16 v[28:31], a[220:223], a[116:119], v[28:31]
    ds_read_b64_tr_b16 a[216:217], v217 offset:4096
    v_mfma_f32_16x16x32_bf16 v[24:27], a[220:223], a[112:115], v[24:27]
    ds_read_b64_tr_b16 a[218:219], v217 offset:10240
    v_mfma_f32_16x16x32_bf16 v[0:3], a[224:227], a[120:123], v[0:3]
    ds_read_b64_tr_b16 a[220:221], v217 offset:5120
    buffer_load_dwordx4 v228, s[24:27], s55 offen offset:0  lds
    v_mfma_f32_16x16x32_bf16 v[4:7], a[224:227], a[124:127], v[4:7]
    ds_read_b64_tr_b16 a[222:223], v217 offset:11264
    v_mfma_f32_16x16x32_bf16 v[12:15], a[228:231], a[124:127], v[12:15]
    ds_read_b64_tr_b16 a[224:225], v216 offset:16384
    v_mfma_f32_16x16x32_bf16 v[8:11], a[228:231], a[120:123], v[8:11]
    ds_read_b64_tr_b16 a[226:227], v216 offset:22528
    s_waitcnt lgkmcnt(6)
    v_mfma_f32_16x16x32_bf16 v[16:19], a[232:235], a[120:123], v[16:19]
    ds_read_b64_tr_b16 a[228:229], v216 offset:17408
    v_mfma_f32_16x16x32_bf16 v[20:23], a[232:235], a[124:127], v[20:23]
    ds_read_b64_tr_b16 a[230:231], v216 offset:23552
    v_mfma_f32_16x16x32_bf16 v[28:31], a[236:239], a[124:127], v[28:31]
    ds_read_b64_tr_b16 a[232:233], v217 offset:16384
    v_mfma_f32_16x16x32_bf16 v[24:27], a[236:239], a[120:123], v[24:27]
    ds_read_b64_tr_b16 a[234:235], v217 offset:22528
    v_mfma_f32_16x16x32_bf16 v[0:3], a[240:243], a[128:131], v[0:3]
    ds_read_b64_tr_b16 a[236:237], v217 offset:17408
    buffer_load_dwordx4 v229, s[24:27], s64 offen offset:1024  lds
    v_mfma_f32_16x16x32_bf16 v[4:7], a[240:243], a[132:135], v[4:7]
    ds_read_b64_tr_b16 a[238:239], v217 offset:23552
    v_mfma_f32_16x16x32_bf16 v[12:15], a[244:247], a[132:135], v[12:15]
    s_waitcnt vmcnt(32)
    s_barrier
    v_add_u32 v212, 0xffff4000, v212
    ds_read_b64_tr_b16 a[240:241], v212 offset:24576
    v_mfma_f32_16x16x32_bf16 v[8:11], a[244:247], a[128:131], v[8:11]
    ds_read_b64_tr_b16 a[242:243], v212 offset:36864
    s_waitcnt lgkmcnt(6)
    v_mfma_f32_16x16x32_bf16 v[16:19], a[216:219], a[128:131], v[16:19]
    v_add_u32 v213, 0xffff4000, v213
    ds_read_b64_tr_b16 a[244:245], v213 offset:24576
    v_mfma_f32_16x16x32_bf16 v[20:23], a[216:219], a[132:135], v[20:23]
    ds_read_b64_tr_b16 a[246:247], v213 offset:36864
    v_mfma_f32_16x16x32_bf16 v[28:31], a[220:223], a[132:135], v[28:31]
    v_add_u32 v214, 0xffff4000, v214
    ds_read_b64_tr_b16 a[216:217], v214 offset:24576
    s_add_u32 m0, s39, 24576
    v_mfma_f32_16x16x32_bf16 v[24:27], a[220:223], a[128:131], v[24:27]
    ds_read_b64_tr_b16 a[218:219], v214 offset:36864
    v_mfma_f32_16x16x32_bf16 v[0:3], a[224:227], a[136:139], v[0:3]
    v_add_u32 v215, 0xffff4000, v215
    ds_read_b64_tr_b16 a[220:221], v215 offset:24576
    v_mfma_f32_16x16x32_bf16 v[4:7], a[224:227], a[140:143], v[4:7]
    ds_read_b64_tr_b16 a[222:223], v215 offset:36864
    buffer_load_dwordx4 v228, s[24:27], s56 offen offset:0  lds
    v_mfma_f32_16x16x32_bf16 v[12:15], a[228:231], a[140:143], v[12:15]
    ds_read_b64_tr_b16 a[224:225], v212 offset:25600
    v_mfma_f32_16x16x32_bf16 v[8:11], a[228:231], a[136:139], v[8:11]
    ds_read_b64_tr_b16 a[226:227], v212 offset:37888
    s_waitcnt lgkmcnt(6)
    v_mfma_f32_16x16x32_bf16 v[16:19], a[232:235], a[136:139], v[16:19]
    ds_read_b64_tr_b16 a[228:229], v213 offset:25600
    v_mfma_f32_16x16x32_bf16 v[20:23], a[232:235], a[140:143], v[20:23]
    ds_read_b64_tr_b16 a[230:231], v213 offset:37888
    v_mfma_f32_16x16x32_bf16 v[28:31], a[236:239], a[140:143], v[28:31]
    ds_read_b64_tr_b16 a[232:233], v214 offset:25600
    v_mfma_f32_16x16x32_bf16 v[24:27], a[236:239], a[136:139], v[24:27]
    ds_read_b64_tr_b16 a[234:235], v214 offset:37888
    v_mfma_f32_16x16x32_bf16 v[96:99], a[240:243], v[128:131], 0
    ds_read_b64_tr_b16 a[236:237], v215 offset:25600
    v_mfma_f32_16x16x32_bf16 v[100:103], a[240:243], v[132:135], 0
    ds_read_b64_tr_b16 a[238:239], v215 offset:37888
    buffer_load_dwordx4 v229, s[24:27], s57 offen offset:1024  lds
    v_mfma_f32_16x16x32_bf16 v[108:111], a[244:247], v[132:135], 0
    ds_read_b64_tr_b16 a[240:241], v212 offset:26624
    v_mfma_f32_16x16x32_bf16 v[104:107], a[244:247], v[128:131], 0
    ds_read_b64_tr_b16 a[242:243], v212 offset:38912
    s_waitcnt lgkmcnt(6)
    v_mfma_f32_16x16x32_bf16 v[112:115], a[216:219], v[128:131], 0
    ds_read_b64_tr_b16 a[244:245], v213 offset:26624
    v_mfma_f32_16x16x32_bf16 v[116:119], a[216:219], v[132:135], 0
    ds_read_b64_tr_b16 a[246:247], v213 offset:38912
    v_mfma_f32_16x16x32_bf16 v[124:127], a[220:223], v[132:135], 0
    ds_read_b64_tr_b16 a[216:217], v214 offset:26624
    v_mul_f32 v0, v0, v8
    v_mfma_f32_16x16x32_bf16 v[120:123], a[220:223], v[128:131], 0
    ds_read_b64_tr_b16 a[218:219], v214 offset:38912
    v_mul_f32 v1, v1, v9
    v_mfma_f32_16x16x32_bf16 v[96:99], a[224:227], v[136:139], v[96:99]
    ds_read_b64_tr_b16 a[220:221], v215 offset:26624
    v_mul_f32 v2, v2, v10
    v_mfma_f32_16x16x32_bf16 v[100:103], a[224:227], v[140:143], v[100:103]
    ds_read_b64_tr_b16 a[222:223], v215 offset:38912
    buffer_load_dwordx4 v230, s[24:27], s58 offen offset:2048  lds
    v_mfma_f32_16x16x32_bf16 v[108:111], a[228:231], v[140:143], v[108:111]
    ds_read_b64_tr_b16 a[224:225], v212 offset:27648
    v_mul_f32 v3, v3, v11
    v_mfma_f32_16x16x32_bf16 v[104:107], a[228:231], v[136:139], v[104:107]
    ds_read_b64_tr_b16 a[226:227], v212 offset:39936
    v_cvt_pk_bf16_f32 v192, v0, v1
    s_waitcnt lgkmcnt(6)
    v_mfma_f32_16x16x32_bf16 v[112:115], a[232:235], v[136:139], v[112:115]
    ds_read_b64_tr_b16 a[228:229], v213 offset:27648
    v_cvt_pk_bf16_f32 v193, v2, v3
    v_mfma_f32_16x16x32_bf16 v[116:119], a[232:235], v[140:143], v[116:119]
    ds_read_b64_tr_b16 a[230:231], v213 offset:39936
    v_mul_f32 v4, v4, v12
    v_mfma_f32_16x16x32_bf16 v[124:127], a[236:239], v[140:143], v[124:127]
    ds_read_b64_tr_b16 a[232:233], v214 offset:27648
    v_mul_f32 v5, v5, v13
    v_mfma_f32_16x16x32_bf16 v[120:123], a[236:239], v[136:139], v[120:123]
    ds_read_b64_tr_b16 a[234:235], v214 offset:39936
    v_mul_f32 v6, v6, v14
    v_mfma_f32_16x16x32_bf16 v[96:99], a[240:243], v[144:147], v[96:99]
    ds_read_b64_tr_b16 a[236:237], v215 offset:27648
    v_mul_f32 v7, v7, v15
    v_cvt_pk_bf16_f32 v196, v4, v5
    v_mfma_f32_16x16x32_bf16 v[100:103], a[240:243], v[148:151], v[100:103]
    ds_read_b64_tr_b16 a[238:239], v215 offset:39936
    buffer_load_dwordx4 v231, s[24:27], s59 offen offset:3072  lds
    v_mfma_f32_16x16x32_bf16 v[108:111], a[244:247], v[148:151], v[108:111]
    ds_read_b64_tr_b16 a[240:241], v212 offset:28672
    v_cvt_pk_bf16_f32 v197, v6, v7
    v_mfma_f32_16x16x32_bf16 v[104:107], a[244:247], v[144:147], v[104:107]
    ds_read_b64_tr_b16 a[242:243], v212 offset:40960
    v_mul_f32 v16, v16, v24
    s_waitcnt lgkmcnt(6)
    v_mfma_f32_16x16x32_bf16 v[112:115], a[216:219], v[144:147], v[112:115]
    ds_read_b64_tr_b16 a[244:245], v213 offset:28672
    v_mul_f32 v17, v17, v25
    v_mfma_f32_16x16x32_bf16 v[116:119], a[216:219], v[148:151], v[116:119]
    ds_read_b64_tr_b16 a[246:247], v213 offset:40960
    s_add_u32 m0, s39, 28672
    v_mfma_f32_16x16x32_bf16 v[124:127], a[220:223], v[148:151], v[124:127]
    ds_read_b64_tr_b16 a[216:217], v214 offset:28672
    v_mul_f32 v18, v18, v26
    v_mfma_f32_16x16x32_bf16 v[120:123], a[220:223], v[144:147], v[120:123]
    ds_read_b64_tr_b16 a[218:219], v214 offset:40960
    v_mul_f32 v19, v19, v27
    v_cvt_pk_bf16_f32 v194, v16, v17
    v_mfma_f32_16x16x32_bf16 v[96:99], a[224:227], v[152:155], v[96:99]
    ds_read_b64_tr_b16 a[220:221], v215 offset:28672
    buffer_load_dwordx4 v228, s[24:27], s60 offen offset:0  lds
    v_mfma_f32_16x16x32_bf16 v[100:103], a[224:227], v[156:159], v[100:103]
    ds_read_b64_tr_b16 a[222:223], v215 offset:40960
    v_cvt_pk_bf16_f32 v195, v18, v19
    v_mfma_f32_16x16x32_bf16 v[108:111], a[228:231], v[156:159], v[108:111]
    ds_read_b64_tr_b16 a[224:225], v212 offset:29696
    v_mul_f32 v20, v20, v28
    v_mfma_f32_16x16x32_bf16 v[104:107], a[228:231], v[152:155], v[104:107]
    ds_read_b64_tr_b16 a[226:227], v212 offset:41984
    v_mul_f32 v21, v21, v29
    s_waitcnt lgkmcnt(6)
    v_mfma_f32_16x16x32_bf16 v[112:115], a[232:235], v[152:155], v[112:115]
    ds_read_b64_tr_b16 a[228:229], v213 offset:29696
    v_mul_f32 v22, v22, v30
    v_mfma_f32_16x16x32_bf16 v[116:119], a[232:235], v[156:159], v[116:119]
    ds_read_b64_tr_b16 a[230:231], v213 offset:41984
    v_mul_f32 v23, v23, v31
    v_mfma_f32_16x16x32_bf16 v[124:127], a[236:239], v[156:159], v[124:127]
    ds_read_b64_tr_b16 a[232:233], v214 offset:29696
    v_cvt_pk_bf16_f32 v198, v20, v21
    s_add_u32 s42, s40, 5
    s_waitcnt vmcnt(9)
    v_subrev_u32 v253, s42, v253
    v_cmp_ge_u32 vcc, 10, v253
    s_nop 1
    s_cmp_eq_u64 vcc, exec
    s_cbranch_scc0 L_poll4_slow
L_poll4_ok:
    v_mfma_f32_16x16x32_bf16 v[120:123], a[236:239], v[152:155], v[120:123]
    ds_read_b64_tr_b16 a[234:235], v214 offset:41984
    v_cvt_pk_bf16_f32 v199, v22, v23
    s_add_u32 s74, s46, 16384
    v_mfma_f32_16x16x32_bf16 v[96:99], a[240:243], v[160:163], v[96:99]
    ds_read_b64_tr_b16 a[236:237], v215 offset:29696
    buffer_load_dwordx4 v229, s[24:27], s61 offen offset:1024  lds
    v_mfma_f32_16x16x32_bf16 v[100:103], a[240:243], v[164:167], v[100:103]
    ds_read_b64_tr_b16 a[238:239], v215 offset:41984
    buffer_store_dwordx4 v[192:195], v208, s[32:35], s74 offen offset:0 sc1
    buffer_store_dwordx4 v[196:199], v208, s[32:35], s74 offen offset:1024 sc1
    v_mfma_f32_16x16x32_bf16 v[108:111], a[244:247], v[164:167], v[108:111]
    s_barrier
    v_add_u32 v212, 0xc000, v212
    ds_read_b64_tr_b16 a[240:241], v212 offset:0
    s_xor_b32 s44, s83, 0
    buffer_load_dwordx4 a[0:3], v208, s[32:35], s44 offen sc1
    v_mfma_f32_16x16x32_bf16 v[104:107], a[244:247], v[160:163], v[104:107]
    ds_read_b64_tr_b16 a[242:243], v212 offset:12288
    s_waitcnt lgkmcnt(6)
    v_mfma_f32_16x16x32_bf16 v[112:115], a[216:219], v[160:163], v[112:115]
    v_add_u32 v213, 0xc000, v213
    ds_read_b64_tr_b16 a[244:245], v213 offset:0
    v_mfma_f32_16x16x32_bf16 v[116:119], a[216:219], v[164:167], v[116:119]
    ds_read_b64_tr_b16 a[246:247], v213 offset:12288
    s_add_u32 s44, s84, 32768
    v_mfma_f32_16x16x32_bf16 v[124:127], a[220:223], v[164:167], v[124:127]
    v_add_u32 v214, 0xc000, v214
    ds_read_b64_tr_b16 a[216:217], v214 offset:0
    s_add_u32 m0, s39, 49152
    v_mfma_f32_16x16x32_bf16 v[120:123], a[220:223], v[160:163], v[120:123]
    ds_read_b64_tr_b16 a[218:219], v214 offset:12288
    v_mfma_f32_16x16x32_bf16 v[96:99], a[224:227], v[168:171], v[96:99]
    v_add_u32 v215, 0xc000, v215
    ds_read_b64_tr_b16 a[220:221], v215 offset:0
    v_mfma_f32_16x16x32_bf16 v[100:103], a[224:227], v[172:175], v[100:103]
    ds_read_b64_tr_b16 a[222:223], v215 offset:12288
    buffer_load_dwordx4 v228, s[24:27], s62 offen offset:0  lds
    v_mfma_f32_16x16x32_bf16 v[108:111], a[228:231], v[172:175], v[108:111]
    ds_read_b64_tr_b16 a[224:225], v212 offset:1024
    buffer_load_dwordx2 a[64:65], v207, s[32:35], s44 offen offset:0 sc1
    v_mfma_f32_16x16x32_bf16 v[104:107], a[228:231], v[168:171], v[104:107]
    ds_read_b64_tr_b16 a[226:227], v212 offset:13312
    s_waitcnt lgkmcnt(6)
    v_mfma_f32_16x16x32_bf16 v[112:115], a[232:235], v[168:171], v[112:115]
    ds_read_b64_tr_b16 a[228:229], v213 offset:1024
    buffer_load_dwordx2 a[66:67], v207, s[32:35], s44 offen offset:512 sc1
    v_mfma_f32_16x16x32_bf16 v[116:119], a[232:235], v[172:175], v[116:119]
    ds_read_b64_tr_b16 a[230:231], v213 offset:13312
    v_mfma_f32_16x16x32_bf16 v[124:127], a[236:239], v[172:175], v[124:127]
    ds_read_b64_tr_b16 a[232:233], v214 offset:1024
    v_mfma_f32_16x16x32_bf16 v[120:123], a[236:239], v[168:171], v[120:123]
    ds_read_b64_tr_b16 a[234:235], v214 offset:13312
    v_mfma_f32_16x16x32_bf16 v[96:99], a[240:243], v[176:179], v[96:99]
    ds_read_b64_tr_b16 a[236:237], v215 offset:1024
    s_add_u32 s44, s84, 34816
    v_mfma_f32_16x16x32_bf16 v[100:103], a[240:243], v[180:183], v[100:103]
    ds_read_b64_tr_b16 a[238:239], v215 offset:13312
    buffer_load_dwordx4 v229, s[24:27], s63 offen offset:1024  lds
    s_add_u32 s92, s92, 12288
    s_addc_u32 s93, s93, 0
    v_mov_b32 v254, s91
    global_load_dword a215, v254, s[92:93]
    v_mfma_f32_16x16x32_bf16 v[108:111], a[244:247], v[180:183], v[108:111]
    ds_read_b64_tr_b16 a[240:241], v212 offset:2048
    v_mfma_f32_16x16x32_bf16 v[104:107], a[244:247], v[176:179], v[104:107]
    ds_read_b64_tr_b16 a[242:243], v212 offset:14336
    buffer_load_dwordx2 a[68:69], v207, s[32:35], s44 offen offset:0 sc1
    s_waitcnt lgkmcnt(6)
    v_mfma_f32_16x16x32_bf16 v[112:115], a[216:219], v[176:179], v[112:115]
    ds_read_b64_tr_b16 a[244:245], v213 offset:2048
    v_mfma_f32_16x16x32_bf16 v[116:119], a[216:219], v[180:183], v[116:119]
    ds_read_b64_tr_b16 a[246:247], v213 offset:14336
    v_mfma_f32_16x16x32_bf16 v[124:127], a[220:223], v[180:183], v[124:127]
    ds_read_b64_tr_b16 a[216:217], v214 offset:2048
    buffer_load_dwordx2 a[70:71], v207, s[32:35], s44 offen offset:512 sc1
    v_mfma_f32_16x16x32_bf16 v[120:123], a[220:223], v[176:179], v[120:123]
    ds_read_b64_tr_b16 a[218:219], v214 offset:14336
    v_mfma_f32_16x16x32_bf16 v[96:99], a[224:227], v[184:187], v[96:99]
    ds_read_b64_tr_b16 a[220:221], v215 offset:2048
    v_mfma_f32_16x16x32_bf16 v[100:103], a[224:227], v[188:191], v[100:103]
    ds_read_b64_tr_b16 a[222:223], v215 offset:14336
    buffer_load_dwordx4 v230, s[24:27], s65 offen offset:2048  lds
    v_mfma_f32_16x16x32_bf16 v[108:111], a[228:231], v[188:191], v[108:111]
    ds_read_b64_tr_b16 a[224:225], v212 offset:3072
    v_and_b32 v251, 15, v209
    v_mfma_f32_16x16x32_bf16 v[104:107], a[228:231], v[184:187], v[104:107]
    ds_read_b64_tr_b16 a[226:227], v212 offset:15360
    s_waitcnt lgkmcnt(6)
    v_mfma_f32_16x16x32_bf16 v[112:115], a[232:235], v[184:187], v[112:115]
    ds_read_b64_tr_b16 a[228:229], v213 offset:3072
    v_mfma_f32_16x16x32_bf16 v[116:119], a[232:235], v[188:191], v[116:119]
    ds_read_b64_tr_b16 a[230:231], v213 offset:15360
    s_and_b32 s42, s36, 1
    s_mul_i32 s42, s42, 960
    s_sub_u32 s44, s84, s42
    s_add_u32 s44, s44, 36864
    v_lshlrev_b32 v251, 2, v251
    v_mfma_f32_16x16x32_bf16 v[124:127], a[236:239], v[188:191], v[124:127]
    ds_read_b64_tr_b16 a[232:233], v214 offset:3072
    v_mfma_f32_16x16x32_bf16 v[120:123], a[236:239], v[184:187], v[120:123]
    ds_read_b64_tr_b16 a[234:235], v214 offset:15360
    v_mfma_f32_16x16x32_bf16 v[96:99], a[240:243], v[192:195], v[96:99]
    ds_read_b64_tr_b16 a[236:237], v215 offset:3072
    v_mfma_f32_16x16x32_bf16 v[100:103], a[240:243], v[196:199], v[100:103]
    ds_read_b64_tr_b16 a[238:239], v215 offset:15360
    buffer_load_dwordx4 v227, s[24:27], s62 offen offset:3072  lds
    v_mfma_f32_16x16x32_bf16 v[108:111], a[244:247], v[196:199], v[108:111]
    ds_read_b64_tr_b16 a[240:241], v212 offset:4096
    buffer_load_dword v210, v251, s[32:35], s44 offen sc1
    v_mfma_f32_16x16x32_bf16 v[104:107], a[244:247], v[192:195], v[104:107]
    ds_read_b64_tr_b16 a[242:243], v212 offset:16384
    s_waitcnt lgkmcnt(6)
    v_mfma_f32_16x16x32_bf16 v[112:115], a[216:219], v[192:195], v[112:115]
    ds_read_b64_tr_b16 a[244:245], v213 offset:4096
    v_accvgpr_read_b32 v200, a192
    v_mfma_f32_16x16x32_bf16 v[116:119], a[216:219], v[196:199], v[116:119]
    ds_read_b64_tr_b16 a[246:247], v213 offset:16384
    s_add_u32 m0, s39, 53248
    v_mfma_f32_16x16x32_bf16 v[124:127], a[220:223], v[196:199], v[124:127]
    ds_read_b64_tr_b16 a[216:217], v214 offset:4096
    v_accvgpr_read_b32 v201, a193
    v_mfma_f32_16x16x32_bf16 v[120:123], a[220:223], v[192:195], v[120:123]
    ds_read_b64_tr_b16 a[218:219], v214 offset:16384
    v_mfma_f32_16x16x32_bf16 v[96:99], a[224:227], a[144:147], v[96:99]
    ds_read_b64_tr_b16 a[220:221], v215 offset:4096
    buffer_load_dwordx4 v224, s[24:27], s63 offen offset:0  lds
    v_accvgpr_read_b32 v202, a194
    v_mfma_f32_16x16x32_bf16 v[100:103], a[224:227], a[148:151], v[100:103]
    ds_read_b64_tr_b16 a[222:223], v215 offset:16384
    s_xor_b32 s44, s83, 2048
    buffer_load_dwordx4 a[4:7], v208, s[32:35], s44 offen sc1
    v_mfma_f32_16x16x32_bf16 v[108:111], a[228:231], a[148:151], v[108:111]
    ds_read_b64_tr_b16 a[224:225], v212 offset:5120
    v_accvgpr_read_b32 v203, a195
    v_mfma_f32_16x16x32_bf16 v[104:107], a[228:231], a[144:147], v[104:107]
    ds_read_b64_tr_b16 a[226:227], v212 offset:17408
    s_waitcnt lgkmcnt(6)
    v_mfma_f32_16x16x32_bf16 v[112:115], a[232:235], a[144:147], v[112:115]
    ds_read_b64_tr_b16 a[228:229], v213 offset:5120
    v_accvgpr_read_b32 v204, a196
    v_mfma_f32_16x16x32_bf16 v[116:119], a[232:235], a[148:151], v[116:119]
    ds_read_b64_tr_b16 a[230:231], v213 offset:17408
    v_mfma_f32_16x16x32_bf16 v[124:127], a[236:239], a[148:151], v[124:127]
    ds_read_b64_tr_b16 a[232:233], v214 offset:5120
    v_mfma_f32_16x16x32_bf16 v[120:123], a[236:239], a[144:147], v[120:123]
    ds_read_b64_tr_b16 a[234:235], v214 offset:17408
    v_accvgpr_read_b32 v205, a197
    v_mfma_f32_16x16x32_bf16 v[96:99], a[240:243], a[152:155], v[96:99]
    ds_read_b64_tr_b16 a[236:237], v215 offset:5120
    buffer_load_dwordx4 v225, s[24:27], s65 offen offset:1024  lds
    v_mfma_f32_16x16x32_bf16 v[100:103], a[240:243], a[156:159], v[100:103]
    ds_read_b64_tr_b16 a[238:239], v215 offset:17408
    v_accvgpr_read_b32 v206, a198
    v_mfma_f32_16x16x32_bf16 v[108:111], a[244:247], a[156:159], v[108:111]
    s_waitcnt vmcnt(14)
    s_barrier
    ds_read_b64_tr_b16 a[240:241], v212 offset:24576
    s_add_u32 s42, s40, 6
    v_mov_b32 v254, s42
    buffer_store_dword v254, v255, s[32:35], s47 offen sc1
    v_mfma_f32_16x16x32_bf16 v[104:107], a[244:247], a[152:155], v[104:107]
    ds_read_b64_tr_b16 a[242:243], v212 offset:36864
    s_add_u32 m0, s39, 73728
    v_accvgpr_read_b32 v248, a199
    s_waitcnt lgkmcnt(6)
    v_mfma_f32_16x16x32_bf16 v[112:115], a[216:219], a[152:155], v[112:115]
    ds_read_b64_tr_b16 a[244:245], v213 offset:24576
    s_add_u32 s70, s71, 2
    s_and_b32 s70, s70, 3
    s_lshl_b32 s70, s70, 7
    s_add_u32 s70, s70, s72
    v_mfma_f32_16x16x32_bf16 v[116:119], a[216:219], a[156:159], v[116:119]
    ds_read_b64_tr_b16 a[246:247], v213 offset:36864
    v_accvgpr_read_b32 v224, a249
    s_xor_b32 s44, s83, 4096
    buffer_load_dwordx4 a[8:11], v208, s[32:35], s44 offen sc1
    v_mfma_f32_16x16x32_bf16 v[124:127], a[220:223], a[156:159], v[124:127]
    ds_read_b64_tr_b16 a[216:217], v214 offset:24576
    v_add_u32 v224, s70, v224
    v_accvgpr_read_b32 v249, a200
    v_mfma_f32_16x16x32_bf16 v[120:123], a[220:223], a[152:155], v[120:123]
    ds_read_b64_tr_b16 a[218:219], v214 offset:36864
    v_subrev_u32 v225, 1024, v224
    v_lshrrev_b32 v250, 3, v209
    v_accvgpr_read_b32 v254, a251
    s_lshl_b32 s42, s36, 1
    s_add_u32 s42, s42, 0
    s_lshl_b32 s43, s42, 9
    s_add_u32 m0, s43, 147456
    s_xor_b32 s42, s42, s78
    s_mul_i32 s42, s42, 41472
    buffer_load_dwordx4 v254, s[12:15], s42 offen lds
    s_add_u32 m0, s39, 73728
    v_mfma_f32_16x16x32_bf16 v[96:99], a[224:227], a[160:163], v[96:99]
    ds_read_b64_tr_b16 a[220:221], v215 offset:24576
    v_subrev_u32 v226, 2048, v224
    v_subrev_u32 v227, 3072, v224
    v_mfma_f32_16x16x32_bf16 v[100:103], a[224:227], a[164:167], v[100:103]
    ds_read_b64_tr_b16 a[222:223], v215 offset:36864
    buffer_load_dwordx4 v224, s[24:27], s48 offen offset:0  lds
    v_mfma_f32_16x16x32_bf16 v[108:111], a[228:231], a[164:167], v[108:111]
    ds_read_b64_tr_b16 a[224:225], v212 offset:25600
    v_mul_u32_u24 v250, 512, v250
    v_mfma_f32_16x16x32_bf16 v[104:107], a[228:231], a[160:163], v[104:107]
    ds_read_b64_tr_b16 a[226:227], v212 offset:37888
    s_waitcnt lgkmcnt(6)
    v_mfma_f32_16x16x32_bf16 v[112:115], a[232:235], a[160:163], v[112:115]
    ds_read_b64_tr_b16 a[228:229], v213 offset:25600
    v_mfma_f32_16x16x32_bf16 v[116:119], a[232:235], a[164:167], v[116:119]
    ds_read_b64_tr_b16 a[230:231], v213 offset:37888
    v_mfma_f32_16x16x32_bf16 v[124:127], a[236:239], a[164:167], v[124:127]
    ds_read_b64_tr_b16 a[232:233], v214 offset:25600
    v_mfma_f32_16x16x32_bf16 v[120:123], a[236:239], a[160:163], v[120:123]
    ds_read_b64_tr_b16 a[234:235], v214 offset:37888
    v_mfma_f32_16x16x32_bf16 v[96:99], a[240:243], a[168:171], v[96:99]
    ds_read_b64_tr_b16 a[236:237], v215 offset:25600
    s_xor_b32 s44, s83, 6144
    buffer_load_dwordx4 a[12:15], v208, s[32:35], s44 offen sc1
    v_mfma_f32_16x16x32_bf16 v[100:103], a[240:243], a[172:175], v[100:103]
    ds_read_b64_tr_b16 a[238:239], v215 offset:37888
    buffer_load_dwordx4 v225, s[24:27], s49 offen offset:1024  lds
    v_mfma_f32_16x16x32_bf16 v[108:111], a[244:247], a[172:175], v[108:111]
    ds_read_b64_tr_b16 a[240:241], v212 offset:26624
    v_mfma_f32_16x16x32_bf16 v[104:107], a[244:247], a[168:171], v[104:107]
    ds_read_b64_tr_b16 a[242:243], v212 offset:38912
    s_waitcnt lgkmcnt(6)
    v_mfma_f32_16x16x32_bf16 v[112:115], a[216:219], a[168:171], v[112:115]
    ds_read_b64_tr_b16 a[244:245], v213 offset:26624
    v_mfma_f32_16x16x32_bf16 v[116:119], a[216:219], a[172:175], v[116:119]
    ds_read_b64_tr_b16 a[246:247], v213 offset:38912
    v_mfma_f32_16x16x32_bf16 v[124:127], a[220:223], a[172:175], v[124:127]
    ds_read_b64_tr_b16 a[216:217], v214 offset:26624
    v_mfma_f32_16x16x32_bf16 v[120:123], a[220:223], a[168:171], v[120:123]
    ds_read_b64_tr_b16 a[218:219], v214 offset:38912
    v_mfma_f32_16x16x32_bf16 v[96:99], a[224:227], a[176:179], v[96:99]
    ds_read_b64_tr_b16 a[220:221], v215 offset:26624
    v_mfma_f32_16x16x32_bf16 v[100:103], a[224:227], a[180:183], v[100:103]
    ds_read_b64_tr_b16 a[222:223], v215 offset:38912
    buffer_load_dwordx4 v226, s[24:27], s50 offen offset:2048  lds
    v_mfma_f32_16x16x32_bf16 v[108:111], a[228:231], a[180:183], v[108:111]
    ds_read_b64_tr_b16 a[224:225], v212 offset:27648
    v_mfma_f32_16x16x32_bf16 v[104:107], a[228:231], a[176:179], v[104:107]
    ds_read_b64_tr_b16 a[226:227], v212 offset:39936
    s_waitcnt lgkmcnt(6)
    v_mfma_f32_16x16x32_bf16 v[112:115], a[232:235], a[176:179], v[112:115]
    ds_read_b64_tr_b16 a[228:229], v213 offset:27648
    s_xor_b32 s44, s83, 8192
    buffer_load_dwordx4 a[16:19], v208, s[32:35], s44 offen sc1
    v_mfma_f32_16x16x32_bf16 v[116:119], a[232:235], a[180:183], v[116:119]
    ds_read_b64_tr_b16 a[230:231], v213 offset:39936
    v_mfma_f32_16x16x32_bf16 v[124:127], a[236:239], a[180:183], v[124:127]
    ds_read_b64_tr_b16 a[232:233], v214 offset:27648
    v_mfma_f32_16x16x32_bf16 v[120:123], a[236:239], a[176:179], v[120:123]
    ds_read_b64_tr_b16 a[234:235], v214 offset:39936
    v_mfma_f32_16x16x32_bf16 v[96:99], a[240:243], a[184:187], v[96:99]
    ds_read_b64_tr_b16 a[236:237], v215 offset:27648
    v_mfma_f32_16x16x32_bf16 v[100:103], a[240:243], a[188:191], v[100:103]
    ds_read_b64_tr_b16 a[238:239], v215 offset:39936
    buffer_load_dwordx4 v227, s[24:27], s51 offen offset:3072  lds
    v_mfma_f32_16x16x32_bf16 v[108:111], a[244:247], a[188:191], v[108:111]
    ds_read_b64_tr_b16 a[240:241], v212 offset:28672
    v_mfma_f32_16x16x32_bf16 v[104:107], a[244:247], a[184:187], v[104:107]
    ds_read_b64_tr_b16 a[242:243], v212 offset:40960
    v_mov_b32 v252, 0
    s_waitcnt lgkmcnt(6)
    v_mfma_f32_16x16x32_bf16 v[112:115], a[216:219], a[184:187], v[112:115]
    ds_read_b64_tr_b16 a[244:245], v213 offset:28672
    s_xor_b32 s77, s47, 256
    v_mfma_f32_16x16x32_bf16 v[116:119], a[216:219], a[188:191], v[116:119]
    ds_read_b64_tr_b16 a[246:247], v213 offset:40960
    s_add_u32 m0, s39, 77824
    buffer_load_dword v253, v252, s[32:35], s77 offen sc1
    v_mfma_f32_16x16x32_bf16 v[124:127], a[220:223], a[188:191], v[124:127]
    ds_read_b64_tr_b16 a[216:217], v214 offset:28672
    v_mfma_f32_16x16x32_bf16 v[120:123], a[220:223], a[184:187], v[120:123]
    ds_read_b64_tr_b16 a[218:219], v214 offset:40960
    s_xor_b32 s44, s83, 10240
    buffer_load_dwordx4 a[20:23], v208, s[32:35], s44 offen sc1
    v_mfma_f32_16x16x32_bf16 v[64:67], a[224:227], v[128:131], 0
    ds_read_b64_tr_b16 a[220:221], v215 offset:28672
    buffer_load_dwordx4 v224, s[24:27], s52 offen offset:0  lds
    v_mfma_f32_16x16x32_bf16 v[68:71], a[224:227], v[132:135], 0
    ds_read_b64_tr_b16 a[222:223], v215 offset:40960
    v_mfma_f32_16x16x32_bf16 v[76:79], a[228:231], v[132:135], 0
    ds_read_b64_tr_b16 a[224:225], v212 offset:29696
    v_mfma_f32_16x16x32_bf16 v[72:75], a[228:231], v[128:131], 0
    ds_read_b64_tr_b16 a[226:227], v212 offset:41984
    s_waitcnt lgkmcnt(6)
    v_mfma_f32_16x16x32_bf16 v[80:83], a[232:235], v[128:131], 0
    ds_read_b64_tr_b16 a[228:229], v213 offset:29696
    v_mfma_f32_16x16x32_bf16 v[84:87], a[232:235], v[132:135], 0
    ds_read_b64_tr_b16 a[230:231], v213 offset:41984
    v_mfma_f32_16x16x32_bf16 v[92:95], a[236:239], v[132:135], 0
    ds_read_b64_tr_b16 a[232:233], v214 offset:29696
    v_mfma_f32_16x16x32_bf16 v[88:91], a[236:239], v[128:131], 0
    ds_read_b64_tr_b16 a[234:235], v214 offset:41984
    v_mfma_f32_16x16x32_bf16 v[64:67], a[240:243], v[136:139], v[64:67]
    ds_read_b64_tr_b16 a[236:237], v215 offset:29696
    buffer_load_dwordx4 v225, s[24:27], s53 offen offset:1024  lds
    v_mfma_f32_16x16x32_bf16 v[68:71], a[240:243], v[140:143], v[68:71]
    ds_read_b64_tr_b16 a[238:239], v215 offset:41984
    v_mfma_f32_16x16x32_bf16 v[76:79], a[244:247], v[140:143], v[76:79]
    s_barrier
    v_add_u32 v212, 0xfffe8000, v212
    ds_read_b64_tr_b16 a[240:241], v212 offset:0
    v_mfma_f32_16x16x32_bf16 v[72:75], a[244:247], v[136:139], v[72:75]
    ds_read_b64_tr_b16 a[242:243], v212 offset:12288
    s_xor_b32 s44, s83, 12288
    buffer_load_dwordx4 a[24:27], v208, s[32:35], s44 offen sc1
    s_waitcnt lgkmcnt(6)
    v_mfma_f32_16x16x32_bf16 v[80:83], a[216:219], v[136:139], v[80:83]
    v_add_u32 v213, 0xfffe8000, v213
    ds_read_b64_tr_b16 a[244:245], v213 offset:0
    v_mfma_f32_16x16x32_bf16 v[84:87], a[216:219], v[140:143], v[84:87]
    ds_read_b64_tr_b16 a[246:247], v213 offset:12288
    v_mfma_f32_16x16x32_bf16 v[92:95], a[220:223], v[140:143], v[92:95]
    v_add_u32 v214, 0xfffe8000, v214
    ds_read_b64_tr_b16 a[216:217], v214 offset:0
    s_add_u32 m0, s39, 98304
    v_mfma_f32_16x16x32_bf16 v[88:91], a[220:223], v[136:139], v[88:91]
    ds_read_b64_tr_b16 a[218:219], v214 offset:12288
    v_mfma_f32_16x16x32_bf16 v[64:67], a[224:227], v[144:147], v[64:67]
    v_add_u32 v215, 0xfffe8000, v215
    ds_read_b64_tr_b16 a[220:221], v215 offset:0
    v_mfma_f32_16x16x32_bf16 v[68:71], a[224:227], v[148:151], v[68:71]
    ds_read_b64_tr_b16 a[222:223], v215 offset:12288
    buffer_load_dwordx4 v224, s[24:27], s54 offen offset:0  lds
    v_mfma_f32_16x16x32_bf16 v[76:79], a[228:231], v[148:151], v[76:79]
    ds_read_b64_tr_b16 a[224:225], v212 offset:1024
    v_mfma_f32_16x16x32_bf16 v[72:75], a[228:231], v[144:147], v[72:75]
    ds_read_b64_tr_b16 a[226:227], v212 offset:13312
    s_waitcnt lgkmcnt(6)
    v_mfma_f32_16x16x32_bf16 v[80:83], a[232:235], v[144:147], v[80:83]
    ds_read_b64_tr_b16 a[228:229], v213 offset:1024
    v_mfma_f32_16x16x32_bf16 v[84:87], a[232:235], v[148:151], v[84:87]
    ds_read_b64_tr_b16 a[230:231], v213 offset:13312
    v_mfma_f32_16x16x32_bf16 v[92:95], a[236:239], v[148:151], v[92:95]
    ds_read_b64_tr_b16 a[232:233], v214 offset:1024
    v_mfma_f32_16x16x32_bf16 v[88:91], a[236:239], v[144:147], v[88:91]
    ds_read_b64_tr_b16 a[234:235], v214 offset:13312
    s_xor_b32 s44, s83, 14336
    buffer_load_dwordx4 a[28:31], v208, s[32:35], s44 offen sc1
    v_mfma_f32_16x16x32_bf16 v[64:67], a[240:243], v[152:155], v[64:67]
    ds_read_b64_tr_b16 a[236:237], v215 offset:1024
    v_mfma_f32_16x16x32_bf16 v[68:71], a[240:243], v[156:159], v[68:71]
    ds_read_b64_tr_b16 a[238:239], v215 offset:13312
    buffer_load_dwordx4 v225, s[24:27], s55 offen offset:1024  lds
    v_mfma_f32_16x16x32_bf16 v[76:79], a[244:247], v[156:159], v[76:79]
    ds_read_b64_tr_b16 a[240:241], v212 offset:2048
    v_mfma_f32_16x16x32_bf16 v[72:75], a[244:247], v[152:155], v[72:75]
    ds_read_b64_tr_b16 a[242:243], v212 offset:14336
    s_waitcnt lgkmcnt(6)
    v_mfma_f32_16x16x32_bf16 v[80:83], a[216:219], v[152:155], v[80:83]
    ds_read_b64_tr_b16 a[244:245], v213 offset:2048
    v_mfma_f32_16x16x32_bf16 v[84:87], a[216:219], v[156:159], v[84:87]
    ds_read_b64_tr_b16 a[246:247], v213 offset:14336
    v_mfma_f32_16x16x32_bf16 v[92:95], a[220:223], v[156:159], v[92:95]
    ds_read_b64_tr_b16 a[216:217], v214 offset:2048
    v_mfma_f32_16x16x32_bf16 v[88:91], a[220:223], v[152:155], v[88:91]
    ds_read_b64_tr_b16 a[218:219], v214 offset:14336
    v_mfma_f32_16x16x32_bf16 v[64:67], a[224:227], v[160:163], v[64:67]
    ds_read_b64_tr_b16 a[220:221], v215 offset:2048
    s_add_u32 s42, s40, 6
    s_waitcnt vmcnt(7)
    v_subrev_u32 v253, s42, v253
    v_cmp_ge_u32 vcc, 9, v253
    s_nop 1
    s_cmp_eq_u64 vcc, exec
    s_cbranch_scc0 L_poll5_slow
L_poll5_ok:
    v_mfma_f32_16x16x32_bf16 v[68:71], a[224:227], v[164:167], v[68:71]
    ds_read_b64_tr_b16 a[222:223], v215 offset:14336
    buffer_load_dwordx4 v226, s[24:27], s64 offen offset:2048  lds
    v_mfma_f32_16x16x32_bf16 v[76:79], a[228:231], v[164:167], v[76:79]
    ds_read_b64_tr_b16 a[224:225], v212 offset:3072
    v_mfma_f32_16x16x32_bf16 v[72:75], a[228:231], v[160:163], v[72:75]
    ds_read_b64_tr_b16 a[226:227], v212 offset:15360
    s_waitcnt lgkmcnt(6)
    v_mfma_f32_16x16x32_bf16 v[80:83], a[232:235], v[160:163], v[80:83]
    ds_read_b64_tr_b16 a[228:229], v213 offset:3072
    s_add_u32 s75, s75, 4096
    v_mfma_f32_16x16x32_bf16 v[84:87], a[232:235], v[164:167], v[84:87]
    ds_read_b64_tr_b16 a[230:231], v213 offset:15360
    v_mfma_f32_16x16x32_bf16 v[92:95], a[236:239], v[164:167], v[92:95]
    ds_read_b64_tr_b16 a[232:233], v214 offset:3072
    v_mfma_f32_16x16x32_bf16 v[88:91], a[236:239], v[160:163], v[88:91]
    ds_read_b64_tr_b16 a[234:235], v214 offset:15360
    buffer_load_dwordx4 a[192:195], v208, s[32:35], s75 offen offset:0 sc1
    v_mfma_f32_16x16x32_bf16 v[64:67], a[240:243], v[168:171], v[64:67]
    ds_read_b64_tr_b16 a[236:237], v215 offset:3072
    v_mfma_f32_16x16x32_bf16 v[68:71], a[240:243], v[172:175], v[68:71]
    ds_read_b64_tr_b16 a[238:239], v215 offset:15360
    buffer_load_dwordx4 v227, s[24:27], s56 offen offset:3072  lds
    v_mfma_f32_16x16x32_bf16 v[76:79], a[244:247], v[172:175], v[76:79]
    ds_read_b64_tr_b16 a[240:241], v212 offset:4096
    v_mfma_f32_16x16x32_bf16 v[72:75], a[244:247], v[168:171], v[72:75]
    ds_read_b64_tr_b16 a[242:243], v212 offset:16384
    buffer_load_dwordx4 a[196:199], v208, s[32:35], s75 offen offset:1024 sc1
    s_waitcnt lgkmcnt(6)
    v_mfma_f32_16x16x32_bf16 v[80:83], a[216:219], v[168:171], v[80:83]
    ds_read_b64_tr_b16 a[244:245], v213 offset:4096
    v_mfma_f32_16x16x32_bf16 v[84:87], a[216:219], v[172:175], v[84:87]
    ds_read_b64_tr_b16 a[246:247], v213 offset:16384
    s_add_u32 m0, s39, 102400
    v_mfma_f32_16x16x32_bf16 v[92:95], a[220:223], v[172:175], v[92:95]
    ds_read_b64_tr_b16 a[216:217], v214 offset:4096
    buffer_load_dwordx4 a[200:203], v208, s[32:35], s75 offen offset:2048 sc1
    v_mfma_f32_16x16x32_bf16 v[88:91], a[220:223], v[168:171], v[88:91]
    ds_read_b64_tr_b16 a[218:219], v214 offset:16384
    v_mfma_f32_16x16x32_bf16 v[64:67], a[224:227], v[176:179], v[64:67]
    ds_read_b64_tr_b16 a[220:221], v215 offset:4096
    buffer_load_dwordx4 v224, s[24:27], s57 offen offset:0  lds
    v_mfma_f32_16x16x32_bf16 v[68:71], a[224:227], v[180:183], v[68:71]
    ds_read_b64_tr_b16 a[222:223], v215 offset:16384
    buffer_load_dwordx4 a[204:207], v208, s[32:35], s75 offen offset:3072 sc1
    v_mfma_f32_16x16x32_bf16 v[76:79], a[228:231], v[180:183], v[76:79]
    ds_read_b64_tr_b16 a[224:225], v212 offset:5120
    v_mfma_f32_16x16x32_bf16 v[72:75], a[228:231], v[176:179], v[72:75]
    ds_read_b64_tr_b16 a[226:227], v212 offset:17408
    s_waitcnt lgkmcnt(6)
    v_mfma_f32_16x16x32_bf16 v[80:83], a[232:235], v[176:179], v[80:83]
    ds_read_b64_tr_b16 a[228:229], v213 offset:5120
    v_mfma_f32_16x16x32_bf16 v[84:87], a[232:235], v[180:183], v[84:87]
    ds_read_b64_tr_b16 a[230:231], v213 offset:17408
    s_add_u32 s75, s75, 4096
    v_mfma_f32_16x16x32_bf16 v[92:95], a[236:239], v[180:183], v[92:95]
    ds_read_b64_tr_b16 a[232:233], v214 offset:5120
    v_mfma_f32_16x16x32_bf16 v[88:91], a[236:239], v[176:179], v[88:91]
    ds_read_b64_tr_b16 a[234:235], v214 offset:17408
    v_mfma_f32_16x16x32_bf16 v[64:67], a[240:243], v[184:187], v[64:67]
    ds_read_b64_tr_b16 a[236:237], v215 offset:5120
    buffer_load_dwordx4 v225, s[24:27], s58 offen offset:1024  lds
    v_mfma_f32_16x16x32_bf16 v[68:71], a[240:243], v[188:191], v[68:71]
    ds_read_b64_tr_b16 a[238:239], v215 offset:17408
    buffer_load_dwordx4 a[208:211], v208, s[32:35], s75 offen offset:0 sc1
    v_mfma_f32_16x16x32_bf16 v[76:79], a[244:247], v[188:191], v[76:79]
    s_barrier
    ds_read_b64_tr_b16 a[240:241], v212 offset:24576
    v_mfma_f32_16x16x32_bf16 v[72:75], a[244:247], v[184:187], v[72:75]
    ds_read_b64_tr_b16 a[242:243], v212 offset:36864
    s_waitcnt lgkmcnt(6)
    v_mfma_f32_16x16x32_bf16 v[80:83], a[216:219], v[184:187], v[80:83]
    ds_read_b64_tr_b16 a[244:245], v213 offset:24576
    buffer_load_dwordx4 a[212:215], v208, s[32:35], s75 offen offset:1024 sc1
    v_mfma_f32_16x16x32_bf16 v[84:87], a[216:219], v[188:191], v[84:87]
    ds_read_b64_tr_b16 a[246:247], v213 offset:36864
    v_mfma_f32_16x16x32_bf16 v[92:95], a[220:223], v[188:191], v[92:95]
    ds_read_b64_tr_b16 a[216:217], v214 offset:24576
    s_add_u32 m0, s39, 122880
    v_mfma_f32_16x16x32_bf16 v[88:91], a[220:223], v[184:187], v[88:91]
    ds_read_b64_tr_b16 a[218:219], v214 offset:36864
    v_mfma_f32_16x16x32_bf16 v[64:67], a[224:227], v[192:195], v[64:67]
    ds_read_b64_tr_b16 a[220:221], v215 offset:24576
    v_mfma_f32_16x16x32_bf16 v[68:71], a[224:227], v[196:199], v[68:71]
    ds_read_b64_tr_b16 a[222:223], v215 offset:36864
    buffer_load_dwordx4 v224, s[24:27], s59 offen offset:0  lds
    v_mfma_f32_16x16x32_bf16 v[76:79], a[228:231], v[196:199], v[76:79]
    ds_read_b64_tr_b16 a[224:225], v212 offset:25600
    v_mfma_f32_16x16x32_bf16 v[72:75], a[228:231], v[192:195], v[72:75]
    ds_read_b64_tr_b16 a[226:227], v212 offset:37888
    s_waitcnt lgkmcnt(6)
    v_mfma_f32_16x16x32_bf16 v[80:83], a[232:235], v[192:195], v[80:83]
    ds_read_b64_tr_b16 a[228:229], v213 offset:25600
    v_mfma_f32_16x16x32_bf16 v[84:87], a[232:235], v[196:199], v[84:87]
    ds_read_b64_tr_b16 a[230:231], v213 offset:37888
    v_mfma_f32_16x16x32_bf16 v[92:95], a[236:239], v[196:199], v[92:95]
    ds_read_b64_tr_b16 a[232:233], v214 offset:25600
    v_mfma_f32_16x16x32_bf16 v[88:91], a[236:239], v[192:195], v[88:91]
    ds_read_b64_tr_b16 a[234:235], v214 offset:37888
    v_mfma_f32_16x16x32_bf16 v[64:67], a[240:243], a[144:147], v[64:67]
    ds_read_b64_tr_b16 a[236:237], v215 offset:25600
    v_mfma_f32_16x16x32_bf16 v[68:71], a[240:243], a[148:151], v[68:71]
    ds_read_b64_tr_b16 a[238:239], v215 offset:37888
    buffer_load_dwordx4 v225, s[24:27], s60 offen offset:1024  lds
    v_mfma_f32_16x16x32_bf16 v[76:79], a[244:247], a[148:151], v[76:79]
    ds_read_b64_tr_b16 a[240:241], v212 offset:26624
    v_mfma_f32_16x16x32_bf16 v[72:75], a[244:247], a[144:147], v[72:75]
    ds_read_b64_tr_b16 a[242:243], v212 offset:38912
    s_waitcnt lgkmcnt(6)
    v_mfma_f32_16x16x32_bf16 v[80:83], a[216:219], a[144:147], v[80:83]
    ds_read_b64_tr_b16 a[244:245], v213 offset:26624
    v_mfma_f32_16x16x32_bf16 v[84:87], a[216:219], a[148:151], v[84:87]
    ds_read_b64_tr_b16 a[246:247], v213 offset:38912
    s_xor_b32 s44, s83, 16384
    buffer_load_dwordx4 a[32:35], v208, s[32:35], s44 offen sc1
    v_mfma_f32_16x16x32_bf16 v[92:95], a[220:223], a[148:151], v[92:95]
    ds_read_b64_tr_b16 a[216:217], v214 offset:26624
    v_mfma_f32_16x16x32_bf16 v[88:91], a[220:223], a[144:147], v[88:91]
    ds_read_b64_tr_b16 a[218:219], v214 offset:38912
    v_mfma_f32_16x16x32_bf16 v[64:67], a[224:227], a[152:155], v[64:67]
    ds_read_b64_tr_b16 a[220:221], v215 offset:26624
    v_mfma_f32_16x16x32_bf16 v[68:71], a[224:227], a[156:159], v[68:71]
    ds_read_b64_tr_b16 a[222:223], v215 offset:38912
    buffer_load_dwordx4 v226, s[24:27], s61 offen offset:2048  lds
    v_mfma_f32_16x16x32_bf16 v[76:79], a[228:231], a[156:159], v[76:79]
    ds_read_b64_tr_b16 a[224:225], v212 offset:27648
    v_mfma_f32_16x16x32_bf16 v[72:75], a[228:231], a[152:155], v[72:75]
    ds_read_b64_tr_b16 a[226:227], v212 offset:39936
    s_waitcnt lgkmcnt(6)
    v_mfma_f32_16x16x32_bf16 v[80:83], a[232:235], a[152:155], v[80:83]
    ds_read_b64_tr_b16 a[228:229], v213 offset:27648
    v_mfma_f32_16x16x32_bf16 v[84:87], a[232:235], a[156:159], v[84:87]
    ds_read_b64_tr_b16 a[230:231], v213 offset:39936
    v_mfma_f32_16x16x32_bf16 v[92:95], a[236:239], a[156:159], v[92:95]
    ds_read_b64_tr_b16 a[232:233], v214 offset:27648
    v_mfma_f32_16x16x32_bf16 v[88:91], a[236:239], a[152:155], v[88:91]
    ds_read_b64_tr_b16 a[234:235], v214 offset:39936
    v_mfma_f32_16x16x32_bf16 v[64:67], a[240:243], a[160:163], v[64:67]
    ds_read_b64_tr_b16 a[236:237], v215 offset:27648
    v_mfma_f32_16x16x32_bf16 v[68:71], a[240:243], a[164:167], v[68:71]
    ds_read_b64_tr_b16 a[238:239], v215 offset:39936
    buffer_load_dwordx4 v227, s[24:27], s62 offen offset:3072  lds
    v_mfma_f32_16x16x32_bf16 v[76:79], a[244:247], a[164:167], v[76:79]
    ds_read_b64_tr_b16 a[240:241], v212 offset:28672
    s_xor_b32 s44, s83, 18432
    buffer_load_dwordx4 a[36:39], v208, s[32:35], s44 offen sc1
    v_mfma_f32_16x16x32_bf16 v[72:75], a[244:247], a[160:163], v[72:75]
    ds_read_b64_tr_b16 a[242:243], v212 offset:40960
    s_waitcnt lgkmcnt(6)
    v_mfma_f32_16x16x32_bf16 v[80:83], a[216:219], a[160:163], v[80:83]
    ds_read_b64_tr_b16 a[244:245], v213 offset:28672
    v_mfma_f32_16x16x32_bf16 v[84:87], a[216:219], a[164:167], v[84:87]
    ds_read_b64_tr_b16 a[246:247], v213 offset:40960
    s_add_u32 m0, s39, 126976
    v_mfma_f32_16x16x32_bf16 v[92:95], a[220:223], a[164:167], v[92:95]
    ds_read_b64_tr_b16 a[216:217], v214 offset:28672
    v_mfma_f32_16x16x32_bf16 v[88:91], a[220:223], a[160:163], v[88:91]
    ds_read_b64_tr_b16 a[218:219], v214 offset:40960
    v_mfma_f32_16x16x32_bf16 v[64:67], a[224:227], a[168:171], v[64:67]
    ds_read_b64_tr_b16 a[220:221], v215 offset:28672
    buffer_load_dwordx4 v224, s[24:27], s63 offen offset:0  lds
    v_mfma_f32_16x16x32_bf16 v[68:71], a[224:227], a[172:175], v[68:71]
    ds_read_b64_tr_b16 a[222:223], v215 offset:40960
    v_mfma_f32_16x16x32_bf16 v[76:79], a[228:231], a[172:175], v[76:79]
    ds_read_b64_tr_b16 a[224:225], v212 offset:29696
    v_mfma_f32_16x16x32_bf16 v[72:75], a[228:231], a[168:171], v[72:75]
    ds_read_b64_tr_b16 a[226:227], v212 offset:41984
    s_waitcnt lgkmcnt(6)
    v_mfma_f32_16x16x32_bf16 v[80:83], a[232:235], a[168:171], v[80:83]
    ds_read_b64_tr_b16 a[228:229], v213 offset:29696
    s_xor_b32 s44, s83, 20480
    buffer_load_dwordx4 a[40:43], v208, s[32:35], s44 offen sc1
    v_mfma_f32_16x16x32_bf16 v[84:87], a[232:235], a[172:175], v[84:87]
    ds_read_b64_tr_b16 a[230:231], v213 offset:41984
    v_mfma_f32_16x16x32_bf16 v[92:95], a[236:239], a[172:175], v[92:95]
    ds_read_b64_tr_b16 a[232:233], v214 offset:29696
    v_accvgpr_read_b32 v254, a251
    s_lshl_b32 s42, s36, 1
    s_add_u32 s42, s42, 8
    s_lshl_b32 s43, s42, 9
    s_add_u32 m0, s43, 147456
    s_xor_b32 s42, s42, s78
    s_mul_i32 s42, s42, 41472
    buffer_load_dwordx4 v254, s[12:15], s42 offen lds
    s_add_u32 m0, s39, 126976
    v_mfma_f32_16x16x32_bf16 v[88:91], a[236:239], a[168:171], v[88:91]
    ds_read_b64_tr_b16 a[234:235], v214 offset:41984
    v_mfma_f32_16x16x32_bf16 v[64:67], a[240:243], a[176:179], v[64:67]
    ds_read_b64_tr_b16 a[236:237], v215 offset:29696
    buffer_load_dwordx4 v225, s[24:27], s65 offen offset:1024  lds
    v_mfma_f32_16x16x32_bf16 v[68:71], a[240:243], a[180:183], v[68:71]
    ds_read_b64_tr_b16 a[238:239], v215 offset:41984
    v_mfma_f32_16x16x32_bf16 v[76:79], a[244:247], a[180:183], v[76:79]
    s_barrier
    v_add_u32 v212, 0xc000, v212
    ds_read_b64_tr_b16 a[240:241], v212 offset:0
    v_mfma_f32_16x16x32_bf16 v[72:75], a[244:247], a[176:179], v[72:75]
    ds_read_b64_tr_b16 a[242:243], v212 offset:12288
    s_add_u32 m0, s39, 0
    s_waitcnt lgkmcnt(6)
    v_mfma_f32_16x16x32_bf16 v[80:83], a[216:219], a[176:179], v[80:83]
    v_add_u32 v213, 0xc000, v213
    ds_read_b64_tr_b16 a[244:245], v213 offset:0
    s_add_u32 s70, s71, 3
    s_and_b32 s70, s70, 3
    s_lshl_b32 s70, s70, 7
    s_add_u32 s70, s70, s72
    v_mfma_f32_16x16x32_bf16 v[84:87], a[216:219], a[180:183], v[84:87]
    ds_read_b64_tr_b16 a[246:247], v213 offset:12288
    v_accvgpr_read_b32 v228, a249
    v_mfma_f32_16x16x32_bf16 v[92:95], a[220:223], a[180:183], v[92:95]
    v_add_u32 v214, 0xc000, v214
    ds_read_b64_tr_b16 a[216:217], v214 offset:0
    v_add_u32 v228, s70, v228
    v_mfma_f32_16x16x32_bf16 v[88:91], a[220:223], a[176:179], v[88:91]
    ds_read_b64_tr_b16 a[218:219], v214 offset:12288
    v_subrev_u32 v229, 1024, v228
    s_xor_b32 s44, s83, 22528
    buffer_load_dwordx4 a[44:47], v208, s[32:35], s44 offen sc1
    v_mfma_f32_16x16x32_bf16 v[64:67], a[224:227], a[184:187], v[64:67]
    v_add_u32 v215, 0xc000, v215
    ds_read_b64_tr_b16 a[220:221], v215 offset:0
    v_subrev_u32 v230, 2048, v228
    v_subrev_u32 v231, 3072, v228
    v_mfma_f32_16x16x32_bf16 v[68:71], a[224:227], a[188:191], v[68:71]
    ds_read_b64_tr_b16 a[222:223], v215 offset:12288
    buffer_load_dwordx4 v228, s[24:27], s48 offen offset:0  lds
    v_mfma_f32_16x16x32_bf16 v[76:79], a[228:231], a[188:191], v[76:79]
    ds_read_b64_tr_b16 a[224:225], v212 offset:1024
    v_mfma_f32_16x16x32_bf16 v[72:75], a[228:231], a[184:187], v[72:75]
    ds_read_b64_tr_b16 a[226:227], v212 offset:13312
    s_waitcnt lgkmcnt(6)
    v_mfma_f32_16x16x32_bf16 v[80:83], a[232:235], a[184:187], v[80:83]
    ds_read_b64_tr_b16 a[228:229], v213 offset:1024
    v_mfma_f32_16x16x32_bf16 v[84:87], a[232:235], a[188:191], v[84:87]
    ds_read_b64_tr_b16 a[230:231], v213 offset:13312
    v_mfma_f32_16x16x32_bf16 v[92:95], a[236:239], a[188:191], v[92:95]
    ds_read_b64_tr_b16 a[232:233], v214 offset:1024
    v_mfma_f32_16x16x32_bf16 v[88:91], a[236:239], a[184:187], v[88:91]
    ds_read_b64_tr_b16 a[234:235], v214 offset:13312
    s_waitcnt vmcnt(20)
    v_mfma_f32_16x16x32_bf16 v[64:67], a[240:243], a[192:195], v[64:67]
    ds_read_b64_tr_b16 a[236:237], v215 offset:1024
    s_waitcnt vmcnt(18)
    v_mfma_f32_16x16x32_bf16 v[68:71], a[240:243], a[196:199], v[68:71]
    ds_read_b64_tr_b16 a[238:239], v215 offset:13312
    buffer_load_dwordx4 v229, s[24:27], s49 offen offset:1024  lds
    v_mfma_f32_16x16x32_bf16 v[76:79], a[244:247], a[196:199], v[76:79]
    ds_read_b64_tr_b16 a[240:241], v212 offset:2048
    v_mfma_f32_16x16x32_bf16 v[72:75], a[244:247], a[192:195], v[72:75]
    ds_read_b64_tr_b16 a[242:243], v212 offset:14336
    s_xor_b32 s44, s83, 24576
    buffer_load_dwordx4 a[48:51], v208, s[32:35], s44 offen sc1
    s_waitcnt lgkmcnt(6)
    v_mfma_f32_16x16x32_bf16 v[80:83], a[216:219], a[192:195], v[80:83]
    ds_read_b64_tr_b16 a[244:245], v213 offset:2048
    v_mfma_f32_16x16x32_bf16 v[84:87], a[216:219], a[196:199], v[84:87]
    ds_read_b64_tr_b16 a[246:247], v213 offset:14336
    v_mfma_f32_16x16x32_bf16 v[92:95], a[220:223], a[196:199], v[92:95]
    ds_read_b64_tr_b16 a[216:217], v214 offset:2048
    v_mfma_f32_16x16x32_bf16 v[88:91], a[220:223], a[192:195], v[88:91]
    ds_read_b64_tr_b16 a[218:219], v214 offset:14336
    s_waitcnt vmcnt(19)
    v_mfma_f32_16x16x32_bf16 v[64:67], a[224:227], a[200:203], v[64:67]
    ds_read_b64_tr_b16 a[220:221], v215 offset:2048
    s_waitcnt vmcnt(17)
    v_mfma_f32_16x16x32_bf16 v[68:71], a[224:227], a[204:207], v[68:71]
    ds_read_b64_tr_b16 a[222:223], v215 offset:14336
    buffer_load_dwordx4 v230, s[24:27], s50 offen offset:2048  lds
    v_mfma_f32_16x16x32_bf16 v[76:79], a[228:231], a[204:207], v[76:79]
    ds_read_b64_tr_b16 a[224:225], v212 offset:3072
    v_mfma_f32_16x16x32_bf16 v[72:75], a[228:231], a[200:203], v[72:75]
    ds_read_b64_tr_b16 a[226:227], v212 offset:15360
    s_waitcnt lgkmcnt(6)
    v_mfma_f32_16x16x32_bf16 v[80:83], a[232:235], a[200:203], v[80:83]
    ds_read_b64_tr_b16 a[228:229], v213 offset:3072
    v_mfma_f32_16x16x32_bf16 v[84:87], a[232:235], a[204:207], v[84:87]
    ds_read_b64_tr_b16 a[230:231], v213 offset:15360
    v_mfma_f32_16x16x32_bf16 v[92:95], a[236:239], a[204:207], v[92:95]
    ds_read_b64_tr_b16 a[232:233], v214 offset:3072
    s_xor_b32 s44, s83, 26624
    buffer_load_dwordx4 a[52:55], v208, s[32:35], s44 offen sc1
    v_mfma_f32_16x16x32_bf16 v[88:91], a[236:239], a[200:203], v[88:91]
    ds_read_b64_tr_b16 a[234:235], v214 offset:15360
    s_waitcnt vmcnt(17)
    v_mfma_f32_16x16x32_bf16 v[64:67], a[240:243], a[208:211], v[64:67]
    ds_read_b64_tr_b16 a[236:237], v215 offset:3072
    s_waitcnt vmcnt(16)
    v_mfma_f32_16x16x32_bf16 v[68:71], a[240:243], a[212:215], v[68:71]
    ds_read_b64_tr_b16 a[238:239], v215 offset:15360
    buffer_load_dwordx4 v231, s[24:27], s51 offen offset:3072  lds
    v_mfma_f32_16x16x32_bf16 v[76:79], a[244:247], a[212:215], v[76:79]
    ds_read_b64_tr_b16 a[240:241], v212 offset:4096
    v_mfma_f32_16x16x32_bf16 v[72:75], a[244:247], a[208:211], v[72:75]
    ds_read_b64_tr_b16 a[242:243], v212 offset:16384
    s_waitcnt lgkmcnt(6)
    v_mfma_f32_16x16x32_bf16 v[80:83], a[216:219], a[208:211], v[80:83]
    ds_read_b64_tr_b16 a[244:245], v213 offset:4096
    v_accvgpr_read_b32 v254, a254
    s_min_u32 s43, s36, 1
    s_lshl_b32 s42, s43, 30
    s_lshl_b32 s43, s43, 10
    s_add_u32 m0, s43, 155648
    s_nop 0
    buffer_load_dwordx4 v254, s[12:15], s42 offen lds
    s_add_u32 m0, s39, 0
    v_mfma_f32_16x16x32_bf16 v[84:87], a[216:219], a[212:215], v[84:87]
    ds_read_b64_tr_b16 a[246:247], v213 offset:16384
    s_add_u32 m0, s39, 4096
    v_mfma_f32_16x16x32_bf16 v[92:95], a[220:223], a[212:215], v[92:95]
    ds_read_b64_tr_b16 a[216:217], v214 offset:4096
    v_mfma_f32_16x16x32_bf16 v[88:91], a[220:223], a[208:211], v[88:91]
    ds_read_b64_tr_b16 a[218:219], v214 offset:16384
    v_mfma_f32_16x16x32_bf16 v[96:99], a[224:227], a[192:195], v[96:99]
    ds_read_b64_tr_b16 a[220:221], v215 offset:4096
    buffer_load_dwordx4 v228, s[24:27], s52 offen offset:0  lds
    v_mfma_f32_16x16x32_bf16 v[100:103], a[224:227], a[196:199], v[100:103]
    ds_read_b64_tr_b16 a[222:223], v215 offset:16384
    s_xor_b32 s44, s83, 28672
    buffer_load_dwordx4 a[56:59], v208, s[32:35], s44 offen sc1
    v_mfma_f32_16x16x32_bf16 v[108:111], a[228:231], a[196:199], v[108:111]
    ds_read_b64_tr_b16 a[224:225], v212 offset:5120
    v_mfma_f32_16x16x32_bf16 v[104:107], a[228:231], a[192:195], v[104:107]
    ds_read_b64_tr_b16 a[226:227], v212 offset:17408
    s_waitcnt lgkmcnt(6)
    v_mfma_f32_16x16x32_bf16 v[112:115], a[232:235], a[192:195], v[112:115]
    ds_read_b64_tr_b16 a[228:229], v213 offset:5120
    v_mfma_f32_16x16x32_bf16 v[116:119], a[232:235], a[196:199], v[116:119]
    ds_read_b64_tr_b16 a[230:231], v213 offset:17408
    v_mfma_f32_16x16x32_bf16 v[124:127], a[236:239], a[196:199], v[124:127]
    ds_read_b64_tr_b16 a[232:233], v214 offset:5120
    v_mfma_f32_16x16x32_bf16 v[120:123], a[236:239], a[192:195], v[120:123]
    ds_read_b64_tr_b16 a[234:235], v214 offset:17408
    v_mfma_f32_16x16x32_bf16 v[96:99], a[240:243], a[200:203], v[96:99]
    ds_read_b64_tr_b16 a[236:237], v215 offset:5120
    buffer_load_dwordx4 v229, s[24:27], s53 offen offset:1024  lds
    v_mfma_f32_16x16x32_bf16 v[100:103], a[240:243], a[204:207], v[100:103]
    ds_read_b64_tr_b16 a[238:239], v215 offset:17408
    v_mfma_f32_16x16x32_bf16 v[108:111], a[244:247], a[204:207], v[108:111]
    s_barrier
    ds_read_b64_tr_b16 a[240:241], v212 offset:24576
    v_mfma_f32_16x16x32_bf16 v[104:107], a[244:247], a[200:203], v[104:107]
    ds_read_b64_tr_b16 a[242:243], v212 offset:36864
    s_waitcnt lgkmcnt(6)
    v_mfma_f32_16x16x32_bf16 v[112:115], a[216:219], a[200:203], v[112:115]
    ds_read_b64_tr_b16 a[244:245], v213 offset:24576
    v_mfma_f32_16x16x32_bf16 v[116:119], a[216:219], a[204:207], v[116:119]
    ds_read_b64_tr_b16 a[246:247], v213 offset:36864
    s_xor_b32 s44, s83, 30720
    buffer_load_dwordx4 a[60:63], v208, s[32:35], s44 offen sc1
    v_mfma_f32_16x16x32_bf16 v[124:127], a[220:223], a[204:207], v[124:127]
    ds_read_b64_tr_b16 a[216:217], v214 offset:24576
    s_add_u32 m0, s39, 24576
    v_mfma_f32_16x16x32_bf16 v[120:123], a[220:223], a[200:203], v[120:123]
    ds_read_b64_tr_b16 a[218:219], v214 offset:36864
    v_mfma_f32_16x16x32_bf16 v[96:99], a[224:227], a[208:211], v[96:99]
    ds_read_b64_tr_b16 a[220:221], v215 offset:24576
    v_mfma_f32_16x16x32_bf16 v[100:103], a[224:227], a[212:215], v[100:103]
    ds_read_b64_tr_b16 a[222:223], v215 offset:36864
    buffer_load_dwordx4 v228, s[24:27], s54 offen offset:0  lds
    v_mfma_f32_16x16x32_bf16 v[108:111], a[228:231], a[212:215], v[108:111]
    ds_read_b64_tr_b16 a[224:225], v212 offset:25600
    v_mfma_f32_16x16x32_bf16 v[104:107], a[228:231], a[208:211], v[104:107]
    ds_read_b64_tr_b16 a[226:227], v212 offset:37888
    s_waitcnt lgkmcnt(6)
    v_mfma_f32_16x16x32_bf16 v[112:115], a[232:235], a[208:211], v[112:115]
    ds_read_b64_tr_b16 a[228:229], v213 offset:25600
    v_mfma_f32_16x16x32_bf16 v[116:119], a[232:235], a[212:215], v[116:119]
    ds_read_b64_tr_b16 a[230:231], v213 offset:37888
    v_mfma_f32_16x16x32_bf16 v[124:127], a[236:239], a[212:215], v[124:127]
    ds_read_b64_tr_b16 a[232:233], v214 offset:25600
    v_mfma_f32_16x16x32_bf16 v[120:123], a[236:239], a[208:211], v[120:123]
    ds_read_b64_tr_b16 a[234:235], v214 offset:37888
    v_mfma_f32_16x16x32_bf16 v[0:3], a[240:243], v[128:131], 0
    ds_read_b64_tr_b16 a[236:237], v215 offset:25600
    v_mfma_f32_16x16x32_bf16 v[4:7], a[240:243], v[132:135], 0
    ds_read_b64_tr_b16 a[238:239], v215 offset:37888
    buffer_load_dwordx4 v229, s[24:27], s55 offen offset:1024  lds
    v_mfma_f32_16x16x32_bf16 v[12:15], a[244:247], v[132:135], 0
    ds_read_b64_tr_b16 a[240:241], v212 offset:26624
    s_add_u32 s80, s71, 1
    s_and_b32 s80, s80, 3
    s_lshl_b32 s80, s80, 12
    s_add_u32 s80, s80, s79
    v_mfma_f32_16x16x32_bf16 v[8:11], a[244:247], v[128:131], 0
    ds_read_b64_tr_b16 a[242:243], v212 offset:38912
    v_cvt_pk_bf16_f32 v64, v64, v65
    s_waitcnt lgkmcnt(6)
    v_mfma_f32_16x16x32_bf16 v[16:19], a[216:219], v[128:131], 0
    ds_read_b64_tr_b16 a[244:245], v213 offset:26624
    v_cvt_pk_bf16_f32 v65, v66, v67
    v_mfma_f32_16x16x32_bf16 v[20:23], a[216:219], v[132:135], 0
    ds_read_b64_tr_b16 a[246:247], v213 offset:38912
    v_cvt_pk_bf16_f32 v66, v72, v73
    v_mfma_f32_16x16x32_bf16 v[28:31], a[220:223], v[132:135], 0
    ds_read_b64_tr_b16 a[216:217], v214 offset:26624
    v_cvt_pk_bf16_f32 v67, v74, v75
    v_cvt_pk_bf16_f32 v68, v68, v69
    v_mfma_f32_16x16x32_bf16 v[24:27], a[220:223], v[128:131], 0
    ds_read_b64_tr_b16 a[218:219], v214 offset:38912
    buffer_load_dwordx4 a[72:75], v200, s[4:7], s85 offen
    v_mfma_f32_16x16x32_bf16 v[0:3], a[224:227], v[136:139], v[0:3]
    ds_read_b64_tr_b16 a[220:221], v215 offset:26624
    v_cvt_pk_bf16_f32 v69, v70, v71
    v_cvt_pk_bf16_f32 v70, v76, v77
    v_mfma_f32_16x16x32_bf16 v[4:7], a[224:227], v[140:143], v[4:7]
    ds_read_b64_tr_b16 a[222:223], v215 offset:38912
    buffer_load_dwordx4 v230, s[24:27], s64 offen offset:2048  lds
    v_cvt_pk_bf16_f32 v71, v78, v79
    v_mfma_f32_16x16x32_bf16 v[12:15], a[228:231], v[140:143], v[12:15]
    ds_read_b64_tr_b16 a[224:225], v212 offset:27648
    v_cvt_pk_bf16_f32 v80, v80, v81
    v_mfma_f32_16x16x32_bf16 v[8:11], a[228:231], v[136:139], v[8:11]
    ds_read_b64_tr_b16 a[226:227], v212 offset:39936
    v_cvt_pk_bf16_f32 v81, v82, v83
    v_cvt_pk_bf16_f32 v82, v88, v89
    s_waitcnt lgkmcnt(6)
    v_mfma_f32_16x16x32_bf16 v[16:19], a[232:235], v[136:139], v[16:19]
    ds_read_b64_tr_b16 a[228:229], v213 offset:27648
    buffer_load_dwordx4 a[76:79], v200, s[4:7], s86 offen
    v_mfma_f32_16x16x32_bf16 v[20:23], a[232:235], v[140:143], v[20:23]
    ds_read_b64_tr_b16 a[230:231], v213 offset:39936
    v_cvt_pk_bf16_f32 v83, v90, v91
    v_mfma_f32_16x16x32_bf16 v[28:31], a[236:239], v[140:143], v[28:31]
    ds_read_b64_tr_b16 a[232:233], v214 offset:27648
    v_cvt_pk_bf16_f32 v84, v84, v85
    v_mfma_f32_16x16x32_bf16 v[24:27], a[236:239], v[136:139], v[24:27]
    ds_read_b64_tr_b16 a[234:235], v214 offset:39936
    v_cvt_pk_bf16_f32 v85, v86, v87
    v_cvt_pk_bf16_f32 v86, v92, v93
    v_mfma_f32_16x16x32_bf16 v[0:3], a[240:243], v[144:147], v[0:3]
    ds_read_b64_tr_b16 a[236:237], v215 offset:27648
    buffer_load_dwordx4 a[80:83], v201, s[4:7], s85 offen
    v_cvt_pk_bf16_f32 v87, v94, v95
    v_mfma_f32_16x16x32_bf16 v[4:7], a[240:243], v[148:151], v[4:7]
    ds_read_b64_tr_b16 a[238:239], v215 offset:39936
    buffer_load_dwordx4 v231, s[24:27], s56 offen offset:3072  lds
    v_cvt_pk_bf16_f32 v96, v96, v97
    v_mfma_f32_16x16x32_bf16 v[12:15], a[244:247], v[148:151], v[12:15]
    ds_read_b64_tr_b16 a[240:241], v212 offset:28672
    v_cvt_pk_bf16_f32 v97, v98, v99
    v_mfma_f32_16x16x32_bf16 v[8:11], a[244:247], v[144:147], v[8:11]
    ds_read_b64_tr_b16 a[242:243], v212 offset:40960
    v_cvt_pk_bf16_f32 v98, v104, v105
    s_waitcnt lgkmcnt(6)
    v_mfma_f32_16x16x32_bf16 v[16:19], a[216:219], v[144:147], v[16:19]
    ds_read_b64_tr_b16 a[244:245], v213 offset:28672
    v_cvt_pk_bf16_f32 v99, v106, v107
    v_cvt_pk_bf16_f32 v100, v100, v101
    v_mfma_f32_16x16x32_bf16 v[20:23], a[216:219], v[148:151], v[20:23]
    ds_read_b64_tr_b16 a[246:247], v213 offset:40960
    s_add_u32 m0, s39, 28672
    v_cvt_pk_bf16_f32 v101, v102, v103
    v_mfma_f32_16x16x32_bf16 v[28:31], a[220:223], v[148:151], v[28:31]
    ds_read_b64_tr_b16 a[216:217], v214 offset:28672
    v_cvt_pk_bf16_f32 v102, v108, v109
    v_mfma_f32_16x16x32_bf16 v[24:27], a[220:223], v[144:147], v[24:27]
    ds_read_b64_tr_b16 a[218:219], v214 offset:40960
    v_cvt_pk_bf16_f32 v103, v110, v111
    v_cvt_pk_bf16_f32 v112, v112, v113
    v_mfma_f32_16x16x32_bf16 v[0:3], a[224:227], v[152:155], v[0:3]
    ds_read_b64_tr_b16 a[220:221], v215 offset:28672
    buffer_load_dwordx4 v228, s[24:27], s57 offen offset:0  lds
    v_cvt_pk_bf16_f32 v113, v114, v115
    v_mfma_f32_16x16x32_bf16 v[4:7], a[224:227], v[156:159], v[4:7]
    ds_read_b64_tr_b16 a[222:223], v215 offset:40960
    v_cvt_pk_bf16_f32 v114, v120, v121
    v_mfma_f32_16x16x32_bf16 v[12:15], a[228:231], v[156:159], v[12:15]
    ds_read_b64_tr_b16 a[224:225], v212 offset:29696
    v_cvt_pk_bf16_f32 v115, v122, v123
    v_mfma_f32_16x16x32_bf16 v[8:11], a[228:231], v[152:155], v[8:11]
    ds_read_b64_tr_b16 a[226:227], v212 offset:41984
    v_cvt_pk_bf16_f32 v116, v116, v117
    s_waitcnt lgkmcnt(6)
    v_mfma_f32_16x16x32_bf16 v[16:19], a[232:235], v[152:155], v[16:19]
    ds_read_b64_tr_b16 a[228:229], v213 offset:29696
    v_cvt_pk_bf16_f32 v117, v118, v119
    v_cvt_pk_bf16_f32 v118, v124, v125
    v_cvt_pk_bf16_f32 v119, v126, v127
    v_mfma_f32_16x16x32_bf16 v[20:23], a[232:235], v[156:159], v[20:23]
    ds_read_b64_tr_b16 a[230:231], v213 offset:41984
    v_mfma_f32_16x16x32_bf16 v[28:31], a[236:239], v[156:159], v[28:31]
    ds_read_b64_tr_b16 a[232:233], v214 offset:29696
    buffer_store_dwordx4 v[64:67], v208, s[32:35], s80 offen offset:0 sc1
    v_mfma_f32_16x16x32_bf16 v[24:27], a[236:239], v[152:155], v[24:27]
    ds_read_b64_tr_b16 a[234:235], v214 offset:41984
    v_mfma_f32_16x16x32_bf16 v[0:3], a[240:243], v[160:163], v[0:3]
    ds_read_b64_tr_b16 a[236:237], v215 offset:29696
    buffer_load_dwordx4 v229, s[24:27], s58 offen offset:1024  lds
    v_mfma_f32_16x16x32_bf16 v[4:7], a[240:243], v[164:167], v[4:7]
    ds_read_b64_tr_b16 a[238:239], v215 offset:41984
    buffer_store_dwordx4 v[68:71], v208, s[32:35], s80 offen offset:2048 sc1
    v_mfma_f32_16x16x32_bf16 v[12:15], a[244:247], v[164:167], v[12:15]
    s_barrier
    v_add_u32 v212, 0xc000, v212
    ds_read_b64_tr_b16 a[240:241], v212 offset:0
    v_mfma_f32_16x16x32_bf16 v[8:11], a[244:247], v[160:163], v[8:11]
    ds_read_b64_tr_b16 a[242:243], v212 offset:12288
    buffer_store_dwordx4 v[80:83], v208, s[32:35], s80 offen offset:1024 sc1
    s_waitcnt lgkmcnt(6)
    v_mfma_f32_16x16x32_bf16 v[16:19], a[216:219], v[160:163], v[16:19]
    v_add_u32 v213, 0xc000, v213
    ds_read_b64_tr_b16 a[244:245], v213 offset:0
    v_mfma_f32_16x16x32_bf16 v[20:23], a[216:219], v[164:167], v[20:23]
    ds_read_b64_tr_b16 a[246:247], v213 offset:12288
    v_mfma_f32_16x16x32_bf16 v[28:31], a[220:223], v[164:167], v[28:31]
    v_add_u32 v214, 0xc000, v214
    ds_read_b64_tr_b16 a[216:217], v214 offset:0
    s_add_u32 m0, s39, 49152
    v_mfma_f32_16x16x32_bf16 v[24:27], a[220:223], v[160:163], v[24:27]
    ds_read_b64_tr_b16 a[218:219], v214 offset:12288
    buffer_store_dwordx4 v[84:87], v208, s[32:35], s80 offen offset:3072 sc1
    v_mfma_f32_16x16x32_bf16 v[0:3], a[224:227], v[168:171], v[0:3]
    v_add_u32 v215, 0xc000, v215
    ds_read_b64_tr_b16 a[220:221], v215 offset:0
    v_mfma_f32_16x16x32_bf16 v[4:7], a[224:227], v[172:175], v[4:7]
    ds_read_b64_tr_b16 a[222:223], v215 offset:12288
    buffer_load_dwordx4 v228, s[24:27], s59 offen offset:0  lds
    v_mfma_f32_16x16x32_bf16 v[12:15], a[228:231], v[172:175], v[12:15]
    ds_read_b64_tr_b16 a[224:225], v212 offset:1024
    s_add_u32 s80, s71, 0
    s_and_b32 s80, s80, 3
    s_lshl_b32 s80, s80, 12
    s_add_u32 s80, s80, s79
    v_mfma_f32_16x16x32_bf16 v[8:11], a[228:231], v[168:171], v[8:11]
    ds_read_b64_tr_b16 a[226:227], v212 offset:13312
    buffer_store_dwordx4 v[96:99], v208, s[32:35], s80 offen offset:0 sc1
    s_waitcnt lgkmcnt(6)
    v_mfma_f32_16x16x32_bf16 v[16:19], a[232:235], v[168:171], v[16:19]
    ds_read_b64_tr_b16 a[228:229], v213 offset:1024
    v_mfma_f32_16x16x32_bf16 v[20:23], a[232:235], v[172:175], v[20:23]
    ds_read_b64_tr_b16 a[230:231], v213 offset:13312
    v_mfma_f32_16x16x32_bf16 v[28:31], a[236:239], v[172:175], v[28:31]
    ds_read_b64_tr_b16 a[232:233], v214 offset:1024
    buffer_store_dwordx4 v[100:103], v208, s[32:35], s80 offen offset:2048 sc1
    v_mfma_f32_16x16x32_bf16 v[24:27], a[236:239], v[168:171], v[24:27]
    ds_read_b64_tr_b16 a[234:235], v214 offset:13312
    v_mfma_f32_16x16x32_bf16 v[0:3], a[240:243], v[176:179], v[0:3]
    ds_read_b64_tr_b16 a[236:237], v215 offset:1024
    v_mfma_f32_16x16x32_bf16 v[4:7], a[240:243], v[180:183], v[4:7]
    ds_read_b64_tr_b16 a[238:239], v215 offset:13312
    buffer_load_dwordx4 v229, s[24:27], s60 offen offset:1024  lds
    v_mfma_f32_16x16x32_bf16 v[12:15], a[244:247], v[180:183], v[12:15]
    ds_read_b64_tr_b16 a[240:241], v212 offset:2048
    buffer_store_dwordx4 v[112:115], v208, s[32:35], s80 offen offset:1024 sc1
    v_mfma_f32_16x16x32_bf16 v[8:11], a[244:247], v[176:179], v[8:11]
    ds_read_b64_tr_b16 a[242:243], v212 offset:14336
    buffer_store_dwordx4 v[116:119], v208, s[32:35], s80 offen offset:3072 sc1
    s_waitcnt lgkmcnt(6)
    v_mfma_f32_16x16x32_bf16 v[16:19], a[216:219], v[176:179], v[16:19]
    ds_read_b64_tr_b16 a[244:245], v213 offset:2048
    v_mfma_f32_16x16x32_bf16 v[20:23], a[216:219], v[180:183], v[20:23]
    ds_read_b64_tr_b16 a[246:247], v213 offset:14336
    v_mfma_f32_16x16x32_bf16 v[28:31], a[220:223], v[180:183], v[28:31]
    ds_read_b64_tr_b16 a[216:217], v214 offset:2048
    v_mfma_f32_16x16x32_bf16 v[24:27], a[220:223], v[176:179], v[24:27]
    ds_read_b64_tr_b16 a[218:219], v214 offset:14336
    v_mfma_f32_16x16x32_bf16 v[0:3], a[224:227], v[184:187], v[0:3]
    ds_read_b64_tr_b16 a[220:221], v215 offset:2048
    v_mfma_f32_16x16x32_bf16 v[4:7], a[224:227], v[188:191], v[4:7]
    ds_read_b64_tr_b16 a[222:223], v215 offset:14336
    buffer_load_dwordx4 v230, s[24:27], s61 offen offset:2048  lds
    v_mfma_f32_16x16x32_bf16 v[12:15], a[228:231], v[188:191], v[12:15]
    ds_read_b64_tr_b16 a[224:225], v212 offset:3072
    v_mfma_f32_16x16x32_bf16 v[8:11], a[228:231], v[184:187], v[8:11]
    ds_read_b64_tr_b16 a[226:227], v212 offset:15360
    s_waitcnt lgkmcnt(6)
    v_mfma_f32_16x16x32_bf16 v[16:19], a[232:235], v[184:187], v[16:19]
    ds_read_b64_tr_b16 a[228:229], v213 offset:3072
    v_mfma_f32_16x16x32_bf16 v[20:23], a[232:235], v[188:191], v[20:23]
    ds_read_b64_tr_b16 a[230:231], v213 offset:15360
    v_mfma_f32_16x16x32_bf16 v[28:31], a[236:239], v[188:191], v[28:31]
    ds_read_b64_tr_b16 a[232:233], v214 offset:3072
    v_mfma_f32_16x16x32_bf16 v[24:27], a[236:239], v[184:187], v[24:27]
    ds_read_b64_tr_b16 a[234:235], v214 offset:15360
    v_mfma_f32_16x16x32_bf16 v[0:3], a[240:243], v[192:195], v[0:3]
    ds_read_b64_tr_b16 a[236:237], v215 offset:3072
    v_mfma_f32_16x16x32_bf16 v[4:7], a[240:243], v[196:199], v[4:7]
    ds_read_b64_tr_b16 a[238:239], v215 offset:15360
    buffer_load_dwordx4 v231, s[24:27], s62 offen offset:3072  lds
    v_mfma_f32_16x16x32_bf16 v[12:15], a[244:247], v[196:199], v[12:15]
    ds_read_b64_tr_b16 a[240:241], v212 offset:4096
    v_mfma_f32_16x16x32_bf16 v[8:11], a[244:247], v[192:195], v[8:11]
    ds_read_b64_tr_b16 a[242:243], v212 offset:16384
    s_waitcnt lgkmcnt(6)
    v_mfma_f32_16x16x32_bf16 v[16:19], a[216:219], v[192:195], v[16:19]
    ds_read_b64_tr_b16 a[244:245], v213 offset:4096
    v_mfma_f32_16x16x32_bf16 v[20:23], a[216:219], v[196:199], v[20:23]
    ds_read_b64_tr_b16 a[246:247], v213 offset:16384
    s_add_u32 m0, s39, 53248
    v_mfma_f32_16x16x32_bf16 v[28:31], a[220:223], v[196:199], v[28:31]
    ds_read_b64_tr_b16 a[216:217], v214 offset:4096
    v_mfma_f32_16x16x32_bf16 v[24:27], a[220:223], v[192:195], v[24:27]
    ds_read_b64_tr_b16 a[218:219], v214 offset:16384
    v_mfma_f32_16x16x32_bf16 v[0:3], a[224:227], a[144:147], v[0:3]
    ds_read_b64_tr_b16 a[220:221], v215 offset:4096
    buffer_load_dwordx4 v228, s[24:27], s63 offen offset:0  lds
    v_mfma_f32_16x16x32_bf16 v[4:7], a[224:227], a[148:151], v[4:7]
    ds_read_b64_tr_b16 a[222:223], v215 offset:16384
    v_mfma_f32_16x16x32_bf16 v[12:15], a[228:231], a[148:151], v[12:15]
    ds_read_b64_tr_b16 a[224:225], v212 offset:5120
    v_mfma_f32_16x16x32_bf16 v[8:11], a[228:231], a[144:147], v[8:11]
    ds_read_b64_tr_b16 a[226:227], v212 offset:17408
    s_waitcnt lgkmcnt(6)
    v_mfma_f32_16x16x32_bf16 v[16:19], a[232:235], a[144:147], v[16:19]
    ds_read_b64_tr_b16 a[228:229], v213 offset:5120
    v_mfma_f32_16x16x32_bf16 v[20:23], a[232:235], a[148:151], v[20:23]
    ds_read_b64_tr_b16 a[230:231], v213 offset:17408
    v_mfma_f32_16x16x32_bf16 v[28:31], a[236:239], a[148:151], v[28:31]
    ds_read_b64_tr_b16 a[232:233], v214 offset:5120
    v_mfma_f32_16x16x32_bf16 v[24:27], a[236:239], a[144:147], v[24:27]
    ds_read_b64_tr_b16 a[234:235], v214 offset:17408
    v_mfma_f32_16x16x32_bf16 v[0:3], a[240:243], a[152:155], v[0:3]
    ds_read_b64_tr_b16 a[236:237], v215 offset:5120
    buffer_load_dwordx4 v229, s[24:27], s65 offen offset:1024  lds
    v_mfma_f32_16x16x32_bf16 v[4:7], a[240:243], a[156:159], v[4:7]
    ds_read_b64_tr_b16 a[238:239], v215 offset:17408
    v_mfma_f32_16x16x32_bf16 v[12:15], a[244:247], a[156:159], v[12:15]
    s_waitcnt vmcnt(35)
    s_waitcnt vmcnt(4)
    s_barrier
    ds_read_b64_tr_b16 a[240:241], v212 offset:24576
    s_add_u32 s42, s40, 7
    v_mov_b32 v254, s42
    buffer_store_dword v254, v255, s[32:35], s47 offen sc1
    v_mfma_f32_16x16x32_bf16 v[8:11], a[244:247], a[152:155], v[8:11]
    ds_read_b64_tr_b16 a[242:243], v212 offset:36864
    s_add_u32 m0, s39, 73728
    s_waitcnt lgkmcnt(6)
    v_mfma_f32_16x16x32_bf16 v[16:19], a[216:219], a[152:155], v[16:19]
    ds_read_b64_tr_b16 a[244:245], v213 offset:24576
    v_accvgpr_read_b32 v224, a250
    v_mfma_f32_16x16x32_bf16 v[20:23], a[216:219], a[156:159], v[20:23]
    ds_read_b64_tr_b16 a[246:247], v213 offset:36864
    v_mfma_f32_16x16x32_bf16 v[28:31], a[220:223], a[156:159], v[28:31]
    ds_read_b64_tr_b16 a[216:217], v214 offset:24576
    v_subrev_u32 v225, 1024, v224
    v_mfma_f32_16x16x32_bf16 v[24:27], a[220:223], a[152:155], v[24:27]
    ds_read_b64_tr_b16 a[218:219], v214 offset:36864
    v_subrev_u32 v226, 2048, v224
    v_mfma_f32_16x16x32_bf16 v[0:3], a[224:227], a[160:163], v[0:3]
    ds_read_b64_tr_b16 a[220:221], v215 offset:24576
    v_subrev_u32 v227, 3072, v224
    v_mfma_f32_16x16x32_bf16 v[4:7], a[224:227], a[164:167], v[4:7]
    ds_read_b64_tr_b16 a[222:223], v215 offset:36864
    buffer_load_dwordx4 v224, s[24:27], s48 offen offset:0  lds
    v_mfma_f32_16x16x32_bf16 v[12:15], a[228:231], a[164:167], v[12:15]
    ds_read_b64_tr_b16 a[224:225], v212 offset:25600
    v_mfma_f32_16x16x32_bf16 v[8:11], a[228:231], a[160:163], v[8:11]
    ds_read_b64_tr_b16 a[226:227], v212 offset:37888
    s_waitcnt lgkmcnt(6)
    v_mfma_f32_16x16x32_bf16 v[16:19], a[232:235], a[160:163], v[16:19]
    ds_read_b64_tr_b16 a[228:229], v213 offset:25600
    v_mfma_f32_16x16x32_bf16 v[20:23], a[232:235], a[164:167], v[20:23]
    ds_read_b64_tr_b16 a[230:231], v213 offset:37888
    v_mfma_f32_16x16x32_bf16 v[28:31], a[236:239], a[164:167], v[28:31]
    ds_read_b64_tr_b16 a[232:233], v214 offset:25600
    v_mfma_f32_16x16x32_bf16 v[24:27], a[236:239], a[160:163], v[24:27]
    ds_read_b64_tr_b16 a[234:235], v214 offset:37888
    v_mfma_f32_16x16x32_bf16 v[0:3], a[240:243], a[168:171], v[0:3]
    ds_read_b64_tr_b16 a[236:237], v215 offset:25600
    v_mfma_f32_16x16x32_bf16 v[4:7], a[240:243], a[172:175], v[4:7]
    ds_read_b64_tr_b16 a[238:239], v215 offset:37888
    buffer_load_dwordx4 v225, s[24:27], s50 offen offset:1024  lds
    v_mfma_f32_16x16x32_bf16 v[12:15], a[244:247], a[172:175], v[12:15]
    ds_read_b64_tr_b16 a[240:241], v212 offset:26624
    v_mfma_f32_16x16x32_bf16 v[8:11], a[244:247], a[168:171], v[8:11]
    ds_read_b64_tr_b16 a[242:243], v212 offset:38912
    s_waitcnt lgkmcnt(6)
    v_mfma_f32_16x16x32_bf16 v[16:19], a[216:219], a[168:171], v[16:19]
    ds_read_b64_tr_b16 a[244:245], v213 offset:26624
    v_mfma_f32_16x16x32_bf16 v[20:23], a[216:219], a[172:175], v[20:23]
    ds_read_b64_tr_b16 a[246:247], v213 offset:38912
    v_mfma_f32_16x16x32_bf16 v[28:31], a[220:223], a[172:175], v[28:31]
    ds_read_b64_tr_b16 a[216:217], v214 offset:26624
    v_mfma_f32_16x16x32_bf16 v[24:27], a[220:223], a[168:171], v[24:27]
    ds_read_b64_tr_b16 a[218:219], v214 offset:38912
    v_mfma_f32_16x16x32_bf16 v[0:3], a[224:227], a[176:179], v[0:3]
    ds_read_b64_tr_b16 a[220:221], v215 offset:26624
    v_mfma_f32_16x16x32_bf16 v[4:7], a[224:227], a[180:183], v[4:7]
    ds_read_b64_tr_b16 a[222:223], v215 offset:38912
    buffer_load_dwordx4 v226, s[24:27], s52 offen offset:2048  lds
    v_mfma_f32_16x16x32_bf16 v[12:15], a[228:231], a[180:183], v[12:15]
    ds_read_b64_tr_b16 a[224:225], v212 offset:27648
    v_mfma_f32_16x16x32_bf16 v[8:11], a[228:231], a[176:179], v[8:11]
    ds_read_b64_tr_b16 a[226:227], v212 offset:39936
    s_waitcnt lgkmcnt(6)
    v_mfma_f32_16x16x32_bf16 v[16:19], a[232:235], a[176:179], v[16:19]
    ds_read_b64_tr_b16 a[228:229], v213 offset:27648
    v_mfma_f32_16x16x32_bf16 v[20:23], a[232:235], a[180:183], v[20:23]
    ds_read_b64_tr_b16 a[230:231], v213 offset:39936
    v_mfma_f32_16x16x32_bf16 v[28:31], a[236:239], a[180:183], v[28:31]
    ds_read_b64_tr_b16 a[232:233], v214 offset:27648
    v_mfma_f32_16x16x32_bf16 v[24:27], a[236:239], a[176:179], v[24:27]
    ds_read_b64_tr_b16 a[234:235], v214 offset:39936
    v_mfma_f32_16x16x32_bf16 v[0:3], a[240:243], a[184:187], v[0:3]
    ds_read_b64_tr_b16 a[236:237], v215 offset:27648
    v_mfma_f32_16x16x32_bf16 v[4:7], a[240:243], a[188:191], v[4:7]
    ds_read_b64_tr_b16 a[238:239], v215 offset:39936
    buffer_load_dwordx4 v227, s[24:27], s54 offen offset:3072  lds
    v_mfma_f32_16x16x32_bf16 v[12:15], a[244:247], a[188:191], v[12:15]
    ds_read_b64_tr_b16 a[240:241], v212 offset:28672
    v_mfma_f32_16x16x32_bf16 v[8:11], a[244:247], a[184:187], v[8:11]
    ds_read_b64_tr_b16 a[242:243], v212 offset:40960
    s_waitcnt lgkmcnt(6)
    v_mfma_f32_16x16x32_bf16 v[16:19], a[216:219], a[184:187], v[16:19]
    ds_read_b64_tr_b16 a[244:245], v213 offset:28672
    v_mfma_f32_16x16x32_bf16 v[20:23], a[216:219], a[188:191], v[20:23]
    ds_read_b64_tr_b16 a[246:247], v213 offset:40960
    s_add_u32 m0, s39, 77824
    v_mfma_f32_16x16x32_bf16 v[28:31], a[220:223], a[188:191], v[28:31]
    ds_read_b64_tr_b16 a[216:217], v214 offset:28672
    v_mfma_f32_16x16x32_bf16 v[24:27], a[220:223], a[184:187], v[24:27]
    ds_read_b64_tr_b16 a[218:219], v214 offset:40960
    v_mfma_f32_16x16x32_bf16 v[0:3], a[224:227], a[192:195], v[0:3]
    ds_read_b64_tr_b16 a[220:221], v215 offset:28672
    buffer_load_dwordx4 v224, s[24:27], s56 offen offset:0  lds
    v_mfma_f32_16x16x32_bf16 v[4:7], a[224:227], a[196:199], v[4:7]
    ds_read_b64_tr_b16 a[222:223], v215 offset:40960
    v_mfma_f32_16x16x32_bf16 v[12:15], a[228:231], a[196:199], v[12:15]
    ds_read_b64_tr_b16 a[224:225], v212 offset:29696
    v_mfma_f32_16x16x32_bf16 v[8:11], a[228:231], a[192:195], v[8:11]
    ds_read_b64_tr_b16 a[226:227], v212 offset:41984
    s_waitcnt lgkmcnt(6)
    v_mfma_f32_16x16x32_bf16 v[16:19], a[232:235], a[192:195], v[16:19]
    ds_read_b64_tr_b16 a[228:229], v213 offset:29696
    v_mfma_f32_16x16x32_bf16 v[20:23], a[232:235], a[196:199], v[20:23]
    ds_read_b64_tr_b16 a[230:231], v213 offset:41984
    v_mfma_f32_16x16x32_bf16 v[28:31], a[236:239], a[196:199], v[28:31]
    ds_read_b64_tr_b16 a[232:233], v214 offset:29696
    v_mfma_f32_16x16x32_bf16 v[24:27], a[236:239], a[192:195], v[24:27]
    ds_read_b64_tr_b16 a[234:235], v214 offset:41984
    v_mfma_f32_16x16x32_bf16 v[0:3], a[240:243], a[200:203], v[0:3]
    ds_read_b64_tr_b16 a[236:237], v215 offset:29696
    buffer_load_dwordx4 v225, s[24:27], s58 offen offset:1024  lds
    v_mfma_f32_16x16x32_bf16 v[4:7], a[240:243], a[204:207], v[4:7]
    ds_read_b64_tr_b16 a[238:239], v215 offset:41984
    v_mfma_f32_16x16x32_bf16 v[12:15], a[244:247], a[204:207], v[12:15]
    s_barrier
    v_add_u32 v212, 0xfffe8000, v212
    ds_read_b64_tr_b16 a[240:241], v212 offset:0
    v_mfma_f32_16x16x32_bf16 v[8:11], a[244:247], a[200:203], v[8:11]
    ds_read_b64_tr_b16 a[242:243], v212 offset:12288
    s_waitcnt lgkmcnt(6)
    v_mfma_f32_16x16x32_bf16 v[16:19], a[216:219], a[200:203], v[16:19]
    v_add_u32 v213, 0xfffe8000, v213
    ds_read_b64_tr_b16 a[244:245], v213 offset:0
    v_mfma_f32_16x16x32_bf16 v[20:23], a[216:219], a[204:207], v[20:23]
    ds_read_b64_tr_b16 a[246:247], v213 offset:12288
    v_mfma_f32_16x16x32_bf16 v[28:31], a[220:223], a[204:207], v[28:31]
    v_add_u32 v214, 0xfffe8000, v214
    ds_read_b64_tr_b16 a[216:217], v214 offset:0
    s_add_u32 m0, s39, 98304
    v_mfma_f32_16x16x32_bf16 v[24:27], a[220:223], a[200:203], v[24:27]
    ds_read_b64_tr_b16 a[218:219], v214 offset:12288
    v_mfma_f32_16x16x32_bf16 v[0:3], a[224:227], a[208:211], v[0:3]
    v_add_u32 v215, 0xfffe8000, v215
    ds_read_b64_tr_b16 a[220:221], v215 offset:0
    v_mfma_f32_16x16x32_bf16 v[4:7], a[224:227], a[212:215], v[4:7]
    ds_read_b64_tr_b16 a[222:223], v215 offset:12288
    buffer_load_dwordx4 v224, s[24:27], s60 offen offset:0  lds
    v_mfma_f32_16x16x32_bf16 v[12:15], a[228:231], a[212:215], v[12:15]
    ds_read_b64_tr_b16 a[224:225], v212 offset:1024
    v_mfma_f32_16x16x32_bf16 v[8:11], a[228:231], a[208:211], v[8:11]
    ds_read_b64_tr_b16 a[226:227], v212 offset:13312
    s_waitcnt lgkmcnt(6)
    v_mfma_f32_16x16x32_bf16 v[16:19], a[232:235], a[208:211], v[16:19]
    ds_read_b64_tr_b16 a[228:229], v213 offset:1024
    v_mfma_f32_16x16x32_bf16 v[20:23], a[232:235], a[212:215], v[20:23]
    ds_read_b64_tr_b16 a[230:231], v213 offset:13312
    v_mfma_f32_16x16x32_bf16 v[28:31], a[236:239], a[212:215], v[28:31]
    ds_read_b64_tr_b16 a[232:233], v214 offset:1024
    v_mfma_f32_16x16x32_bf16 v[24:27], a[236:239], a[208:211], v[24:27]
    ds_read_b64_tr_b16 a[234:235], v214 offset:13312
    v_mfma_f32_16x16x32_bf16 v[32:35], a[240:243], v[128:131], 0
    ds_read_b64_tr_b16 a[236:237], v215 offset:1024
    v_mfma_f32_16x16x32_bf16 v[36:39], a[240:243], v[132:135], 0
    ds_read_b64_tr_b16 a[238:239], v215 offset:13312
    buffer_load_dwordx4 v225, s[24:27], s62 offen offset:1024  lds
    v_mfma_f32_16x16x32_bf16 v[44:47], a[244:247], v[132:135], 0
    ds_read_b64_tr_b16 a[240:241], v212 offset:2048
    v_mfma_f32_16x16x32_bf16 v[40:43], a[244:247], v[128:131], 0
    ds_read_b64_tr_b16 a[242:243], v212 offset:14336
    s_waitcnt lgkmcnt(6)
    v_mfma_f32_16x16x32_bf16 v[48:51], a[216:219], v[128:131], 0
    ds_read_b64_tr_b16 a[244:245], v213 offset:2048
    s_add_u32 s80, s71, 2
    s_and_b32 s80, s80, 3
    s_lshl_b32 s80, s80, 12
    s_add_u32 s80, s80, s79
    v_mfma_f32_16x16x32_bf16 v[52:55], a[216:219], v[132:135], 0
    ds_read_b64_tr_b16 a[246:247], v213 offset:14336
    v_cvt_pk_bf16_f32 v0, v0, v1
    v_mfma_f32_16x16x32_bf16 v[60:63], a[220:223], v[132:135], 0
    ds_read_b64_tr_b16 a[216:217], v214 offset:2048
    v_cvt_pk_bf16_f32 v1, v2, v3
    v_mfma_f32_16x16x32_bf16 v[56:59], a[220:223], v[128:131], 0
    ds_read_b64_tr_b16 a[218:219], v214 offset:14336
    v_cvt_pk_bf16_f32 v2, v8, v9
    v_mfma_f32_16x16x32_bf16 v[32:35], a[224:227], v[136:139], v[32:35]
    ds_read_b64_tr_b16 a[220:221], v215 offset:2048
    v_cvt_pk_bf16_f32 v3, v10, v11
    v_mfma_f32_16x16x32_bf16 v[36:39], a[224:227], v[140:143], v[36:39]
    ds_read_b64_tr_b16 a[222:223], v215 offset:14336
    buffer_load_dwordx4 v226, s[24:27], s73 offen offset:2048  lds
    v_cvt_pk_bf16_f32 v4, v4, v5
    v_mfma_f32_16x16x32_bf16 v[44:47], a[228:231], v[140:143], v[44:47]
    ds_read_b64_tr_b16 a[224:225], v212 offset:3072
    v_accvgpr_read_b32 v228, a249
    v_cvt_pk_bf16_f32 v5, v6, v7
    v_mfma_f32_16x16x32_bf16 v[40:43], a[228:231], v[136:139], v[40:43]
    ds_read_b64_tr_b16 a[226:227], v212 offset:15360
    v_add_u32 v228, s90, v228
    v_cvt_pk_bf16_f32 v6, v12, v13
    s_waitcnt lgkmcnt(6)
    v_mfma_f32_16x16x32_bf16 v[48:51], a[232:235], v[136:139], v[48:51]
    ds_read_b64_tr_b16 a[228:229], v213 offset:3072
    v_subrev_u32 v229, 1024, v228
    v_mfma_f32_16x16x32_bf16 v[52:55], a[232:235], v[140:143], v[52:55]
    ds_read_b64_tr_b16 a[230:231], v213 offset:15360
    v_cvt_pk_bf16_f32 v7, v14, v15
    v_cvt_pk_bf16_f32 v16, v16, v17
    v_mfma_f32_16x16x32_bf16 v[60:63], a[236:239], v[140:143], v[60:63]
    ds_read_b64_tr_b16 a[232:233], v214 offset:3072
    v_subrev_u32 v230, 2048, v228
    v_cvt_pk_bf16_f32 v17, v18, v19
    v_mfma_f32_16x16x32_bf16 v[56:59], a[236:239], v[136:139], v[56:59]
    ds_read_b64_tr_b16 a[234:235], v214 offset:15360
    v_subrev_u32 v231, 3072, v228
    v_cvt_pk_bf16_f32 v18, v24, v25
    v_cvt_pk_bf16_f32 v19, v26, v27
    v_mfma_f32_16x16x32_bf16 v[32:35], a[240:243], v[144:147], v[32:35]
    ds_read_b64_tr_b16 a[236:237], v215 offset:3072
    s_xor_b32 s69, s78, 0
    s_mul_i32 s69, s69, 41472
    v_mfma_f32_16x16x32_bf16 v[36:39], a[240:243], v[148:151], v[36:39]
    ds_read_b64_tr_b16 a[238:239], v215 offset:15360
    buffer_load_dwordx4 v231, s[12:15], s69 offen offset:3072  lds
    v_cvt_pk_bf16_f32 v20, v20, v21
    v_mfma_f32_16x16x32_bf16 v[44:47], a[244:247], v[148:151], v[44:47]
    ds_read_b64_tr_b16 a[240:241], v212 offset:4096
    v_cvt_pk_bf16_f32 v21, v22, v23
    v_cvt_pk_bf16_f32 v22, v28, v29
    v_mfma_f32_16x16x32_bf16 v[40:43], a[244:247], v[144:147], v[40:43]
    ds_read_b64_tr_b16 a[242:243], v212 offset:16384
    s_add_u32 m0, s39, 102400
    v_cvt_pk_bf16_f32 v23, v30, v31
    s_waitcnt lgkmcnt(6)
    v_mfma_f32_16x16x32_bf16 v[48:51], a[216:219], v[144:147], v[48:51]
    ds_read_b64_tr_b16 a[244:245], v213 offset:4096
    v_mfma_f32_16x16x32_bf16 v[52:55], a[216:219], v[148:151], v[52:55]
    ds_read_b64_tr_b16 a[246:247], v213 offset:16384
    v_mfma_f32_16x16x32_bf16 v[60:63], a[220:223], v[148:151], v[60:63]
    ds_read_b64_tr_b16 a[216:217], v214 offset:4096
    s_xor_b32 s69, s78, 1
    s_mul_i32 s69, s69, 41472
    v_mfma_f32_16x16x32_bf16 v[56:59], a[220:223], v[144:147], v[56:59]
    ds_read_b64_tr_b16 a[218:219], v214 offset:16384
    buffer_store_dwordx4 v[0:3], v208, s[32:35], s80 offen offset:0 sc1
    v_mfma_f32_16x16x32_bf16 v[32:35], a[224:227], v[152:155], v[32:35]
    ds_read_b64_tr_b16 a[220:221], v215 offset:4096
    buffer_load_dwordx4 v228, s[12:15], s69 offen offset:0  lds
    v_mfma_f32_16x16x32_bf16 v[36:39], a[224:227], v[156:159], v[36:39]
    ds_read_b64_tr_b16 a[222:223], v215 offset:16384
    v_mfma_f32_16x16x32_bf16 v[44:47], a[228:231], v[156:159], v[44:47]
    ds_read_b64_tr_b16 a[224:225], v212 offset:5120
    v_mfma_f32_16x16x32_bf16 v[40:43], a[228:231], v[152:155], v[40:43]
    ds_read_b64_tr_b16 a[226:227], v212 offset:17408
    s_waitcnt lgkmcnt(6)
    v_mfma_f32_16x16x32_bf16 v[48:51], a[232:235], v[152:155], v[48:51]
    ds_read_b64_tr_b16 a[228:229], v213 offset:5120
    s_xor_b32 s69, s78, 2
    s_mul_i32 s69, s69, 41472
    v_mfma_f32_16x16x32_bf16 v[52:55], a[232:235], v[156:159], v[52:55]
    ds_read_b64_tr_b16 a[230:231], v213 offset:17408
    buffer_store_dwordx4 v[4:7], v208, s[32:35], s80 offen offset:2048 sc1
    v_mfma_f32_16x16x32_bf16 v[60:63], a[236:239], v[156:159], v[60:63]
    ds_read_b64_tr_b16 a[232:233], v214 offset:5120
    v_mfma_f32_16x16x32_bf16 v[56:59], a[236:239], v[152:155], v[56:59]
    ds_read_b64_tr_b16 a[234:235], v214 offset:17408
    v_mfma_f32_16x16x32_bf16 v[32:35], a[240:243], v[160:163], v[32:35]
    ds_read_b64_tr_b16 a[236:237], v215 offset:5120
    buffer_load_dwordx4 v229, s[12:15], s69 offen offset:1024  lds
    v_mfma_f32_16x16x32_bf16 v[36:39], a[240:243], v[164:167], v[36:39]
    ds_read_b64_tr_b16 a[238:239], v215 offset:17408
    buffer_store_dwordx4 v[16:19], v208, s[32:35], s80 offen offset:1024 sc1
    v_mfma_f32_16x16x32_bf16 v[44:47], a[244:247], v[164:167], v[44:47]
    s_barrier
    ds_read_b64_tr_b16 a[240:241], v212 offset:24576
    v_mfma_f32_16x16x32_bf16 v[40:43], a[244:247], v[160:163], v[40:43]
    ds_read_b64_tr_b16 a[242:243], v212 offset:36864
    s_waitcnt lgkmcnt(6)
    v_mfma_f32_16x16x32_bf16 v[48:51], a[216:219], v[160:163], v[48:51]
    ds_read_b64_tr_b16 a[244:245], v213 offset:24576
    s_add_u32 m0, s39, 122880
    v_mfma_f32_16x16x32_bf16 v[52:55], a[216:219], v[164:167], v[52:55]
    ds_read_b64_tr_b16 a[246:247], v213 offset:36864
    v_mfma_f32_16x16x32_bf16 v[60:63], a[220:223], v[164:167], v[60:63]
    ds_read_b64_tr_b16 a[216:217], v214 offset:24576
    v_mfma_f32_16x16x32_bf16 v[56:59], a[220:223], v[160:163], v[56:59]
    ds_read_b64_tr_b16 a[218:219], v214 offset:36864
    s_xor_b32 s69, s78, 3
    s_mul_i32 s69, s69, 41472
    v_mfma_f32_16x16x32_bf16 v[32:35], a[224:227], v[168:171], v[32:35]
    ds_read_b64_tr_b16 a[220:221], v215 offset:24576
    buffer_store_dwordx4 v[20:23], v208, s[32:35], s80 offen offset:3072 sc1
    v_mfma_f32_16x16x32_bf16 v[36:39], a[224:227], v[172:175], v[36:39]
    ds_read_b64_tr_b16 a[222:223], v215 offset:36864
    buffer_load_dwordx4 v228, s[12:15], s69 offen offset:0  lds
    v_mfma_f32_16x16x32_bf16 v[44:47], a[228:231], v[172:175], v[44:47]
    ds_read_b64_tr_b16 a[224:225], v212 offset:25600
    v_mfma_f32_16x16x32_bf16 v[40:43], a[228:231], v[168:171], v[40:43]
    ds_read_b64_tr_b16 a[226:227], v212 offset:37888
    s_waitcnt lgkmcnt(6)
    v_mfma_f32_16x16x32_bf16 v[48:51], a[232:235], v[168:171], v[48:51]
    ds_read_b64_tr_b16 a[228:229], v213 offset:25600
    v_mfma_f32_16x16x32_bf16 v[52:55], a[232:235], v[172:175], v[52:55]
    ds_read_b64_tr_b16 a[230:231], v213 offset:37888
    s_xor_b32 s69, s78, 4
    s_mul_i32 s69, s69, 41472
    v_mfma_f32_16x16x32_bf16 v[60:63], a[236:239], v[172:175], v[60:63]
    ds_read_b64_tr_b16 a[232:233], v214 offset:25600
    v_mfma_f32_16x16x32_bf16 v[56:59], a[236:239], v[168:171], v[56:59]
    ds_read_b64_tr_b16 a[234:235], v214 offset:37888
    v_mfma_f32_16x16x32_bf16 v[32:35], a[240:243], v[176:179], v[32:35]
    ds_read_b64_tr_b16 a[236:237], v215 offset:25600
    v_mfma_f32_16x16x32_bf16 v[36:39], a[240:243], v[180:183], v[36:39]
    ds_read_b64_tr_b16 a[238:239], v215 offset:37888
    buffer_load_dwordx4 v229, s[12:15], s69 offen offset:1024  lds
    v_mfma_f32_16x16x32_bf16 v[44:47], a[244:247], v[180:183], v[44:47]
    ds_read_b64_tr_b16 a[240:241], v212 offset:26624
    v_mfma_f32_16x16x32_bf16 v[40:43], a[244:247], v[176:179], v[40:43]
    ds_read_b64_tr_b16 a[242:243], v212 offset:38912
    s_waitcnt lgkmcnt(6)
    v_mfma_f32_16x16x32_bf16 v[48:51], a[216:219], v[176:179], v[48:51]
    ds_read_b64_tr_b16 a[244:245], v213 offset:26624
    v_mfma_f32_16x16x32_bf16 v[52:55], a[216:219], v[180:183], v[52:55]
    ds_read_b64_tr_b16 a[246:247], v213 offset:38912
    s_xor_b32 s69, s78, 5
    s_mul_i32 s69, s69, 41472
    v_mfma_f32_16x16x32_bf16 v[60:63], a[220:223], v[180:183], v[60:63]
    ds_read_b64_tr_b16 a[216:217], v214 offset:26624
    v_mfma_f32_16x16x32_bf16 v[56:59], a[220:223], v[176:179], v[56:59]
    ds_read_b64_tr_b16 a[218:219], v214 offset:38912
    v_mfma_f32_16x16x32_bf16 v[32:35], a[224:227], v[184:187], v[32:35]
    ds_read_b64_tr_b16 a[220:221], v215 offset:26624
    v_mfma_f32_16x16x32_bf16 v[36:39], a[224:227], v[188:191], v[36:39]
    ds_read_b64_tr_b16 a[222:223], v215 offset:38912
    buffer_load_dwordx4 v230, s[12:15], s69 offen offset:2048  lds
    v_mfma_f32_16x16x32_bf16 v[44:47], a[228:231], v[188:191], v[44:47]
    ds_read_b64_tr_b16 a[224:225], v212 offset:27648
    v_mfma_f32_16x16x32_bf16 v[40:43], a[228:231], v[184:187], v[40:43]
    ds_read_b64_tr_b16 a[226:227], v212 offset:39936
    s_waitcnt lgkmcnt(6)
    v_mfma_f32_16x16x32_bf16 v[48:51], a[232:235], v[184:187], v[48:51]
    ds_read_b64_tr_b16 a[228:229], v213 offset:27648
    v_mfma_f32_16x16x32_bf16 v[52:55], a[232:235], v[188:191], v[52:55]
    ds_read_b64_tr_b16 a[230:231], v213 offset:39936
    s_xor_b32 s69, s78, 6
    s_mul_i32 s69, s69, 41472
    v_mfma_f32_16x16x32_bf16 v[60:63], a[236:239], v[188:191], v[60:63]
    ds_read_b64_tr_b16 a[232:233], v214 offset:27648
    v_mfma_f32_16x16x32_bf16 v[56:59], a[236:239], v[184:187], v[56:59]
    ds_read_b64_tr_b16 a[234:235], v214 offset:39936
    buffer_load_dword v253, v250, s[32:35], s94 offen sc1
    v_mfma_f32_16x16x32_bf16 v[32:35], a[240:243], v[192:195], v[32:35]
    ds_read_b64_tr_b16 a[236:237], v215 offset:27648
    v_mfma_f32_16x16x32_bf16 v[36:39], a[240:243], v[196:199], v[36:39]
    ds_read_b64_tr_b16 a[238:239], v215 offset:39936
    buffer_load_dwordx4 v231, s[12:15], s69 offen offset:3072  lds
    v_mfma_f32_16x16x32_bf16 v[44:47], a[244:247], v[196:199], v[44:47]
    ds_read_b64_tr_b16 a[240:241], v212 offset:28672
    v_mfma_f32_16x16x32_bf16 v[40:43], a[244:247], v[192:195], v[40:43]
    ds_read_b64_tr_b16 a[242:243], v212 offset:40960
    s_add_u32 m0, s39, 126976
    s_waitcnt lgkmcnt(6)
    v_mfma_f32_16x16x32_bf16 v[48:51], a[216:219], v[192:195], v[48:51]
    ds_read_b64_tr_b16 a[244:245], v213 offset:28672
    v_mfma_f32_16x16x32_bf16 v[52:55], a[216:219], v[196:199], v[52:55]
    ds_read_b64_tr_b16 a[246:247], v213 offset:40960
    v_mfma_f32_16x16x32_bf16 v[60:63], a[220:223], v[196:199], v[60:63]
    ds_read_b64_tr_b16 a[216:217], v214 offset:28672
    s_xor_b32 s69, s78, 7
    s_mul_i32 s69, s69, 41472
    v_mfma_f32_16x16x32_bf16 v[56:59], a[220:223], v[192:195], v[56:59]
    ds_read_b64_tr_b16 a[218:219], v214 offset:40960
    v_mfma_f32_16x16x32_bf16 v[32:35], a[224:227], a[144:147], v[32:35]
    ds_read_b64_tr_b16 a[220:221], v215 offset:28672
    buffer_load_dwordx4 v228, s[12:15], s69 offen offset:0  lds
    v_mfma_f32_16x16x32_bf16 v[36:39], a[224:227], a[148:151], v[36:39]
    ds_read_b64_tr_b16 a[222:223], v215 offset:40960
    v_mfma_f32_16x16x32_bf16 v[44:47], a[228:231], a[148:151], v[44:47]
    ds_read_b64_tr_b16 a[224:225], v212 offset:29696
    v_mfma_f32_16x16x32_bf16 v[40:43], a[228:231], a[144:147], v[40:43]
    ds_read_b64_tr_b16 a[226:227], v212 offset:41984
    s_waitcnt lgkmcnt(6)
    v_mfma_f32_16x16x32_bf16 v[48:51], a[232:235], a[144:147], v[48:51]
    ds_read_b64_tr_b16 a[228:229], v213 offset:29696
    s_xor_b32 s69, s78, 8
    s_mul_i32 s69, s69, 41472
    v_mfma_f32_16x16x32_bf16 v[52:55], a[232:235], a[148:151], v[52:55]
    ds_read_b64_tr_b16 a[230:231], v213 offset:41984
    v_mfma_f32_16x16x32_bf16 v[60:63], a[236:239], a[148:151], v[60:63]
    ds_read_b64_tr_b16 a[232:233], v214 offset:29696
    v_mfma_f32_16x16x32_bf16 v[56:59], a[236:239], a[144:147], v[56:59]
    ds_read_b64_tr_b16 a[234:235], v214 offset:41984
    v_mfma_f32_16x16x32_bf16 v[32:35], a[240:243], a[152:155], v[32:35]
    ds_read_b64_tr_b16 a[236:237], v215 offset:29696
    buffer_load_dwordx4 v229, s[12:15], s69 offen offset:1024  lds
    v_mfma_f32_16x16x32_bf16 v[36:39], a[240:243], a[156:159], v[36:39]
    ds_read_b64_tr_b16 a[238:239], v215 offset:41984
    v_mfma_f32_16x16x32_bf16 v[44:47], a[244:247], a[156:159], v[44:47]
    s_waitcnt vmcnt(24)
    s_waitcnt vmcnt(7)
    s_barrier
    v_add_u32 v212, 0xc000, v212
    ds_read_b64_tr_b16 a[240:241], v212 offset:0
    s_add_u32 s42, s40, 8
    v_mov_b32 v254, s42
    buffer_store_dword v254, v255, s[32:35], s47 offen sc1
    v_mfma_f32_16x16x32_bf16 v[40:43], a[244:247], a[152:155], v[40:43]
    ds_read_b64_tr_b16 a[242:243], v212 offset:12288
    s_waitcnt lgkmcnt(6)
    v_mfma_f32_16x16x32_bf16 v[48:51], a[216:219], a[152:155], v[48:51]
    v_add_u32 v213, 0xc000, v213
    ds_read_b64_tr_b16 a[244:245], v213 offset:0
    s_add_u32 m0, s39, 0
    v_mfma_f32_16x16x32_bf16 v[52:55], a[216:219], a[156:159], v[52:55]
    ds_read_b64_tr_b16 a[246:247], v213 offset:12288
    v_mfma_f32_16x16x32_bf16 v[60:63], a[220:223], a[156:159], v[60:63]
    v_add_u32 v214, 0xc000, v214
    ds_read_b64_tr_b16 a[216:217], v214 offset:0
    v_mfma_f32_16x16x32_bf16 v[56:59], a[220:223], a[152:155], v[56:59]
    ds_read_b64_tr_b16 a[218:219], v214 offset:12288
    s_xor_b32 s69, s78, 9
    s_mul_i32 s69, s69, 41472
    v_mfma_f32_16x16x32_bf16 v[32:35], a[224:227], a[160:163], v[32:35]
    v_add_u32 v215, 0xc000, v215
    ds_read_b64_tr_b16 a[220:221], v215 offset:0
    v_mfma_f32_16x16x32_bf16 v[36:39], a[224:227], a[164:167], v[36:39]
    ds_read_b64_tr_b16 a[222:223], v215 offset:12288
    buffer_load_dwordx4 v228, s[12:15], s69 offen offset:0  lds
    v_mfma_f32_16x16x32_bf16 v[44:47], a[228:231], a[164:167], v[44:47]
    ds_read_b64_tr_b16 a[224:225], v212 offset:1024
    v_mfma_f32_16x16x32_bf16 v[40:43], a[228:231], a[160:163], v[40:43]
    ds_read_b64_tr_b16 a[226:227], v212 offset:13312
    s_waitcnt lgkmcnt(6)
    v_mfma_f32_16x16x32_bf16 v[48:51], a[232:235], a[160:163], v[48:51]
    ds_read_b64_tr_b16 a[228:229], v213 offset:1024
    v_mfma_f32_16x16x32_bf16 v[52:55], a[232:235], a[164:167], v[52:55]
    ds_read_b64_tr_b16 a[230:231], v213 offset:13312
    s_xor_b32 s69, s78, 10
    s_mul_i32 s69, s69, 41472
    v_mfma_f32_16x16x32_bf16 v[60:63], a[236:239], a[164:167], v[60:63]
    ds_read_b64_tr_b16 a[232:233], v214 offset:1024
    v_mfma_f32_16x16x32_bf16 v[56:59], a[236:239], a[160:163], v[56:59]
    ds_read_b64_tr_b16 a[234:235], v214 offset:13312
    v_mfma_f32_16x16x32_bf16 v[32:35], a[240:243], a[168:171], v[32:35]
    ds_read_b64_tr_b16 a[236:237], v215 offset:1024
    v_mfma_f32_16x16x32_bf16 v[36:39], a[240:243], a[172:175], v[36:39]
    ds_read_b64_tr_b16 a[238:239], v215 offset:13312
    buffer_load_dwordx4 v229, s[12:15], s69 offen offset:1024  lds
    v_mfma_f32_16x16x32_bf16 v[44:47], a[244:247], a[172:175], v[44:47]
    ds_read_b64_tr_b16 a[240:241], v212 offset:2048
    v_mfma_f32_16x16x32_bf16 v[40:43], a[244:247], a[168:171], v[40:43]
    ds_read_b64_tr_b16 a[242:243], v212 offset:14336
    s_waitcnt lgkmcnt(6)
    v_mfma_f32_16x16x32_bf16 v[48:51], a[216:219], a[168:171], v[48:51]
    ds_read_b64_tr_b16 a[244:245], v213 offset:2048
    v_mfma_f32_16x16x32_bf16 v[52:55], a[216:219], a[172:175], v[52:55]
    ds_read_b64_tr_b16 a[246:247], v213 offset:14336
    s_xor_b32 s69, s78, 11
    s_mul_i32 s69, s69, 41472
    v_mfma_f32_16x16x32_bf16 v[60:63], a[220:223], a[172:175], v[60:63]
    ds_read_b64_tr_b16 a[216:217], v214 offset:2048
    v_mfma_f32_16x16x32_bf16 v[56:59], a[220:223], a[168:171], v[56:59]
    ds_read_b64_tr_b16 a[218:219], v214 offset:14336
    v_mfma_f32_16x16x32_bf16 v[32:35], a[224:227], a[176:179], v[32:35]
    ds_read_b64_tr_b16 a[220:221], v215 offset:2048
    v_mfma_f32_16x16x32_bf16 v[36:39], a[224:227], a[180:183], v[36:39]
    ds_read_b64_tr_b16 a[222:223], v215 offset:14336
    buffer_load_dwordx4 v230, s[12:15], s69 offen offset:2048  lds
    v_mfma_f32_16x16x32_bf16 v[44:47], a[228:231], a[180:183], v[44:47]
    ds_read_b64_tr_b16 a[224:225], v212 offset:3072
    v_mfma_f32_16x16x32_bf16 v[40:43], a[228:231], a[176:179], v[40:43]
    ds_read_b64_tr_b16 a[226:227], v212 offset:15360
    s_waitcnt lgkmcnt(6)
    v_mfma_f32_16x16x32_bf16 v[48:51], a[232:235], a[176:179], v[48:51]
    ds_read_b64_tr_b16 a[228:229], v213 offset:3072
    v_mfma_f32_16x16x32_bf16 v[52:55], a[232:235], a[180:183], v[52:55]
    ds_read_b64_tr_b16 a[230:231], v213 offset:15360
    s_xor_b32 s69, s78, 12
    s_mul_i32 s69, s69, 41472
    v_mfma_f32_16x16x32_bf16 v[60:63], a[236:239], a[180:183], v[60:63]
    ds_read_b64_tr_b16 a[232:233], v214 offset:3072
    v_mfma_f32_16x16x32_bf16 v[56:59], a[236:239], a[176:179], v[56:59]
    ds_read_b64_tr_b16 a[234:235], v214 offset:15360
    v_mfma_f32_16x16x32_bf16 v[32:35], a[240:243], a[184:187], v[32:35]
    ds_read_b64_tr_b16 a[236:237], v215 offset:3072
    v_mfma_f32_16x16x32_bf16 v[36:39], a[240:243], a[188:191], v[36:39]
    ds_read_b64_tr_b16 a[238:239], v215 offset:15360
    buffer_load_dwordx4 v231, s[12:15], s69 offen offset:3072  lds
    v_mfma_f32_16x16x32_bf16 v[44:47], a[244:247], a[188:191], v[44:47]
    ds_read_b64_tr_b16 a[240:241], v212 offset:4096
    v_mfma_f32_16x16x32_bf16 v[40:43], a[244:247], a[184:187], v[40:43]
    ds_read_b64_tr_b16 a[242:243], v212 offset:16384
    s_add_u32 m0, s39, 4096
    s_waitcnt lgkmcnt(6)
    v_mfma_f32_16x16x32_bf16 v[48:51], a[216:219], a[184:187], v[48:51]
    ds_read_b64_tr_b16 a[244:245], v213 offset:4096
    v_cmp_ge_u32 s[0:1], 1, v206
    s_add_u32 s42, s40, 7
    s_waitcnt vmcnt(8)
    v_subrev_u32 v253, s42, v253
    v_cmp_ge_u32 vcc, 8, v253
    s_nop 1
    s_orn2_b64 vcc, vcc, s[0:1]
    s_cmp_eq_u64 vcc, exec
    s_cbranch_scc0 L_poll6_slow
L_poll6_ok:
    v_mfma_f32_16x16x32_bf16 v[52:55], a[216:219], a[188:191], v[52:55]
    ds_read_b64_tr_b16 a[246:247], v213 offset:16384
    s_sub_u32 s89, s88, 0
    s_and_b32 s89, s89, 3
    s_mul_i32 s89, s89, 73728
    s_add_u32 s89, s89, s87
    v_mfma_f32_16x16x32_bf16 v[60:63], a[220:223], a[188:191], v[60:63]
    ds_read_b64_tr_b16 a[216:217], v214 offset:4096
    s_xor_b32 s69, s78, 13
    s_mul_i32 s69, s69, 41472
    buffer_load_dwordx4 v[0:3], v208, s[32:35], s89 offen offset:0 sc1
    v_mfma_f32_16x16x32_bf16 v[56:59], a[220:223], a[184:187], v[56:59]
    ds_read_b64_tr_b16 a[218:219], v214 offset:16384
    buffer_load_dwordx4 v[4:7], v208, s[32:35], s89 offen offset:1024 sc1
    v_mfma_f32_16x16x32_bf16 v[32:35], a[224:227], a[192:195], v[32:35]
    ds_read_b64_tr_b16 a[220:221], v215 offset:4096
    buffer_load_dwordx4 v228, s[12:15], s69 offen offset:0  lds
    v_mfma_f32_16x16x32_bf16 v[36:39], a[224:227], a[196:199], v[36:39]
    ds_read_b64_tr_b16 a[222:223], v215 offset:16384
    s_add_u32 s89, s89, 294912
    v_mfma_f32_16x16x32_bf16 v[44:47], a[228:231], a[196:199], v[44:47]
    ds_read_b64_tr_b16 a[224:225], v212 offset:5120
    buffer_load_dwordx4 v[8:11], v208, s[32:35], s89 offen offset:0 sc1
    v_mfma_f32_16x16x32_bf16 v[40:43], a[228:231], a[192:195], v[40:43]
    ds_read_b64_tr_b16 a[226:227], v212 offset:17408
    buffer_load_dwordx4 v[12:15], v208, s[32:35], s89 offen offset:1024 sc1
    s_sub_u32 s89, s88, 1
    s_and_b32 s89, s89, 3
    s_mul_i32 s89, s89, 73728
    s_add_u32 s89, s89, s87
    s_waitcnt lgkmcnt(6)
    v_mfma_f32_16x16x32_bf16 v[48:51], a[232:235], a[192:195], v[48:51]
    ds_read_b64_tr_b16 a[228:229], v213 offset:5120
    s_xor_b32 s69, s78, 14
    s_mul_i32 s69, s69, 41472
    v_mfma_f32_16x16x32_bf16 v[52:55], a[232:235], a[196:199], v[52:55]
    ds_read_b64_tr_b16 a[230:231], v213 offset:17408
    buffer_load_dwordx4 v[16:19], v208, s[32:35], s89 offen offset:0 sc1
    v_mfma_f32_16x16x32_bf16 v[60:63], a[236:239], a[196:199], v[60:63]
    ds_read_b64_tr_b16 a[232:233], v214 offset:5120
    buffer_load_dwordx4 v[20:23], v208, s[32:35], s89 offen offset:1024 sc1
    v_mfma_f32_16x16x32_bf16 v[56:59], a[236:239], a[192:195], v[56:59]
    ds_read_b64_tr_b16 a[234:235], v214 offset:17408
    s_add_u32 s89, s89, 294912
    v_mfma_f32_16x16x32_bf16 v[32:35], a[240:243], a[200:203], v[32:35]
    ds_read_b64_tr_b16 a[236:237], v215 offset:5120
    buffer_load_dwordx4 v229, s[12:15], s69 offen offset:1024  lds
    v_mfma_f32_16x16x32_bf16 v[36:39], a[240:243], a[204:207], v[36:39]
    ds_read_b64_tr_b16 a[238:239], v215 offset:17408
    buffer_load_dwordx4 v[24:27], v208, s[32:35], s89 offen offset:0 sc1
    buffer_load_dwordx4 v[28:31], v208, s[32:35], s89 offen offset:1024 sc1
    v_mfma_f32_16x16x32_bf16 v[44:47], a[244:247], a[204:207], v[44:47]
    s_barrier
    ds_read_b64_tr_b16 a[240:241], v216 offset:24576
    v_mfma_f32_16x16x32_bf16 v[40:43], a[244:247], a[200:203], v[40:43]
    ds_read_b64_tr_b16 a[242:243], v216 offset:30720
    buffer_load_dword v253, v250, s[32:35], s94 offen sc1
    s_waitcnt lgkmcnt(6)
    v_mfma_f32_16x16x32_bf16 v[48:51], a[216:219], a[200:203], v[48:51]
    ds_read_b64_tr_b16 a[244:245], v217 offset:24576
    v_mfma_f32_16x16x32_bf16 v[52:55], a[216:219], a[204:207], v[52:55]
    ds_read_b64_tr_b16 a[246:247], v217 offset:30720
    v_mfma_f32_16x16x32_bf16 v[60:63], a[220:223], a[204:207], v[60:63]
    ds_read_b64_tr_b16 a[216:217], v216 offset:36864
    s_add_u32 m0, s39, 24576
    v_mfma_f32_16x16x32_bf16 v[56:59], a[220:223], a[200:203], v[56:59]
    ds_read_b64_tr_b16 a[218:219], v216 offset:43008
    v_mfma_f32_16x16x32_bf16 v[32:35], a[224:227], a[208:211], v[32:35]
    ds_read_b64_tr_b16 a[220:221], v217 offset:36864
    v_mfma_f32_16x16x32_bf16 v[36:39], a[224:227], a[212:215], v[36:39]
    ds_read_b64_tr_b16 a[222:223], v217 offset:43008
    v_mfma_f32_16x16x32_bf16 v[44:47], a[228:231], a[212:215], v[44:47]
    ds_read_b64_tr_b16 a[224:225], v216 offset:25600
    v_mfma_f32_16x16x32_bf16 v[40:43], a[228:231], a[208:211], v[40:43]
    ds_read_b64_tr_b16 a[226:227], v216 offset:31744
    s_waitcnt lgkmcnt(6)
    v_mfma_f32_16x16x32_bf16 v[48:51], a[232:235], a[208:211], v[48:51]
    ds_read_b64_tr_b16 a[228:229], v217 offset:25600
    s_xor_b32 s69, s78, 15
    s_mul_i32 s69, s69, 41472
    v_mfma_f32_16x16x32_bf16 v[52:55], a[232:235], a[212:215], v[52:55]
    ds_read_b64_tr_b16 a[230:231], v217 offset:31744
    v_mfma_f32_16x16x32_bf16 v[60:63], a[236:239], a[212:215], v[60:63]
    ds_read_b64_tr_b16 a[232:233], v216 offset:37888
    v_mfma_f32_16x16x32_bf16 v[56:59], a[236:239], a[208:211], v[56:59]
    ds_read_b64_tr_b16 a[234:235], v216 offset:44032
    v_mfma_f32_16x16x32_bf16 v[64:67], a[240:243], v[128:131], 0
    ds_read_b64_tr_b16 a[236:237], v217 offset:37888
    buffer_load_dwordx4 v228, s[12:15], s69 offen offset:0  lds
    v_mfma_f32_16x16x32_bf16 v[68:71], a[240:243], v[132:135], 0
    ds_read_b64_tr_b16 a[238:239], v217 offset:44032
    v_lshrrev_b32 v251, 5, v209
    v_mfma_f32_16x16x32_bf16 v[76:79], a[244:247], v[132:135], 0
    ds_read_b64_tr_b16 a[240:241], v216 offset:26624
    v_mfma_f32_16x16x32_bf16 v[72:75], a[244:247], v[128:131], 0
    ds_read_b64_tr_b16 a[242:243], v216 offset:32768
    s_lshl_b32 s70, s36, 1
    s_add_u32 s70, s70, 1
    v_add_u32 v251, s70, v251
    s_waitcnt lgkmcnt(6)
    v_mfma_f32_16x16x32_bf16 v[64:67], a[216:219], v[136:139], v[64:67]
    ds_read_b64_tr_b16 a[244:245], v217 offset:26624
    s_add_u32 s80, s71, 3
    s_and_b32 s80, s80, 3
    s_lshl_b32 s80, s80, 12
    s_add_u32 s80, s80, s79
    v_mfma_f32_16x16x32_bf16 v[68:71], a[216:219], v[140:143], v[68:71]
    ds_read_b64_tr_b16 a[246:247], v217 offset:32768
    v_mul_u32_u24 v251, 36864, v251
    v_mfma_f32_16x16x32_bf16 v[76:79], a[220:223], v[140:143], v[76:79]
    ds_read_b64_tr_b16 a[216:217], v216 offset:38912
    v_cvt_pk_bf16_f32 v32, v32, v33
    v_cvt_pk_bf16_f32 v33, v34, v35
    v_mfma_f32_16x16x32_bf16 v[72:75], a[220:223], v[136:139], v[72:75]
    ds_read_b64_tr_b16 a[218:219], v216 offset:45056
    v_add_u32 v228, v228, v251
    v_cvt_pk_bf16_f32 v34, v40, v41
    v_mfma_f32_16x16x32_bf16 v[64:67], a[224:227], v[144:147], v[64:67]
    ds_read_b64_tr_b16 a[220:221], v217 offset:38912
    v_add_u32 v229, v229, v251
    v_mfma_f32_16x16x32_bf16 v[68:71], a[224:227], v[148:151], v[68:71]
    ds_read_b64_tr_b16 a[222:223], v217 offset:45056
    v_cvt_pk_bf16_f32 v35, v42, v43
    v_cvt_pk_bf16_f32 v36, v36, v37
    v_mfma_f32_16x16x32_bf16 v[76:79], a[228:231], v[148:151], v[76:79]
    ds_read_b64_tr_b16 a[224:225], v216 offset:27648
    v_add_u32 v230, v230, v251
    v_mfma_f32_16x16x32_bf16 v[72:75], a[228:231], v[144:147], v[72:75]
    ds_read_b64_tr_b16 a[226:227], v216 offset:33792
    v_cvt_pk_bf16_f32 v37, v38, v39
    v_cvt_pk_bf16_f32 v38, v44, v45
    s_waitcnt lgkmcnt(6)
    v_mfma_f32_16x16x32_bf16 v[64:67], a[232:235], v[152:155], v[64:67]
    ds_read_b64_tr_b16 a[228:229], v217 offset:27648
    v_add_u32 v231, v231, v251
    v_mfma_f32_16x16x32_bf16 v[68:71], a[232:235], v[156:159], v[68:71]
    ds_read_b64_tr_b16 a[230:231], v217 offset:33792
    v_cvt_pk_bf16_f32 v39, v46, v47
    v_cvt_pk_bf16_f32 v48, v48, v49
    v_mfma_f32_16x16x32_bf16 v[76:79], a[236:239], v[156:159], v[76:79]
    ds_read_b64_tr_b16 a[232:233], v216 offset:39936
    s_mov_b32 s69, 0
    v_cvt_pk_bf16_f32 v49, v50, v51
    v_mfma_f32_16x16x32_bf16 v[72:75], a[236:239], v[152:155], v[72:75]
    ds_read_b64_tr_b16 a[234:235], v216 offset:46080
    buffer_load_dwordx4 v229, s[12:15], s69 offen offset:1024  lds
    v_cvt_pk_bf16_f32 v50, v56, v57
    v_mfma_f32_16x16x32_bf16 v[64:67], a[240:243], v[160:163], v[64:67]
    ds_read_b64_tr_b16 a[236:237], v217 offset:39936
    v_cvt_pk_bf16_f32 v51, v58, v59
    v_mfma_f32_16x16x32_bf16 v[68:71], a[240:243], v[164:167], v[68:71]
    ds_read_b64_tr_b16 a[238:239], v217 offset:46080
    v_cvt_pk_bf16_f32 v52, v52, v53
    v_mfma_f32_16x16x32_bf16 v[76:79], a[244:247], v[164:167], v[76:79]
    ds_read_b64_tr_b16 a[240:241], v216 offset:28672
    v_cvt_pk_bf16_f32 v53, v54, v55
    v_mfma_f32_16x16x32_bf16 v[72:75], a[244:247], v[160:163], v[72:75]
    ds_read_b64_tr_b16 a[242:243], v216 offset:34816
    v_cvt_pk_bf16_f32 v54, v60, v61
    v_cvt_pk_bf16_f32 v55, v62, v63
    s_waitcnt lgkmcnt(6)
    v_mfma_f32_16x16x32_bf16 v[64:67], a[216:219], v[168:171], v[64:67]
    ds_read_b64_tr_b16 a[244:245], v217 offset:28672
    v_mfma_f32_16x16x32_bf16 v[68:71], a[216:219], v[172:175], v[68:71]
    ds_read_b64_tr_b16 a[246:247], v217 offset:34816
    v_mfma_f32_16x16x32_bf16 v[76:79], a[220:223], v[172:175], v[76:79]
    ds_read_b64_tr_b16 a[216:217], v216 offset:40960
    v_mfma_f32_16x16x32_bf16 v[72:75], a[220:223], v[168:171], v[72:75]
    ds_read_b64_tr_b16 a[218:219], v216 offset:47104
    s_mov_b32 s69, 331776
    v_mfma_f32_16x16x32_bf16 v[64:67], a[224:227], v[176:179], v[64:67]
    ds_read_b64_tr_b16 a[220:221], v217 offset:40960
    v_mfma_f32_16x16x32_bf16 v[68:71], a[224:227], v[180:183], v[68:71]
    ds_read_b64_tr_b16 a[222:223], v217 offset:47104
    v_mfma_f32_16x16x32_bf16 v[76:79], a[228:231], v[180:183], v[76:79]
    ds_read_b64_tr_b16 a[224:225], v216 offset:29696
    v_mfma_f32_16x16x32_bf16 v[72:75], a[228:231], v[176:179], v[72:75]
    ds_read_b64_tr_b16 a[226:227], v216 offset:35840
    s_waitcnt lgkmcnt(6)
    v_mfma_f32_16x16x32_bf16 v[64:67], a[232:235], v[184:187], v[64:67]
    ds_read_b64_tr_b16 a[228:229], v217 offset:29696
    v_mfma_f32_16x16x32_bf16 v[68:71], a[232:235], v[188:191], v[68:71]
    ds_read_b64_tr_b16 a[230:231], v217 offset:35840
    v_mfma_f32_16x16x32_bf16 v[76:79], a[236:239], v[188:191], v[76:79]
    ds_read_b64_tr_b16 a[232:233], v216 offset:41984
    v_mfma_f32_16x16x32_bf16 v[72:75], a[236:239], v[184:187], v[72:75]
    ds_read_b64_tr_b16 a[234:235], v216 offset:48128
    buffer_load_dwordx4 v230, s[12:15], s69 offen offset:2048  lds
    v_mfma_f32_16x16x32_bf16 v[64:67], a[240:243], a[144:147], v[64:67]
    ds_read_b64_tr_b16 a[236:237], v217 offset:41984
    v_mfma_f32_16x16x32_bf16 v[68:71], a[240:243], a[148:151], v[68:71]
    ds_read_b64_tr_b16 a[238:239], v217 offset:48128
    v_mfma_f32_16x16x32_bf16 v[76:79], a[244:247], a[148:151], v[76:79]
    s_barrier
    v_add_u32 v216, 0xc000, v216
    ds_read_b64_tr_b16 a[240:241], v216 offset:0
    v_mfma_f32_16x16x32_bf16 v[72:75], a[244:247], a[144:147], v[72:75]
    ds_read_b64_tr_b16 a[242:243], v216 offset:6144
    s_waitcnt lgkmcnt(6)
    v_mfma_f32_16x16x32_bf16 v[64:67], a[216:219], a[152:155], v[64:67]
    v_add_u32 v217, 0xc000, v217
    ds_read_b64_tr_b16 a[244:245], v217 offset:0
    v_mfma_f32_16x16x32_bf16 v[68:71], a[216:219], a[156:159], v[68:71]
    ds_read_b64_tr_b16 a[246:247], v217 offset:6144
    v_mfma_f32_16x16x32_bf16 v[76:79], a[220:223], a[156:159], v[76:79]
    ds_read_b64_tr_b16 a[216:217], v216 offset:12288
    buffer_store_dwordx4 v[32:35], v208, s[32:35], s80 offen offset:0 sc1
    v_mfma_f32_16x16x32_bf16 v[72:75], a[220:223], a[152:155], v[72:75]
    ds_read_b64_tr_b16 a[218:219], v216 offset:18432
    v_mfma_f32_16x16x32_bf16 v[64:67], a[224:227], a[160:163], v[64:67]
    ds_read_b64_tr_b16 a[220:221], v217 offset:12288
    v_mfma_f32_16x16x32_bf16 v[68:71], a[224:227], a[164:167], v[68:71]
    ds_read_b64_tr_b16 a[222:223], v217 offset:18432
    v_mfma_f32_16x16x32_bf16 v[76:79], a[228:231], a[164:167], v[76:79]
    ds_read_b64_tr_b16 a[224:225], v216 offset:1024
    buffer_store_dwordx4 v[36:39], v208, s[32:35], s80 offen offset:2048 sc1
    v_mfma_f32_16x16x32_bf16 v[72:75], a[228:231], a[160:163], v[72:75]
    ds_read_b64_tr_b16 a[226:227], v216 offset:7168
    s_waitcnt lgkmcnt(6)
    v_mfma_f32_16x16x32_bf16 v[64:67], a[232:235], a[168:171], v[64:67]
    ds_read_b64_tr_b16 a[228:229], v217 offset:1024
    v_mfma_f32_16x16x32_bf16 v[68:71], a[232:235], a[172:175], v[68:71]
    ds_read_b64_tr_b16 a[230:231], v217 offset:7168
    v_mfma_f32_16x16x32_bf16 v[76:79], a[236:239], a[172:175], v[76:79]
    ds_read_b64_tr_b16 a[232:233], v216 offset:13312
    v_mfma_f32_16x16x32_bf16 v[72:75], a[236:239], a[168:171], v[72:75]
    ds_read_b64_tr_b16 a[234:235], v216 offset:19456
    buffer_store_dwordx4 v[48:51], v208, s[32:35], s80 offen offset:1024 sc1
    v_mfma_f32_16x16x32_bf16 v[64:67], a[240:243], a[176:179], v[64:67]
    ds_read_b64_tr_b16 a[236:237], v217 offset:13312
    v_mfma_f32_16x16x32_bf16 v[68:71], a[240:243], a[180:183], v[68:71]
    ds_read_b64_tr_b16 a[238:239], v217 offset:19456
    v_mfma_f32_16x16x32_bf16 v[76:79], a[244:247], a[180:183], v[76:79]
    ds_read_b64_tr_b16 a[240:241], v216 offset:2048
    v_mfma_f32_16x16x32_bf16 v[72:75], a[244:247], a[176:179], v[72:75]
    ds_read_b64_tr_b16 a[242:243], v216 offset:8192
    buffer_store_dwordx4 v[52:55], v208, s[32:35], s80 offen offset:3072 sc1
    s_waitcnt lgkmcnt(6)
    v_mfma_f32_16x16x32_bf16 v[64:67], a[216:219], a[184:187], v[64:67]
    ds_read_b64_tr_b16 a[244:245], v217 offset:2048
    v_mfma_f32_16x16x32_bf16 v[68:71], a[216:219], a[188:191], v[68:71]
    ds_read_b64_tr_b16 a[246:247], v217 offset:8192
    v_mfma_f32_16x16x32_bf16 v[76:79], a[220:223], a[188:191], v[76:79]
    ds_read_b64_tr_b16 a[216:217], v216 offset:14336
    v_mfma_f32_16x16x32_bf16 v[72:75], a[220:223], a[184:187], v[72:75]
    ds_read_b64_tr_b16 a[218:219], v216 offset:20480
    v_mfma_f32_16x16x32_bf16 v[64:67], a[224:227], a[192:195], v[64:67]
    ds_read_b64_tr_b16 a[220:221], v217 offset:14336
    v_mfma_f32_16x16x32_bf16 v[68:71], a[224:227], a[196:199], v[68:71]
    ds_read_b64_tr_b16 a[222:223], v217 offset:20480
    v_mfma_f32_16x16x32_bf16 v[76:79], a[228:231], a[196:199], v[76:79]
    v_add_u32 v212, 0xc000, v212
    ds_read_b64_tr_b16 a[224:225], v212 offset:3072
    v_mfma_f32_16x16x32_bf16 v[72:75], a[228:231], a[192:195], v[72:75]
    ds_read_b64_tr_b16 a[226:227], v212 offset:15360
    s_waitcnt lgkmcnt(6)
    v_mfma_f32_16x16x32_bf16 v[64:67], a[232:235], a[200:203], v[64:67]
    v_add_u32 v213, 0xc000, v213
    ds_read_b64_tr_b16 a[228:229], v213 offset:3072
    v_mfma_f32_16x16x32_bf16 v[68:71], a[232:235], a[204:207], v[68:71]
    ds_read_b64_tr_b16 a[230:231], v213 offset:15360
    v_mfma_f32_16x16x32_bf16 v[76:79], a[236:239], a[204:207], v[76:79]
    v_add_u32 v214, 0xc000, v214
    ds_read_b64_tr_b16 a[232:233], v214 offset:3072
    v_mfma_f32_16x16x32_bf16 v[72:75], a[236:239], a[200:203], v[72:75]
    ds_read_b64_tr_b16 a[234:235], v214 offset:15360
    v_mfma_f32_16x16x32_bf16 v[64:67], a[240:243], v[192:195], v[64:67]
    v_add_u32 v215, 0xc000, v215
    ds_read_b64_tr_b16 a[236:237], v215 offset:3072
    v_mfma_f32_16x16x32_bf16 v[68:71], a[240:243], v[196:199], v[68:71]
    ds_read_b64_tr_b16 a[238:239], v215 offset:15360
    v_mfma_f32_16x16x32_bf16 v[76:79], a[244:247], v[196:199], v[76:79]
    ds_read_b64_tr_b16 a[240:241], v218 offset:0
    v_mfma_f32_16x16x32_bf16 v[72:75], a[244:247], v[192:195], v[72:75]
    ds_read_b64_tr_b16 a[242:243], v218 offset:256
    s_waitcnt lgkmcnt(6)
    v_mfma_f32_16x16x32_bf16 v[64:67], a[216:219], a[208:211], v[64:67]
    ds_read_b64_tr_b16 a[244:245], v212 offset:4096
    v_mfma_f32_16x16x32_bf16 v[68:71], a[216:219], a[212:215], v[68:71]
    ds_read_b64_tr_b16 a[246:247], v212 offset:16384
    v_mfma_f32_16x16x32_bf16 v[76:79], a[220:223], a[212:215], v[76:79]
    ds_read_b64_tr_b16 a[216:217], v213 offset:4096
    v_mfma_f32_16x16x32_bf16 v[72:75], a[220:223], a[208:211], v[72:75]
    ds_read_b64_tr_b16 a[218:219], v213 offset:16384
    v_mfma_f32_16x16x32_bf16 v[96:99], a[224:227], a[0:3], 0
    ds_read_b64_tr_b16 a[220:221], v214 offset:4096
    ds_read_b64_tr_b16 a[222:223], v214 offset:16384
    v_mfma_f32_16x16x32_bf16 v[100:103], a[228:231], a[0:3], 0
    ds_read_b64_tr_b16 a[224:225], v215 offset:4096
    ds_read_b64_tr_b16 a[226:227], v215 offset:16384
    s_waitcnt lgkmcnt(10)
    v_mfma_f32_16x16x32_bf16 v[104:107], a[232:235], a[0:3], 0
    ds_read_b64_tr_b16 a[228:229], v218 offset:512
    ds_read_b64_tr_b16 a[230:231], v218 offset:768
    v_mfma_f32_16x16x32_bf16 v[108:111], a[236:239], a[0:3], 0
    ds_read_b64_tr_b16 a[232:233], v212 offset:5120
    ds_read_b64_tr_b16 a[234:235], v212 offset:17408
    s_add_u32 s80, s79, 16384
    s_waitcnt lgkmcnt(10)
    v_mfma_f32_16x16x32_bf16 v[112:115], a[240:243], a[0:3], 0
    ds_read_b64_tr_b16 a[236:237], v213 offset:5120
    ds_read_b64_tr_b16 a[238:239], v213 offset:17408
    v_cvt_pk_bf16_f32 v64, v64, v65
    v_mfma_f32_16x16x32_bf16 v[96:99], a[244:247], a[4:7], v[96:99]
    ds_read_b64_tr_b16 a[240:241], v214 offset:5120
    ds_read_b64_tr_b16 a[242:243], v214 offset:17408
    v_cvt_pk_bf16_f32 v65, v66, v67
    s_waitcnt lgkmcnt(10)
    v_mfma_f32_16x16x32_bf16 v[100:103], a[216:219], a[4:7], v[100:103]
    ds_read_b64_tr_b16 a[244:245], v215 offset:5120
    ds_read_b64_tr_b16 a[246:247], v215 offset:17408
    v_cvt_pk_bf16_f32 v66, v72, v73
    v_mfma_f32_16x16x32_bf16 v[104:107], a[220:223], a[4:7], v[104:107]
    ds_read_b64_tr_b16 a[216:217], v218 offset:1024
    ds_read_b64_tr_b16 a[218:219], v218 offset:1280
    v_cvt_pk_bf16_f32 v67, v74, v75
    s_waitcnt lgkmcnt(10)
    v_mfma_f32_16x16x32_bf16 v[108:111], a[224:227], a[4:7], v[108:111]
    s_waitcnt vmcnt(23)
    s_barrier
    ds_read_b64_tr_b16 a[220:221], v212 offset:24576
    ds_read_b64_tr_b16 a[222:223], v212 offset:36864
    v_cvt_pk_bf16_f32 v68, v68, v69
    v_cvt_pk_bf16_f32 v69, v70, v71
    v_cvt_pk_bf16_f32 v70, v76, v77
    v_cvt_pk_bf16_f32 v71, v78, v79
    v_mfma_f32_16x16x32_bf16 v[112:115], a[228:231], a[4:7], v[112:115]
    ds_read_b64_tr_b16 a[224:225], v213 offset:24576
    ds_read_b64_tr_b16 a[226:227], v213 offset:36864
    s_waitcnt lgkmcnt(10)
    v_mfma_f32_16x16x32_bf16 v[96:99], a[232:235], a[8:11], v[96:99]
    ds_read_b64_tr_b16 a[228:229], v214 offset:24576
    ds_read_b64_tr_b16 a[230:231], v214 offset:36864
    buffer_store_dwordx4 v[64:67], v208, s[32:35], s80 offen offset:0 sc1
    v_mfma_f32_16x16x32_bf16 v[100:103], a[236:239], a[8:11], v[100:103]
    ds_read_b64_tr_b16 a[232:233], v215 offset:24576
    ds_read_b64_tr_b16 a[234:235], v215 offset:36864
    s_waitcnt lgkmcnt(10)
    v_mfma_f32_16x16x32_bf16 v[104:107], a[240:243], a[8:11], v[104:107]
    ds_read_b64_tr_b16 a[236:237], v218 offset:1536
    ds_read_b64_tr_b16 a[238:239], v218 offset:1792
    v_mfma_f32_16x16x32_bf16 v[108:111], a[244:247], a[8:11], v[108:111]
    ds_read_b64_tr_b16 a[240:241], v212 offset:25600
    ds_read_b64_tr_b16 a[242:243], v212 offset:37888
    s_waitcnt lgkmcnt(10)
    v_mfma_f32_16x16x32_bf16 v[112:115], a[216:219], a[8:11], v[112:115]
    ds_read_b64_tr_b16 a[244:245], v213 offset:25600
    ds_read_b64_tr_b16 a[246:247], v213 offset:37888
    buffer_store_dwordx4 v[68:71], v208, s[32:35], s80 offen offset:1024 sc1
    v_mfma_f32_16x16x32_bf16 v[96:99], a[220:223], a[12:15], v[96:99]
    ds_read_b64_tr_b16 a[216:217], v214 offset:25600
    ds_read_b64_tr_b16 a[218:219], v214 offset:37888
    ds_write_b128 v204, a[72:75]
    s_waitcnt lgkmcnt(11)
    v_mfma_f32_16x16x32_bf16 v[100:103], a[224:227], a[12:15], v[100:103]
    ds_read_b64_tr_b16 a[220:221], v215 offset:25600
    ds_read_b64_tr_b16 a[222:223], v215 offset:37888
    v_mfma_f32_16x16x32_bf16 v[104:107], a[228:231], a[12:15], v[104:107]
    ds_read_b64_tr_b16 a[224:225], v218 offset:2048
    ds_read_b64_tr_b16 a[226:227], v218 offset:2304
    ds_write_b128 v204, a[76:79] offset:1152
    s_waitcnt lgkmcnt(12)
    v_mfma_f32_16x16x32_bf16 v[108:111], a[232:235], a[12:15], v[108:111]
    ds_read_b64_tr_b16 a[228:229], v212 offset:26624
    ds_read_b64_tr_b16 a[230:231], v212 offset:38912
    v_mfma_f32_16x16x32_bf16 v[112:115], a[236:239], a[12:15], v[112:115]
    ds_read_b64_tr_b16 a[232:233], v213 offset:26624
    ds_read_b64_tr_b16 a[234:235], v213 offset:38912
    s_mov_b64 exec, 0xffff
    ds_write_b128 v205, a[80:83]
    s_mov_b64 exec, -1
    s_waitcnt lgkmcnt(13)
    v_mfma_f32_16x16x32_bf16 v[96:99], a[240:243], a[16:19], v[96:99]
    ds_read_b64_tr_b16 a[236:237], v214 offset:26624
    ds_read_b64_tr_b16 a[238:239], v214 offset:38912
    v_mfma_f32_16x16x32_bf16 v[100:103], a[244:247], a[16:19], v[100:103]
    ds_read_b64_tr_b16 a[240:241], v215 offset:26624
    ds_read_b64_tr_b16 a[242:243], v215 offset:38912
    ds_read_b64 v[80:81], v203 offset:0
    s_waitcnt lgkmcnt(13)
    v_mfma_f32_16x16x32_bf16 v[104:107], a[216:219], a[16:19], v[104:107]
    ds_read_b64_tr_b16 a[244:245], v218 offset:2560
    ds_read_b64_tr_b16 a[246:247], v218 offset:2816
    v_mfma_f32_16x16x32_bf16 v[108:111], a[220:223], a[16:19], v[108:111]
    ds_read_b64_tr_b16 a[216:217], v212 offset:27648
    ds_read_b64_tr_b16 a[218:219], v212 offset:39936
    ds_read_b64 v[82:83], v203 offset:32
    s_waitcnt lgkmcnt(13)
    v_mfma_f32_16x16x32_bf16 v[112:115], a[224:227], a[16:19], v[112:115]
    ds_read_b64_tr_b16 a[220:221], v213 offset:27648
    ds_read_b64_tr_b16 a[222:223], v213 offset:39936
    ds_read_b64 v[84:85], v203 offset:64
    v_mfma_f32_16x16x32_bf16 v[96:99], a[228:231], a[20:23], v[96:99]
    ds_read_b64_tr_b16 a[224:225], v214 offset:27648
    ds_read_b64_tr_b16 a[226:227], v214 offset:39936
    s_waitcnt lgkmcnt(13)
    v_mfma_f32_16x16x32_bf16 v[100:103], a[232:235], a[20:23], v[100:103]
    ds_read_b64_tr_b16 a[228:229], v215 offset:27648
    ds_read_b64_tr_b16 a[230:231], v215 offset:39936
    ds_read_b64 v[86:87], v203 offset:96
    v_mfma_f32_16x16x32_bf16 v[104:107], a[236:239], a[20:23], v[104:107]
    ds_read_b64_tr_b16 a[232:233], v218 offset:3072
    ds_read_b64_tr_b16 a[234:235], v218 offset:3328
    s_waitcnt lgkmcnt(13)
    v_mfma_f32_16x16x32_bf16 v[108:111], a[240:243], a[20:23], v[108:111]
    ds_read_b64_tr_b16 a[236:237], v212 offset:28672
    ds_read_b64_tr_b16 a[238:239], v212 offset:40960
    ds_read_b64 v[88:89], v203 offset:128
    v_mfma_f32_16x16x32_bf16 v[112:115], a[244:247], a[20:23], v[112:115]
    ds_read_b64_tr_b16 a[240:241], v213 offset:28672
    ds_read_b64_tr_b16 a[242:243], v213 offset:40960
    s_waitcnt lgkmcnt(13)
    v_mfma_f32_16x16x32_bf16 v[96:99], a[216:219], a[24:27], v[96:99]
    ds_read_b64_tr_b16 a[244:245], v214 offset:28672
    ds_read_b64_tr_b16 a[246:247], v214 offset:40960
    v_cmp_eq_u32 s[0:1], 2, v206
    s_add_u32 s42, s40, 8
    s_waitcnt vmcnt(9)
    v_subrev_u32 v253, s42, v253
    v_cmp_ge_u32 vcc, 7, v253
    s_nop 1
    s_orn2_b64 vcc, vcc, s[0:1]
    s_cmp_eq_u64 vcc, exec
    s_cbranch_scc0 L_poll7_slow
L_poll7_ok:
    v_mul_f32 v211, 0xbfb8aa3b, v210
    v_mfma_f32_16x16x32_bf16 v[100:103], a[220:223], a[24:27], v[100:103]
    ds_read_b64_tr_b16 a[216:217], v215 offset:28672
    ds_read_b64_tr_b16 a[218:219], v215 offset:40960
    s_waitcnt lgkmcnt(12)
    v_mfma_f32_16x16x32_bf16 v[104:107], a[224:227], a[24:27], v[104:107]
    ds_read_b64_tr_b16 a[220:221], v218 offset:3584
    ds_read_b64_tr_b16 a[222:223], v218 offset:3840
    s_sub_u32 s89, s88, 2
    s_and_b32 s89, s89, 3
    s_mul_i32 s89, s89, 73728
    s_add_u32 s89, s89, s87
    v_mfma_f32_16x16x32_bf16 v[108:111], a[228:231], a[24:27], v[108:111]
    ds_read_b64_tr_b16 a[224:225], v212 offset:29696
    ds_read_b64_tr_b16 a[226:227], v212 offset:41984
    s_waitcnt lgkmcnt(11)
    v_mfma_f32_16x16x32_bf16 v[112:115], a[232:235], a[24:27], v[112:115]
    ds_read_b64_tr_b16 a[228:229], v213 offset:29696
    ds_read_b64_tr_b16 a[230:231], v213 offset:41984
    buffer_load_dwordx4 v[160:163], v208, s[32:35], s89 offen offset:0 sc1
    v_mfma_f32_16x16x32_bf16 v[96:99], a[236:239], a[28:31], v[96:99]
    ds_read_b64_tr_b16 a[232:233], v214 offset:29696
    ds_read_b64_tr_b16 a[234:235], v214 offset:41984
    s_waitcnt lgkmcnt(10)
    v_mfma_f32_16x16x32_bf16 v[100:103], a[240:243], a[28:31], v[100:103]
    ds_read_b64_tr_b16 a[236:237], v215 offset:29696
    ds_read_b64_tr_b16 a[238:239], v215 offset:41984
    buffer_load_dwordx4 v[164:167], v208, s[32:35], s89 offen offset:1024 sc1
    v_mfma_f32_16x16x32_bf16 v[104:107], a[244:247], a[28:31], v[104:107]
    ds_read_b64_tr_b16 a[240:241], v218 offset:4096
    ds_read_b64_tr_b16 a[242:243], v218 offset:4352
    s_waitcnt lgkmcnt(10)
    v_mfma_f32_16x16x32_bf16 v[108:111], a[216:219], a[28:31], v[108:111]
    s_waitcnt vmcnt(4)
    s_waitcnt vmcnt(2)
    s_barrier
    v_add_u32 v212, 0xfffe8000, v212
    ds_read_b64_tr_b16 a[244:245], v212 offset:0
    ds_read_b64_tr_b16 a[246:247], v212 offset:12288
    s_add_u32 s42, s40, 9
    v_mov_b32 v254, s42
    buffer_store_dword v254, v255, s[32:35], s47 offen sc1
    s_add_u32 s89, s89, 294912
    v_mfma_f32_16x16x32_bf16 v[112:115], a[220:223], a[28:31], v[112:115]
    v_add_u32 v213, 0xfffe8000, v213
    ds_read_b64_tr_b16 a[216:217], v213 offset:0
    ds_read_b64_tr_b16 a[218:219], v213 offset:12288
    v_mfma_f32_4x4x4_16b_bf16 v[128:131], v[248:249], v[80:81], 0
    s_waitcnt lgkmcnt(10)
    v_mfma_f32_16x16x32_bf16 v[96:99], a[224:227], a[32:35], v[96:99]
    v_add_u32 v214, 0xfffe8000, v214
    ds_read_b64_tr_b16 a[220:221], v214 offset:0
    ds_read_b64_tr_b16 a[222:223], v214 offset:12288
    buffer_load_dwordx4 v[168:171], v208, s[32:35], s89 offen offset:0 sc1
    v_mfma_f32_16x16x32_bf16 v[100:103], a[228:231], a[32:35], v[100:103]
    v_add_u32 v215, 0xfffe8000, v215
    ds_read_b64_tr_b16 a[224:225], v215 offset:0
    ds_read_b64_tr_b16 a[226:227], v215 offset:12288
    v_mfma_f32_4x4x4_16b_bf16 v[132:135], v[248:249], v[82:83], 0
    s_waitcnt lgkmcnt(10)
    v_mfma_f32_16x16x32_bf16 v[104:107], a[232:235], a[32:35], v[104:107]
    ds_read_b64_tr_b16 a[228:229], v218 offset:4608
    ds_read_b64_tr_b16 a[230:231], v218 offset:4864
    buffer_load_dwordx4 v[172:175], v208, s[32:35], s89 offen offset:1024 sc1
    v_mfma_f32_16x16x32_bf16 v[108:111], a[236:239], a[32:35], v[108:111]
    ds_read_b64_tr_b16 a[232:233], v212 offset:1024
    ds_read_b64_tr_b16 a[234:235], v212 offset:13312
    v_mfma_f32_4x4x4_16b_bf16 v[136:139], v[248:249], v[84:85], 0
    s_waitcnt lgkmcnt(10)
    v_mfma_f32_16x16x32_bf16 v[112:115], a[240:243], a[32:35], v[112:115]
    ds_read_b64_tr_b16 a[236:237], v213 offset:1024
    ds_read_b64_tr_b16 a[238:239], v213 offset:13312
    v_mfma_f32_4x4x4_16b_bf16 v[140:143], v[248:249], v[86:87], 0
    v_mfma_f32_16x16x32_bf16 v[96:99], a[244:247], a[36:39], v[96:99]
    ds_read_b64_tr_b16 a[240:241], v214 offset:1024
    ds_read_b64_tr_b16 a[242:243], v214 offset:13312
    s_waitcnt lgkmcnt(10)
    v_mfma_f32_16x16x32_bf16 v[100:103], a[216:219], a[36:39], v[100:103]
    ds_read_b64_tr_b16 a[244:245], v215 offset:1024
    ds_read_b64_tr_b16 a[246:247], v215 offset:13312
    v_mfma_f32_4x4x4_16b_bf16 v[144:147], v[248:249], v[88:89], 0
    v_mfma_f32_16x16x32_bf16 v[104:107], a[220:223], a[36:39], v[104:107]
    ds_read_b64_tr_b16 a[216:217], v218 offset:5120
    ds_read_b64_tr_b16 a[218:219], v218 offset:5376
    s_waitcnt lgkmcnt(10)
    v_mfma_f32_16x16x32_bf16 v[108:111], a[224:227], a[36:39], v[108:111]
    ds_read_b64_tr_b16 a[220:221], v212 offset:2048
    ds_read_b64_tr_b16 a[222:223], v212 offset:14336
    v_mfma_f32_16x16x32_bf16 v[112:115], a[228:231], a[36:39], v[112:115]
    ds_read_b64_tr_b16 a[224:225], v213 offset:2048
    ds_read_b64_tr_b16 a[226:227], v213 offset:14336
    s_waitcnt lgkmcnt(10)
    v_mfma_f32_16x16x32_bf16 v[96:99], a[232:235], a[40:43], v[96:99]
    ds_read_b64_tr_b16 a[228:229], v214 offset:2048
    ds_read_b64_tr_b16 a[230:231], v214 offset:14336
    v_mfma_f32_16x16x32_bf16 v[100:103], a[236:239], a[40:43], v[100:103]
    ds_read_b64_tr_b16 a[232:233], v215 offset:2048
    ds_read_b64_tr_b16 a[234:235], v215 offset:14336
    v_mfma_f32_4x4x4_16b_bf16 v[232:235], v[248:249], v[0:1], 0
    s_waitcnt lgkmcnt(10)
    v_mfma_f32_16x16x32_bf16 v[104:107], a[240:243], a[40:43], v[104:107]
    ds_read_b64_tr_b16 a[236:237], v218 offset:5632
    ds_read_b64_tr_b16 a[238:239], v218 offset:5888
    v_mfma_f32_16x16x32_bf16 v[108:111], a[244:247], a[40:43], v[108:111]
    ds_read_b64_tr_b16 a[240:241], v212 offset:3072
    ds_read_b64_tr_b16 a[242:243], v212 offset:15360
    v_mfma_f32_4x4x4_16b_bf16 v[236:239], v[248:249], v[2:3], 0
    buffer_load_dword v253, v250, s[32:35], s94 offen sc1
    s_waitcnt lgkmcnt(10)
    v_mfma_f32_16x16x32_bf16 v[112:115], a[216:219], a[40:43], v[112:115]
    ds_read_b64_tr_b16 a[244:245], v213 offset:3072
    ds_read_b64_tr_b16 a[246:247], v213 offset:15360
    v_mfma_f32_16x16x32_bf16 v[96:99], a[220:223], a[44:47], v[96:99]
    ds_read_b64_tr_b16 a[216:217], v214 offset:3072
    ds_read_b64_tr_b16 a[218:219], v214 offset:15360
    v_mfma_f32_4x4x4_16b_bf16 v[240:243], v[248:249], v[4:5], 0
    s_waitcnt lgkmcnt(10)
    v_mfma_f32_16x16x32_bf16 v[100:103], a[224:227], a[44:47], v[100:103]
    ds_read_b64_tr_b16 a[220:221], v215 offset:3072
    ds_read_b64_tr_b16 a[222:223], v215 offset:15360
    v_mfma_f32_16x16x32_bf16 v[104:107], a[228:231], a[44:47], v[104:107]
    ds_read_b64_tr_b16 a[224:225], v218 offset:6144
    ds_read_b64_tr_b16 a[226:227], v218 offset:6400
    v_mfma_f32_4x4x4_16b_bf16 v[244:247], v[248:249], v[6:7], 0
    s_waitcnt lgkmcnt(10)
    v_mfma_f32_16x16x32_bf16 v[108:111], a[232:235], a[44:47], v[108:111]
    ds_read_b64_tr_b16 a[228:229], v212 offset:4096
    ds_read_b64_tr_b16 a[230:231], v212 offset:16384
    v_mfma_f32_16x16x32_bf16 v[112:115], a[236:239], a[44:47], v[112:115]
    ds_read_b64_tr_b16 a[232:233], v213 offset:4096
    ds_read_b64_tr_b16 a[234:235], v213 offset:16384
    v_mfma_f32_4x4x4_16b_bf16 v[232:235], v[248:249], v[8:9], v[232:235]
    s_waitcnt lgkmcnt(10)
    v_mfma_f32_16x16x32_bf16 v[96:99], a[240:243], a[48:51], v[96:99]
    ds_read_b64_tr_b16 a[236:237], v214 offset:4096
    ds_read_b64_tr_b16 a[238:239], v214 offset:16384
    v_mfma_f32_16x16x32_bf16 v[100:103], a[244:247], a[48:51], v[100:103]
    ds_read_b64_tr_b16 a[240:241], v215 offset:4096
    ds_read_b64_tr_b16 a[242:243], v215 offset:16384
    v_mfma_f32_4x4x4_16b_bf16 v[236:239], v[248:249], v[10:11], v[236:239]
    s_waitcnt lgkmcnt(10)
    v_mfma_f32_16x16x32_bf16 v[104:107], a[216:219], a[48:51], v[104:107]
    ds_read_b64_tr_b16 a[244:245], v218 offset:6656
    ds_read_b64_tr_b16 a[246:247], v218 offset:6912
    v_mfma_f32_16x16x32_bf16 v[108:111], a[220:223], a[48:51], v[108:111]
    ds_read_b64_tr_b16 a[216:217], v212 offset:5120
    ds_read_b64_tr_b16 a[218:219], v212 offset:17408
    v_mfma_f32_4x4x4_16b_bf16 v[240:243], v[248:249], v[12:13], v[240:243]
    s_waitcnt lgkmcnt(10)
    v_mfma_f32_16x16x32_bf16 v[112:115], a[224:227], a[48:51], v[112:115]
    ds_read_b64_tr_b16 a[220:221], v213 offset:5120
    ds_read_b64_tr_b16 a[222:223], v213 offset:17408
    v_mfma_f32_16x16x32_bf16 v[96:99], a[228:231], a[52:55], v[96:99]
    ds_read_b64_tr_b16 a[224:225], v214 offset:5120
    ds_read_b64_tr_b16 a[226:227], v214 offset:17408
    v_mfma_f32_4x4x4_16b_bf16 v[244:247], v[248:249], v[14:15], v[244:247]
    s_waitcnt lgkmcnt(10)
    v_mfma_f32_16x16x32_bf16 v[100:103], a[232:235], a[52:55], v[100:103]
    ds_read_b64_tr_b16 a[228:229], v215 offset:5120
    ds_read_b64_tr_b16 a[230:231], v215 offset:17408
    v_mfma_f32_16x16x32_bf16 v[104:107], a[236:239], a[52:55], v[104:107]
    ds_read_b64_tr_b16 a[232:233], v218 offset:7168
    ds_read_b64_tr_b16 a[234:235], v218 offset:7424
    s_waitcnt lgkmcnt(10)
    v_mfma_f32_16x16x32_bf16 v[108:111], a[240:243], a[52:55], v[108:111]
    s_barrier
    ds_read_b64_tr_b16 a[236:237], v212 offset:24576
    ds_read_b64_tr_b16 a[238:239], v212 offset:36864
    v_mfma_f32_4x4x4_16b_bf16 v[232:235], v[248:249], v[16:17], v[232:235]
    v_mfma_f32_16x16x32_bf16 v[112:115], a[244:247], a[52:55], v[112:115]
    ds_read_b64_tr_b16 a[240:241], v213 offset:24576
    ds_read_b64_tr_b16 a[242:243], v213 offset:36864
    s_waitcnt lgkmcnt(10)
    v_mfma_f32_16x16x32_bf16 v[96:99], a[216:219], a[56:59], v[96:99]
    ds_read_b64_tr_b16 a[244:245], v214 offset:24576
    ds_read_b64_tr_b16 a[246:247], v214 offset:36864
    v_mfma_f32_4x4x4_16b_bf16 v[236:239], v[248:249], v[18:19], v[236:239]
    v_mfma_f32_16x16x32_bf16 v[100:103], a[220:223], a[56:59], v[100:103]
    ds_read_b64_tr_b16 a[216:217], v215 offset:24576
    ds_read_b64_tr_b16 a[218:219], v215 offset:36864
    s_waitcnt lgkmcnt(10)
    v_mfma_f32_16x16x32_bf16 v[104:107], a[224:227], a[56:59], v[104:107]
    ds_read_b64_tr_b16 a[220:221], v218 offset:7680
    ds_read_b64_tr_b16 a[222:223], v218 offset:7936
    v_mfma_f32_4x4x4_16b_bf16 v[240:243], v[248:249], v[20:21], v[240:243]
    v_mfma_f32_16x16x32_bf16 v[108:111], a[228:231], a[56:59], v[108:111]
    ds_read_b64_tr_b16 a[224:225], v212 offset:25600
    ds_read_b64_tr_b16 a[226:227], v212 offset:37888
    s_waitcnt lgkmcnt(10)
    v_mfma_f32_16x16x32_bf16 v[112:115], a[232:235], a[56:59], v[112:115]
    ds_read_b64_tr_b16 a[228:229], v213 offset:25600
    ds_read_b64_tr_b16 a[230:231], v213 offset:37888
    v_mfma_f32_4x4x4_16b_bf16 v[244:247], v[248:249], v[22:23], v[244:247]
    v_mfma_f32_16x16x32_bf16 v[96:99], a[236:239], a[60:63], v[96:99]
    ds_read_b64_tr_b16 a[232:233], v214 offset:25600
    ds_read_b64_tr_b16 a[234:235], v214 offset:37888
    s_waitcnt lgkmcnt(10)
    v_mfma_f32_16x16x32_bf16 v[100:103], a[240:243], a[60:63], v[100:103]
    ds_read_b64_tr_b16 a[236:237], v215 offset:25600
    ds_read_b64_tr_b16 a[238:239], v215 offset:37888
    v_mfma_f32_4x4x4_16b_bf16 v[232:235], v[248:249], v[24:25], v[232:235]
    v_mfma_f32_16x16x32_bf16 v[104:107], a[244:247], a[60:63], v[104:107]
    ds_read_b64_tr_b16 a[240:241], v218 offset:8192
    ds_read_b64_tr_b16 a[242:243], v218 offset:8448
    s_add_u32 s42, s40, 9
    s_waitcnt vmcnt(0)
    v_subrev_u32 v253, s42, v253
    v_cmp_ge_u32 vcc, 6, v253
    s_nop 1
    s_cmp_eq_u64 vcc, exec
    s_cbranch_scc0 L_poll8_slow
L_poll8_ok:
    s_sub_u32 s89, s88, 3
    s_and_b32 s89, s89, 3
    s_mul_i32 s89, s89, 73728
    s_add_u32 s89, s89, s87
    s_waitcnt lgkmcnt(10)
    v_mfma_f32_16x16x32_bf16 v[108:111], a[216:219], a[60:63], v[108:111]
    ds_read_b64_tr_b16 a[244:245], v212 offset:26624
    ds_read_b64_tr_b16 a[246:247], v212 offset:38912
    v_mfma_f32_4x4x4_16b_bf16 v[236:239], v[248:249], v[26:27], v[236:239]
    v_mfma_f32_16x16x32_bf16 v[112:115], a[220:223], a[60:63], v[112:115]
    ds_read_b64_tr_b16 a[216:217], v213 offset:26624
    ds_read_b64_tr_b16 a[218:219], v213 offset:38912
    buffer_load_dwordx4 v[176:179], v208, s[32:35], s89 offen offset:0 sc1
    buffer_load_dwordx4 v[180:183], v208, s[32:35], s89 offen offset:1024 sc1
    s_waitcnt lgkmcnt(10)
    v_mfma_f32_16x16x32_bf16 v[96:99], a[224:227], a[64:67], v[96:99]
    ds_read_b64_tr_b16 a[220:221], v214 offset:26624
    ds_read_b64_tr_b16 a[222:223], v214 offset:38912
    v_mfma_f32_4x4x4_16b_bf16 v[240:243], v[248:249], v[28:29], v[240:243]
    v_mfma_f32_16x16x32_bf16 v[100:103], a[228:231], a[64:67], v[100:103]
    ds_read_b64_tr_b16 a[224:225], v215 offset:26624
    ds_read_b64_tr_b16 a[226:227], v215 offset:38912
    s_add_u32 s89, s89, 294912
    buffer_load_dwordx4 v[184:187], v208, s[32:35], s89 offen offset:0 sc1
    s_waitcnt lgkmcnt(10)
    v_mfma_f32_16x16x32_bf16 v[104:107], a[232:235], a[64:67], v[104:107]
    ds_read_b64_tr_b16 a[228:229], v218 offset:8704
    ds_read_b64_tr_b16 a[230:231], v218 offset:8960
    v_mfma_f32_4x4x4_16b_bf16 v[244:247], v[248:249], v[30:31], v[244:247]
    v_mfma_f32_16x16x32_bf16 v[108:111], a[236:239], a[64:67], v[108:111]
    buffer_load_dwordx4 v[188:191], v208, s[32:35], s89 offen offset:1024 sc1
    s_waitcnt lgkmcnt(8)
    v_mfma_f32_16x16x32_bf16 v[112:115], a[240:243], a[64:67], v[112:115]
    buffer_load_dwordx2 a[144:145], v202, s[32:35], s101 offen sc1
    v_mfma_f32_16x16x32_bf16 v[96:99], a[244:247], a[68:71], v[96:99]
    s_add_u32 s101, s101, 73728
    buffer_load_dwordx2 a[146:147], v202, s[32:35], s101 offen sc1
    s_waitcnt lgkmcnt(4)
    v_mfma_f32_16x16x32_bf16 v[100:103], a[216:219], a[68:71], v[100:103]
    s_add_u32 s101, s101, 73728
    buffer_load_dwordx2 a[148:149], v202, s[32:35], s101 offen sc1
    v_mfma_f32_16x16x32_bf16 v[104:107], a[220:223], a[68:71], v[104:107]
    s_add_u32 s101, s101, 73728
    buffer_load_dwordx2 a[150:151], v202, s[32:35], s101 offen sc1
    s_waitcnt lgkmcnt(0)
    v_mfma_f32_16x16x32_bf16 v[108:111], a[224:227], a[68:71], v[108:111]
    s_add_u32 s101, s101, 73728
    buffer_load_dwordx2 a[152:153], v202, s[32:35], s101 offen sc1
    v_mfma_f32_16x16x32_bf16 v[112:115], a[228:231], a[68:71], v[112:115]
    s_add_u32 s101, s101, 73728
    buffer_load_dwordx2 a[154:155], v202, s[32:35], s101 offen sc1
    s_add_u32 s101, s101, 73728
    buffer_load_dwordx2 a[156:157], v202, s[32:35], s101 offen sc1
    s_add_u32 s101, s101, 73728
    buffer_load_dwordx2 a[158:159], v202, s[32:35], s101 offen sc1
    v_mul_f32 v96, v96, v210
    v_mul_f32 v97, v97, v210
    v_mul_f32 v98, v98, v210
    v_mul_f32 v99, v99, v210
    v_mul_f32 v100, v100, v210
    v_mul_f32 v101, v101, v210
    v_mul_f32 v102, v102, v210
    v_mul_f32 v103, v103, v210
    v_mul_f32 v104, v104, v210
    v_mul_f32 v105, v105, v210
    v_mul_f32 v106, v106, v210
    v_mul_f32 v107, v107, v210
    v_mul_f32 v108, v108, v210
    v_mul_f32 v109, v109, v210
    v_mul_f32 v110, v110, v210
    v_mul_f32 v111, v111, v210
    v_mul_f32 v112, v112, v210
    v_mul_f32 v113, v113, v210
    v_mul_f32 v114, v114, v210
    v_mul_f32 v115, v115, v210
    v_mfma_f32_4x4x4_16b_bf16 v[232:235], v[248:249], v[160:161], v[232:235]
    v_mfma_f32_4x4x4_16b_bf16 v[236:239], v[248:249], v[162:163], v[236:239]
    v_mfma_f32_4x4x4_16b_bf16 v[240:243], v[248:249], v[164:165], v[240:243]
    v_mfma_f32_4x4x4_16b_bf16 v[244:247], v[248:249], v[166:167], v[244:247]
    v_mfma_f32_4x4x4_16b_bf16 v[232:235], v[248:249], v[168:169], v[232:235]
    v_mfma_f32_4x4x4_16b_bf16 v[236:239], v[248:249], v[170:171], v[236:239]
    v_mfma_f32_4x4x4_16b_bf16 v[240:243], v[248:249], v[172:173], v[240:243]
    v_mfma_f32_4x4x4_16b_bf16 v[244:247], v[248:249], v[174:175], v[244:247]
    s_cmp_eq_u32 s47, 47185920
    s_cselect_b32 s42, 47251456, 1073741824
    v_mov_b32 v254, s40
    buffer_store_dword v254, v255, s[32:35], s42 offen sc1
    s_waitcnt vmcnt(12)
    v_mfma_f32_4x4x4_16b_bf16 v[232:235], v[248:249], v[176:177], v[232:235]
    v_mfma_f32_4x4x4_16b_bf16 v[236:239], v[248:249], v[178:179], v[236:239]
    s_waitcnt vmcnt(11)
    v_mfma_f32_4x4x4_16b_bf16 v[240:243], v[248:249], v[180:181], v[240:243]
    v_mfma_f32_4x4x4_16b_bf16 v[244:247], v[248:249], v[182:183], v[244:247]
    s_waitcnt vmcnt(10)
    v_mfma_f32_4x4x4_16b_bf16 v[232:235], v[248:249], v[184:185], v[232:235]
    v_mfma_f32_4x4x4_16b_bf16 v[236:239], v[248:249], v[186:187], v[236:239]
    s_waitcnt vmcnt(9)
    v_mfma_f32_4x4x4_16b_bf16 v[240:243], v[248:249], v[188:189], v[240:243]
    v_mfma_f32_4x4x4_16b_bf16 v[244:247], v[248:249], v[190:191], v[244:247]
    s_nop 3
    v_mul_f32 v32, v211, v232
    v_mul_f32 v33, v211, v233
    v_mul_f32 v34, v211, v234
    v_mul_f32 v35, v211, v235
    v_mul_f32 v36, v211, v236
    v_mul_f32 v37, v211, v237
    v_mul_f32 v38, v211, v238
    v_mul_f32 v39, v211, v239
    v_mul_f32 v232, v232, v96
    v_mul_f32 v233, v233, v97
    v_mul_f32 v234, v234, v98
    v_mul_f32 v235, v235, v99
    v_mul_f32 v236, v236, v100
    v_mul_f32 v237, v237, v101
    v_mul_f32 v238, v238, v102
    v_mul_f32 v239, v239, v103
    v_exp_f32 v32, v32
    v_exp_f32 v33, v33
    v_exp_f32 v34, v34
    v_exp_f32 v35, v35
    v_exp_f32 v36, v36
    v_exp_f32 v37, v37
    v_exp_f32 v38, v38
    v_exp_f32 v39, v39
    v_add_f32 v32, 1.0, v32
    v_add_f32 v33, 1.0, v33
    v_add_f32 v34, 1.0, v34
    v_add_f32 v35, 1.0, v35
    v_add_f32 v36, 1.0, v36
    v_add_f32 v37, 1.0, v37
    v_add_f32 v38, 1.0, v38
    v_add_f32 v39, 1.0, v39
    v_rcp_f32 v32, v32
    v_rcp_f32 v33, v33
    v_rcp_f32 v34, v34
    v_rcp_f32 v35, v35
    v_rcp_f32 v36, v36
    v_rcp_f32 v37, v37
    v_rcp_f32 v38, v38
    v_rcp_f32 v39, v39
    v_fma_f32 v232, v232, v32, v128
    v_fma_f32 v233, v233, v33, v129
    v_fma_f32 v234, v234, v34, v130
    v_fma_f32 v235, v235, v35, v131
    v_fma_f32 v236, v236, v36, v132
    v_fma_f32 v237, v237, v37, v133
    v_fma_f32 v238, v238, v38, v134
    v_fma_f32 v239, v239, v39, v135
    v_cvt_pk_bf16_f32 v232, v232, v233
    v_cvt_pk_bf16_f32 v233, v234, v235
    ds_write_b64 v203, v[232:233] offset:0
    v_cvt_pk_bf16_f32 v236, v236, v237
    v_cvt_pk_bf16_f32 v237, v238, v239
    ds_write_b64 v203, v[236:237] offset:32
    v_mul_f32 v40, v211, v240
    v_mul_f32 v41, v211, v241
    v_mul_f32 v42, v211, v242
    v_mul_f32 v43, v211, v243
    v_mul_f32 v44, v211, v244
    v_mul_f32 v45, v211, v245
    v_mul_f32 v46, v211, v246
    v_mul_f32 v47, v211, v247
    v_mul_f32 v240, v240, v104
    v_mul_f32 v241, v241, v105
    v_mul_f32 v242, v242, v106
    v_mul_f32 v243, v243, v107
    v_mul_f32 v244, v244, v108
    v_mul_f32 v245, v245, v109
    v_mul_f32 v246, v246, v110
    v_mul_f32 v247, v247, v111
    v_exp_f32 v40, v40
    v_exp_f32 v41, v41
    v_exp_f32 v42, v42
    v_exp_f32 v43, v43
    v_exp_f32 v44, v44
    v_exp_f32 v45, v45
    v_exp_f32 v46, v46
    v_exp_f32 v47, v47
    v_add_f32 v40, 1.0, v40
    v_add_f32 v41, 1.0, v41
    v_add_f32 v42, 1.0, v42
    v_add_f32 v43, 1.0, v43
    v_add_f32 v44, 1.0, v44
    v_add_f32 v45, 1.0, v45
    v_add_f32 v46, 1.0, v46
    v_add_f32 v47, 1.0, v47
    v_rcp_f32 v40, v40
    v_rcp_f32 v41, v41
    v_rcp_f32 v42, v42
    v_rcp_f32 v43, v43
    v_rcp_f32 v44, v44
    v_rcp_f32 v45, v45
    v_rcp_f32 v46, v46
    v_rcp_f32 v47, v47
    v_fma_f32 v240, v240, v40, v136
    v_fma_f32 v241, v241, v41, v137
    v_fma_f32 v242, v242, v42, v138
    v_fma_f32 v243, v243, v43, v139
    v_fma_f32 v244, v244, v44, v140
    v_fma_f32 v245, v245, v45, v141
    v_fma_f32 v246, v246, v46, v142
    v_fma_f32 v247, v247, v47, v143
    v_cvt_pk_bf16_f32 v240, v240, v241
    v_cvt_pk_bf16_f32 v241, v242, v243
    ds_write_b64 v203, v[240:241] offset:64
    v_cvt_pk_bf16_f32 v244, v244, v245
    v_cvt_pk_bf16_f32 v245, v246, v247
    ds_write_b64 v203, v[244:245] offset:96
    ds_read_b128 v[56:59], v204
    ds_read_b128 v[60:63], v204 offset:1152
    s_waitcnt vmcnt(8)
    v_mfma_f32_4x4x4_16b_bf16 v[152:155], v[248:249], a[144:145], 0
    s_waitcnt vmcnt(7)
    s_nop 0
    v_mfma_f32_4x4x4_16b_bf16 v[152:155], v[248:249], a[146:147], v[152:155]
    s_waitcnt vmcnt(6)
    s_nop 0
    v_mfma_f32_4x4x4_16b_bf16 v[152:155], v[248:249], a[148:149], v[152:155]
    s_waitcnt vmcnt(5)
    s_nop 0
    v_mfma_f32_4x4x4_16b_bf16 v[152:155], v[248:249], a[150:151], v[152:155]
    s_waitcnt lgkmcnt(1)
    buffer_store_dwordx4 v[56:59], v200, s[28:31], s85 offen
    s_waitcnt lgkmcnt(0)
    buffer_store_dwordx4 v[60:63], v200, s[28:31], s86 offen
    s_waitcnt vmcnt(6)
    v_mfma_f32_4x4x4_16b_bf16 v[152:155], v[248:249], a[152:153], v[152:155]
    s_waitcnt vmcnt(5)
    s_nop 0
    v_mfma_f32_4x4x4_16b_bf16 v[152:155], v[248:249], a[154:155], v[152:155]
    s_waitcnt vmcnt(4)
    s_nop 0
    v_mfma_f32_4x4x4_16b_bf16 v[152:155], v[248:249], a[156:157], v[152:155]
    s_waitcnt vmcnt(3)
    s_nop 0
    v_mfma_f32_4x4x4_16b_bf16 v[152:155], v[248:249], a[158:159], v[152:155]
    s_nop 7
    v_mul_f32 v48, v211, v152
    v_mul_f32 v49, v211, v153
    v_mul_f32 v50, v211, v154
    v_mul_f32 v51, v211, v155
    v_mul_f32 v152, v152, v112
    v_mul_f32 v153, v153, v113
    v_mul_f32 v154, v154, v114
    v_mul_f32 v155, v155, v115
    v_exp_f32 v48, v48
    v_exp_f32 v49, v49
    v_exp_f32 v50, v50
    v_exp_f32 v51, v51
    v_add_f32 v48, 1.0, v48
    v_add_f32 v49, 1.0, v49
    v_add_f32 v50, 1.0, v50
    v_add_f32 v51, 1.0, v51
    v_rcp_f32 v48, v48
    v_rcp_f32 v49, v49
    v_rcp_f32 v50, v50
    v_rcp_f32 v51, v51
    v_fma_f32 v152, v152, v48, v144
    v_fma_f32 v153, v153, v49, v145
    v_fma_f32 v154, v154, v50, v146
    v_fma_f32 v155, v155, v51, v147
    v_cvt_pk_bf16_f32 v152, v152, v153
    v_cvt_pk_bf16_f32 v153, v154, v155
    s_mov_b32 exec_hi, 0
    ds_write_b64 v203, v[152:153] offset:128
    s_mov_b32 exec_hi, -1
    ds_read_b128 v[52:55], v205
    s_waitcnt lgkmcnt(0)
    buffer_store_dwordx4 v[52:55], v201, s[28:31], s85 offen
L_end:
    s_endpgm
L_poll0_slow:
    s_mov_b32 s43, 300000
L_poll0_loop:
    s_sleep 1
    buffer_load_dword v253, v252, s[32:35], s77 offen sc1
    s_waitcnt vmcnt(0)
    v_subrev_u32 v253, s42, v253
    v_cmp_ge_u32 vcc, 14, v253
    s_sub_u32 s43, s43, 1
    s_cbranch_scc1 L_poll0_ok
        s_cmp_eq_u64 vcc, exec
    s_cbranch_scc0 L_poll0_loop
    s_branch L_poll0_ok
L_poll1_slow:
    s_mov_b32 s43, 300000
L_poll1_loop:
    s_sleep 1
    buffer_load_dword v253, v252, s[32:35], s77 offen sc1
    s_waitcnt vmcnt(0)
    v_subrev_u32 v253, s42, v253
    v_cmp_ge_u32 vcc, 13, v253
    s_sub_u32 s43, s43, 1
    s_cbranch_scc1 L_poll1_ok
        s_cmp_eq_u64 vcc, exec
    s_cbranch_scc0 L_poll1_loop
    s_branch L_poll1_ok
L_poll2_slow:
    s_mov_b32 s43, 300000
L_poll2_loop:
    s_sleep 1
    buffer_load_dword v253, v252, s[32:35], s77 offen sc1
    s_waitcnt vmcnt(0)
    v_subrev_u32 v253, s42, v253
    v_cmp_ge_u32 vcc, 12, v253
    s_sub_u32 s43, s43, 1
    s_cbranch_scc1 L_poll2_ok
        s_cmp_eq_u64 vcc, exec
    s_cbranch_scc0 L_poll2_loop
    s_branch L_poll2_ok
L_poll3_slow:
    s_mov_b32 s43, 300000
L_poll3_loop:
    s_sleep 1
    buffer_load_dword v253, v252, s[32:35], s77 offen sc1
    s_waitcnt vmcnt(0)
    v_subrev_u32 v253, s42, v253
    v_cmp_ge_u32 vcc, 11, v253
    s_sub_u32 s43, s43, 1
    s_cbranch_scc1 L_poll3_ok
        s_cmp_eq_u64 vcc, exec
    s_cbranch_scc0 L_poll3_loop
    s_branch L_poll3_ok
L_poll4_slow:
    s_mov_b32 s43, 300000
L_poll4_loop:
    s_sleep 1
    buffer_load_dword v253, v252, s[32:35], s95 offen sc1
    s_waitcnt vmcnt(0)
    v_subrev_u32 v253, s42, v253
    v_cmp_ge_u32 vcc, 10, v253
    s_sub_u32 s43, s43, 1
    s_cbranch_scc1 L_poll4_ok
        s_cmp_eq_u64 vcc, exec
    s_cbranch_scc0 L_poll4_loop
    s_branch L_poll4_ok
L_poll5_slow:
    s_mov_b32 s43, 300000
L_poll5_loop:
    s_sleep 1
    buffer_load_dword v253, v252, s[32:35], s77 offen sc1
    s_waitcnt vmcnt(0)
    v_subrev_u32 v253, s42, v253
    v_cmp_ge_u32 vcc, 9, v253
    s_sub_u32 s43, s43, 1
    s_cbranch_scc1 L_poll5_ok
        s_cmp_eq_u64 vcc, exec
    s_cbranch_scc0 L_poll5_loop
    s_branch L_poll5_ok
L_poll6_slow:
    s_mov_b32 s43, 300000
L_poll6_loop:
    s_sleep 1
    buffer_load_dword v253, v250, s[32:35], s94 offen sc1
    s_waitcnt vmcnt(0)
    v_subrev_u32 v253, s42, v253
    v_cmp_ge_u32 vcc, 8, v253
    s_sub_u32 s43, s43, 1
    s_cbranch_scc1 L_poll6_ok
    s_orn2_b64 vcc, vcc, s[0:1]
    s_cmp_eq_u64 vcc, exec
    s_cbranch_scc0 L_poll6_loop
    s_branch L_poll6_ok
L_poll7_slow:
    s_mov_b32 s43, 300000
L_poll7_loop:
    s_sleep 1
    buffer_load_dword v253, v250, s[32:35], s94 offen sc1
    s_waitcnt vmcnt(0)
    v_subrev_u32 v253, s42, v253
    v_cmp_ge_u32 vcc, 7, v253
    s_sub_u32 s43, s43, 1
    s_cbranch_scc1 L_poll7_ok
    s_orn2_b64 vcc, vcc, s[0:1]
    s_cmp_eq_u64 vcc, exec
    s_cbranch_scc0 L_poll7_loop
    s_branch L_poll7_ok
L_poll8_slow:
    s_mov_b32 s43, 300000
L_poll8_loop:
    s_sleep 1
    buffer_load_dword v253, v250, s[32:35], s94 offen sc1
    s_waitcnt vmcnt(0)
    v_subrev_u32 v253, s42, v253
    v_cmp_ge_u32 vcc, 6, v253
    s_sub_u32 s43, s43, 1
    s_cbranch_scc1 L_poll8_ok
        s_cmp_eq_u64 vcc, exec
    s_cbranch_scc0 L_poll8_loop
    s_branch L_poll8_ok
.fill 4096, 4, 0xbf800000

.section .rodata,"a"
.p2align 6
.amdhsa_kernel recurrent_scan__linear_attn_block__glu_gated_bilinear__prompt_kernel
  .amdhsa_next_free_vgpr 512
  .amdhsa_next_free_sgpr 102
  .amdhsa_accum_offset 256
  .amdhsa_group_segment_fixed_size 0
  .amdhsa_kernarg_size 80
  .amdhsa_user_sgpr_count 2
  .amdhsa_user_sgpr_kernarg_segment_ptr 1
  .amdhsa_system_sgpr_workgroup_id_x 1
.end_amdhsa_kernel
```
